```python
import torch

def _softmax(x, axis=-1):
    return torch.softmax(x, dim=axis)
def _gelu(x):
    return torch.nn.functional.gelu(x, approximate="tanh")
def _silu(x):
    return torch.nn.functional.silu(x)
def _sigmoid(x):
    return torch.sigmoid(x)
def _layernorm(x, axis=-1, eps=1e-5):
    m = x.mean(dim=axis, keepdim=True)
    v = x.var(dim=axis, keepdim=True, unbiased=False)
    return (x - m) / torch.sqrt(v + eps)
def _scatter_add(tgt, idx, src, axis=0):
    return tgt.clone().index_add_(axis, idx, src)
def _segment_sum(src, seg, n):
    out = torch.zeros((n,) + src.shape[1:], dtype=src.dtype)
    return out.index_add_(0, seg, src)
def _pad(x, pw):
    flat = tuple(v for pair in reversed(pw) for v in pair)
    return torch.nn.functional.pad(x, flat)

kernel_name = 'recurrent_scan__ssm_conv_s5__glu_gated_bilinear__prompt'

def setup_inputs():

    _w = (lambda a: (lambda t: t.to(torch.bfloat16) if t.is_floating_point() else t)(torch.as_tensor(a)))
    def _A_setup():
        B, S, D = 1, 2048, 512
        P = D
        Lambda_re = -0.5 * (lambda _x: torch.exp(torch.as_tensor(_x)))((lambda *s: torch.randn(*s, dtype=torch.bfloat16) * 0.8)(P))
        Lambda_im = (lambda *s: torch.randn(*s, dtype=torch.bfloat16) * 0.8)(P) * 1.0
        B_re = (lambda *s: torch.randn(*s, dtype=torch.bfloat16) * 1.6)(P, D) * (D ** -0.5)
        B_im = (lambda *s: torch.randn(*s, dtype=torch.bfloat16) * 0.8)(P, D) * (D ** -0.5)
        C_re = (lambda *s: torch.randn(*s, dtype=torch.bfloat16) * 1.6)(D, P) * (P ** -0.5)
        C_im = (lambda *s: torch.randn(*s, dtype=torch.bfloat16) * 0.8)(D, P) * (P ** -0.5)
        log_dt = (lambda *s: torch.randn(*s, dtype=torch.bfloat16) * 0.8)(P) * 0.3 - 2.0
        Dskip = (lambda *s: torch.randn(*s, dtype=torch.bfloat16) * 0.8)(D)
        return {
            "x": _w((lambda *s: torch.randn(*s, dtype=torch.bfloat16) * 0.05)(B, S, D)),
            "Lambda_re": _w(Lambda_re),
            "Lambda_im": _w(Lambda_im),
            "B_re": _w(B_re),
            "B_im": _w(B_im),
            "C_re": _w(C_re),
            "C_im": _w(C_im),
            "log_dt": _w(log_dt),
            "Dskip": _w(Dskip),
        }
    _A_in = _A_setup()

    def _B_setup():
        B, S, D, F = 1, 2048, 512, 1792
        return {
            "x": _w((lambda *s: torch.randn(*s, dtype=torch.bfloat16) * 0.05)(B, S, D)),
            "w_gate": _w((lambda *s: torch.randn(*s, dtype=torch.bfloat16) * 0.2)(D, F) * (D ** -0.5)),
            "w_up": _w((lambda *s: torch.randn(*s, dtype=torch.bfloat16) * 0.2)(D, F) * (D ** -0.5)),
            "w_down": _w((lambda *s: torch.randn(*s, dtype=torch.bfloat16) * 0.2)(F, D) * (F ** -0.5)),
        }
    _B_in = _B_setup()

    return {
        "A_x": _A_in["x"],
        "A_Lambda_re": _A_in["Lambda_re"],
        "A_Lambda_im": _A_in["Lambda_im"],
        "A_B_re": _A_in["B_re"],
        "A_B_im": _A_in["B_im"],
        "A_C_re": _A_in["C_re"],
        "A_C_im": _A_in["C_im"],
        "A_log_dt": _A_in["log_dt"],
        "A_Dskip": _A_in["Dskip"],
        "B_x": _B_in["x"],
        "B_w_gate": _B_in["w_gate"],
        "B_w_up": _B_in["w_up"],
        "B_w_down": _B_in["w_down"],
    }

def reference(A_x, A_Lambda_re, A_Lambda_im, A_B_re, A_B_im, A_C_re, A_C_im, A_log_dt, A_Dskip, B_x, B_w_gate, B_w_up, B_w_down):
    def _A_ref(x, Lambda_re, Lambda_im, B_re, B_im, C_re, C_im, log_dt, Dskip):
        Bsz, L, H = x.shape
        Lam = Lambda_re + 1j * Lambda_im
        Bmat = B_re + 1j * B_im
        Cmat = C_re + 1j * C_im
        dt = torch.exp(log_dt)
        Lam_bar = torch.exp(dt * Lam)
        B_bar = ((Lam_bar - 1.0) / Lam)[:, None] * Bmat
        Bu = torch.einsum("bld,pd->blp", x + 0j, B_bar)
        h = torch.zeros_like(Bu[:, 0, :])
        hs = []
        for t in range(L):
            h = Lam_bar[None, :] * h + Bu[:, t, :]
            hs.append(h)
        hseq = torch.stack(hs, 1)
        y = 2.0 * torch.einsum("blp,dp->bld", hseq, Cmat).real + x * Dskip[None, None, :]
        return y

    def _B_ref(x, w_gate, w_up, w_down):
        g = torch.einsum("bsd,df->bsf", x, w_gate)
        u = torch.einsum("bsd,df->bsf", x, w_up)
        h = g * u
        return torch.einsum("bsf,fd->bsd", h, w_down)

    x = A_x
    xn = _layernorm(x, axis=-1)
    s = _A_ref(xn, A_Lambda_re, A_Lambda_im, A_B_re, A_B_im, A_C_re, A_C_im, A_log_dt, A_Dskip)
    g = _silu(_B_ref(xn, B_w_gate, B_w_up, B_w_down))
    return x + s * g
```

```asm
; @launch kernel=prep_kernel grid=(1856,1,1) block=(256,1,1) lds=0
; @launch kernel=k1_kernel grid=(256,1,1) block=(256,1,1) lds=133120
; @launch kernel=k2_kernel grid=(256,1,1) block=(256,1,1) lds=131072
.amdgcn_target "amdgcn-amd-amdhsa--gfx950"
.text
.globl prep_kernel
.p2align 8
.type prep_kernel,@function
prep_kernel:
    s_cmp_ge_u32 s2, 1856
    s_cbranch_scc1 P_done
    s_load_dwordx2 s[4:5], s[0:1], 120
    s_cmp_ge_u32 s2, 1408
    s_cbranch_scc1 P_w2d
    s_cmp_ge_u32 s2, 1152
    s_cbranch_scc1 P_w2c
    s_cmp_ge_u32 s2, 1024
    s_cbranch_scc1 P_w1s
    s_cmp_ge_u32 s2, 512
    s_cbranch_scc1 P_w1g
    s_load_dwordx2 s[6:7], s[0:1], 0
    s_load_dwordx2 s[8:9], s[0:1], 64
    s_waitcnt lgkmcnt(0)
    s_mov_b32 s12, s6
    s_mov_b32 s13, s7
    s_mov_b32 s14, 2097152
    s_mov_b32 s15, 0x00020000
    s_mov_b32 s16, s8
    s_mov_b32 s17, s9
    s_mov_b32 s18, 1024
    s_mov_b32 s19, 0x00020000
    s_add_u32 s20, s4, 0
    s_addc_u32 s21, s5, 0
    s_mov_b32 s22, 2097152
    s_mov_b32 s23, 0x00020000
    s_add_u32 s24, s4, 2097152
    s_addc_u32 s25, s5, 0
    s_mov_b32 s26, 2097152
    s_mov_b32 s27, 0x00020000
    v_and_b32 v1, 63, v0
    v_lshrrev_b32 v2, 6, v0
    s_lshl_b32 s3, s2, 2
    v_add_u32 v3, s3, v2
    v_lshlrev_b32 v4, 10, v3
    v_lshl_add_u32 v4, v1, 4, v4
    v_lshlrev_b32 v5, 4, v1
    buffer_load_dwordx4 v[8:11], v4, s[12:15], 0 offen
    buffer_load_dwordx4 v[12:15], v5, s[16:19], 0 offen
    v_lshlrev_b32 v6, 2, v1
    s_mov_b32 s30, 0xffff0000
    s_waitcnt vmcnt(1)
    v_lshlrev_b32 v16, 16, v8
    v_and_b32 v17, s30, v8
    v_lshlrev_b32 v18, 16, v9
    v_and_b32 v19, s30, v9
    v_lshlrev_b32 v20, 16, v10
    v_and_b32 v21, s30, v10
    v_lshlrev_b32 v22, 16, v11
    v_and_b32 v23, s30, v11
    v_add_f32 v24, v16, v17
    v_add_f32 v24, v24, v18
    v_add_f32 v24, v24, v19
    v_add_f32 v24, v24, v20
    v_add_f32 v24, v24, v21
    v_add_f32 v24, v24, v22
    v_add_f32 v24, v24, v23
    v_xor_b32 v25, 4, v6
    ds_bpermute_b32 v26, v25, v24
    s_waitcnt lgkmcnt(0)
    v_add_f32 v24, v24, v26
    v_xor_b32 v25, 8, v6
    ds_bpermute_b32 v26, v25, v24
    s_waitcnt lgkmcnt(0)
    v_add_f32 v24, v24, v26
    v_xor_b32 v25, 16, v6
    ds_bpermute_b32 v26, v25, v24
    s_waitcnt lgkmcnt(0)
    v_add_f32 v24, v24, v26
    v_xor_b32 v25, 32, v6
    ds_bpermute_b32 v26, v25, v24
    s_waitcnt lgkmcnt(0)
    v_add_f32 v24, v24, v26
    v_xor_b32 v25, 64, v6
    ds_bpermute_b32 v26, v25, v24
    s_waitcnt lgkmcnt(0)
    v_add_f32 v24, v24, v26
    v_xor_b32 v25, 128, v6
    ds_bpermute_b32 v26, v25, v24
    s_waitcnt lgkmcnt(0)
    v_add_f32 v24, v24, v26
    v_mul_f32 v24, 0x3b000000, v24
    v_sub_f32 v32, v16, v24
    v_sub_f32 v33, v17, v24
    v_sub_f32 v34, v18, v24
    v_sub_f32 v35, v19, v24
    v_sub_f32 v36, v20, v24
    v_sub_f32 v37, v21, v24
    v_sub_f32 v38, v22, v24
    v_sub_f32 v39, v23, v24
    v_mul_f32 v27, v32, v32
    v_fmac_f32 v27, v33, v33
    v_fmac_f32 v27, v34, v34
    v_fmac_f32 v27, v35, v35
    v_fmac_f32 v27, v36, v36
    v_fmac_f32 v27, v37, v37
    v_fmac_f32 v27, v38, v38
    v_fmac_f32 v27, v39, v39
    v_xor_b32 v25, 4, v6
    ds_bpermute_b32 v26, v25, v27
    s_waitcnt lgkmcnt(0)
    v_add_f32 v27, v27, v26
    v_xor_b32 v25, 8, v6
    ds_bpermute_b32 v26, v25, v27
    s_waitcnt lgkmcnt(0)
    v_add_f32 v27, v27, v26
    v_xor_b32 v25, 16, v6
    ds_bpermute_b32 v26, v25, v27
    s_waitcnt lgkmcnt(0)
    v_add_f32 v27, v27, v26
    v_xor_b32 v25, 32, v6
    ds_bpermute_b32 v26, v25, v27
    s_waitcnt lgkmcnt(0)
    v_add_f32 v27, v27, v26
    v_xor_b32 v25, 64, v6
    ds_bpermute_b32 v26, v25, v27
    s_waitcnt lgkmcnt(0)
    v_add_f32 v27, v27, v26
    v_xor_b32 v25, 128, v6
    ds_bpermute_b32 v26, v25, v27
    s_waitcnt lgkmcnt(0)
    v_add_f32 v27, v27, v26
    v_mul_f32 v27, 0x3b000000, v27
    v_cvt_pk_bf16_f32 v25, v24, v24
    v_lshlrev_b32 v24, 16, v25
    v_cvt_pk_bf16_f32 v25, v27, v27
    v_lshlrev_b32 v27, 16, v25
    v_add_f32 v27, 0x3727c5ac, v27
    v_cvt_pk_bf16_f32 v25, v27, v27
    v_lshlrev_b32 v27, 16, v25
    v_sqrt_f32 v27, v27
    s_nop 0
    v_cvt_pk_bf16_f32 v25, v27, v27
    v_lshlrev_b32 v27, 16, v25
    v_rcp_f32 v28, v27
    s_nop 0
    v_sub_f32 v32, v16, v24
    v_cvt_pk_bf16_f32 v25, v32, v32
    v_lshlrev_b32 v32, 16, v25
    v_mul_f32 v40, v32, v28
    v_fma_f32 v25, -v40, v27, v32
    v_fma_f32 v40, v25, v28, v40
    v_sub_f32 v33, v17, v24
    v_cvt_pk_bf16_f32 v25, v33, v33
    v_lshlrev_b32 v33, 16, v25
    v_mul_f32 v41, v33, v28
    v_fma_f32 v25, -v41, v27, v33
    v_fma_f32 v41, v25, v28, v41
    v_sub_f32 v34, v18, v24
    v_cvt_pk_bf16_f32 v25, v34, v34
    v_lshlrev_b32 v34, 16, v25
    v_mul_f32 v42, v34, v28
    v_fma_f32 v25, -v42, v27, v34
    v_fma_f32 v42, v25, v28, v42
    v_sub_f32 v35, v19, v24
    v_cvt_pk_bf16_f32 v25, v35, v35
    v_lshlrev_b32 v35, 16, v25
    v_mul_f32 v43, v35, v28
    v_fma_f32 v25, -v43, v27, v35
    v_fma_f32 v43, v25, v28, v43
    v_sub_f32 v36, v20, v24
    v_cvt_pk_bf16_f32 v25, v36, v36
    v_lshlrev_b32 v36, 16, v25
    v_mul_f32 v44, v36, v28
    v_fma_f32 v25, -v44, v27, v36
    v_fma_f32 v44, v25, v28, v44
    v_sub_f32 v37, v21, v24
    v_cvt_pk_bf16_f32 v25, v37, v37
    v_lshlrev_b32 v37, 16, v25
    v_mul_f32 v45, v37, v28
    v_fma_f32 v25, -v45, v27, v37
    v_fma_f32 v45, v25, v28, v45
    v_sub_f32 v38, v22, v24
    v_cvt_pk_bf16_f32 v25, v38, v38
    v_lshlrev_b32 v38, 16, v25
    v_mul_f32 v46, v38, v28
    v_fma_f32 v25, -v46, v27, v38
    v_fma_f32 v46, v25, v28, v46
    v_sub_f32 v39, v23, v24
    v_cvt_pk_bf16_f32 v25, v39, v39
    v_lshlrev_b32 v39, 16, v25
    v_mul_f32 v47, v39, v28
    v_fma_f32 v25, -v47, v27, v39
    v_fma_f32 v47, v25, v28, v47
    v_cvt_pk_bf16_f32 v48, v40, v41
    v_cvt_pk_bf16_f32 v49, v42, v43
    v_cvt_pk_bf16_f32 v50, v44, v45
    v_cvt_pk_bf16_f32 v51, v46, v47
    v_lshrrev_b32 v7, 4, v3
    v_lshlrev_b32 v7, 14, v7
    v_lshl_add_u32 v7, v1, 8, v7
    v_and_b32 v25, 15, v3
    v_lshl_add_u32 v7, v25, 4, v7
    buffer_store_dwordx4 v[48:51], v7, s[20:23], 0 offen
    s_waitcnt vmcnt(1)
    v_lshlrev_b32 v16, 16, v48
    v_and_b32 v17, s30, v48
    v_lshlrev_b32 v32, 16, v12
    v_and_b32 v33, s30, v12
    v_lshlrev_b32 v18, 16, v49
    v_and_b32 v19, s30, v49
    v_lshlrev_b32 v34, 16, v13
    v_and_b32 v35, s30, v13
    v_lshlrev_b32 v20, 16, v50
    v_and_b32 v21, s30, v50
    v_lshlrev_b32 v36, 16, v14
    v_and_b32 v37, s30, v14
    v_lshlrev_b32 v22, 16, v51
    v_and_b32 v23, s30, v51
    v_lshlrev_b32 v38, 16, v15
    v_and_b32 v39, s30, v15
    v_mul_f32 v16, v16, v32
    v_mul_f32 v17, v17, v33
    v_mul_f32 v18, v18, v34
    v_mul_f32 v19, v19, v35
    v_mul_f32 v20, v20, v36
    v_mul_f32 v21, v21, v37
    v_mul_f32 v22, v22, v38
    v_mul_f32 v23, v23, v39
    v_cvt_pk_bf16_f32 v52, v16, v17
    v_cvt_pk_bf16_f32 v53, v18, v19
    v_cvt_pk_bf16_f32 v54, v20, v21
    v_cvt_pk_bf16_f32 v55, v22, v23
    buffer_store_dwordx4 v[52:55], v4, s[24:27], 0 offen
    s_endpgm
P_w1g:
    s_load_dwordx2 s[6:7], s[0:1], 80
    s_load_dwordx2 s[8:9], s[0:1], 88
    v_lshrrev_b32 v2, 6, v0
    s_nop 0
    v_readfirstlane_b32 s3, v2
    s_sub_u32 s10, s2, 512
    s_lshl_b32 s10, s10, 2
    s_add_u32 s10, s10, s3
    s_and_b32 s11, s10, 31
    s_lshr_b32 s10, s10, 5
    s_cmp_ge_u32 s11, 28
    s_cbranch_scc1 P_done
    s_waitcnt lgkmcnt(0)
    s_mov_b32 s12, s6
    s_mov_b32 s13, s7
    s_mov_b32 s14, 1835008
    s_mov_b32 s15, 0x00020000
    s_mov_b32 s16, s8
    s_mov_b32 s17, s9
    s_mov_b32 s18, 1835008
    s_mov_b32 s19, 0x00020000
    s_add_u32 s20, s4, 4194304
    s_addc_u32 s21, s5, 0
    s_mov_b32 s22, 4718592
    s_mov_b32 s23, 0x00020000
    v_and_b32 v1, 63, v0
    s_lshl_b32 s3, s11, 6
    v_add_u32 v3, s3, v1
    v_lshlrev_b32 v4, 1, v3
    s_mul_i32 s28, s10, 28672
    s_add_u32 s32, s28, 0
    s_add_u32 s33, s28, 3584
    s_add_u32 s34, s28, 7168
    s_add_u32 s35, s28, 10752
    s_add_u32 s36, s28, 14336
    s_add_u32 s37, s28, 17920
    s_add_u32 s38, s28, 21504
    s_add_u32 s39, s28, 25088
    buffer_load_ushort v8, v4, s[12:15], s32 offen
    buffer_load_ushort v9, v4, s[12:15], s33 offen
    buffer_load_ushort v10, v4, s[12:15], s34 offen
    buffer_load_ushort v11, v4, s[12:15], s35 offen
    buffer_load_ushort v12, v4, s[12:15], s36 offen
    buffer_load_ushort v13, v4, s[12:15], s37 offen
    buffer_load_ushort v14, v4, s[12:15], s38 offen
    buffer_load_ushort v15, v4, s[12:15], s39 offen
    buffer_load_ushort v16, v4, s[16:19], s32 offen
    buffer_load_ushort v17, v4, s[16:19], s33 offen
    buffer_load_ushort v18, v4, s[16:19], s34 offen
    buffer_load_ushort v19, v4, s[16:19], s35 offen
    buffer_load_ushort v20, v4, s[16:19], s36 offen
    buffer_load_ushort v21, v4, s[16:19], s37 offen
    buffer_load_ushort v22, v4, s[16:19], s38 offen
    buffer_load_ushort v23, v4, s[16:19], s39 offen
    v_mul_u32_u24 v5, 9363, v3
    v_lshrrev_b32 v5, 20, v5
    v_mul_u32_u24 v6, 112, v5
    v_sub_u32 v6, v3, v6
    v_lshrrev_b32 v7, 3, v6
    v_mul_u32_u24 v5, 18*16*1024, v5
    v_lshl_add_u32 v5, v7, 10, v5
    v_and_b32 v6, 7, v6
    v_lshl_add_u32 v5, v6, 5, v5
    s_lshr_b32 s29, s10, 2
    s_mul_i32 s29, s29, 18432
    s_and_b32 s31, s10, 3
    s_lshl_b32 s31, s31, 8
    s_add_u32 s29, s29, s31
    s_add_u32 s29, s29, 4096
    s_waitcnt vmcnt(8)
    v_lshl_or_b32 v24, v9, 16, v8
    v_lshl_or_b32 v25, v11, 16, v10
    v_lshl_or_b32 v26, v13, 16, v12
    v_lshl_or_b32 v27, v15, 16, v14
    buffer_store_dwordx4 v[24:27], v5, s[20:23], s29 offen
    s_waitcnt vmcnt(1)
    v_lshl_or_b32 v28, v17, 16, v16
    v_lshl_or_b32 v29, v19, 16, v18
    v_lshl_or_b32 v30, v21, 16, v20
    v_lshl_or_b32 v31, v23, 16, v22
    buffer_store_dwordx4 v[28:31], v5, s[20:23], s29 offen offset:16
    s_endpgm
P_w1s:
    s_load_dwordx2 s[6:7], s[0:1], 24
    s_load_dwordx2 s[8:9], s[0:1], 32
    s_load_dwordx2 s[40:41], s[0:1], 8
    s_load_dwordx2 s[42:43], s[0:1], 16
    s_load_dwordx2 s[44:45], s[0:1], 56
    s_waitcnt lgkmcnt(0)
    s_mov_b32 s12, s6
    s_mov_b32 s13, s7
    s_mov_b32 s14, 524288
    s_mov_b32 s15, 0x00020000
    s_mov_b32 s16, s8
    s_mov_b32 s17, s9
    s_mov_b32 s18, 524288
    s_mov_b32 s19, 0x00020000
    s_add_u32 s20, s4, 4194304
    s_addc_u32 s21, s5, 0
    s_mov_b32 s22, 4718592
    s_mov_b32 s23, 0x00020000
    s_mov_b32 s24, s40
    s_mov_b32 s25, s41
    s_mov_b32 s26, 1024
    s_mov_b32 s27, 0x00020000
    s_mov_b32 s28, s42
    s_mov_b32 s29, s43
    s_mov_b32 s30, 1024
    s_mov_b32 s31, 0x00020000
    s_mov_b32 s32, s44
    s_mov_b32 s33, s45
    s_mov_b32 s34, 1024
    s_mov_b32 s35, 0x00020000
    v_and_b32 v1, 63, v0
    v_lshrrev_b32 v2, 6, v0
    s_sub_u32 s3, s2, 1024
    s_lshl_b32 s3, s3, 2
    v_add_u32 v3, s3, v2
    v_lshlrev_b32 v4, 1, v3
    buffer_load_ushort v8, v4, s[24:27], 0 offen
    buffer_load_ushort v9, v4, s[28:31], 0 offen
    buffer_load_ushort v10, v4, s[32:35], 0 offen
    v_lshlrev_b32 v5, 10, v3
    v_lshl_add_u32 v5, v1, 4, v5
    buffer_load_dwordx4 v[12:15], v5, s[12:15], 0 offen
    buffer_load_dwordx4 v[16:19], v5, s[16:19], 0 offen
    s_waitcnt vmcnt(2)
    v_lshlrev_b32 v8, 16, v8
    v_lshlrev_b32 v9, 16, v9
    v_lshlrev_b32 v10, 16, v10
    v_mul_f32 v22, 0x3fb8aa3b, v10
    v_exp_f32 v22, v22
    s_nop 0
    v_cvt_pk_bf16_f32 v23, v22, v22
    v_lshlrev_b32 v22, 16, v23
    v_mul_f32 v23, v22, v8
    v_mul_f32 v24, v22, v9
    v_mul_f32 v23, 0x3fb8aa3b, v23
    v_exp_f32 v23, v23
    v_mul_f32 v24, 0x3e22f983, v24
    v_fract_f32 v24, v24
    v_cos_f32 v20, v24
    v_sin_f32 v21, v24
    s_nop 0
    v_mul_f32 v20, v20, v23
    v_mul_f32 v21, v21, v23
    v_add_f32 v22, -1.0, v20
    v_mul_f32 v23, v8, v8
    v_fmac_f32 v23, v9, v9
    v_rcp_f32 v23, v23
    v_mul_f32 v26, v22, v8
    v_fmac_f32 v26, v21, v9
    v_mul_f32 v27, v21, v8
    v_fma_f32 v27, -v22, v9, v27
    v_mul_f32 v26, v26, v23
    v_mul_f32 v27, v27, v23
    s_mov_b32 s46, 0xffff0000
    s_waitcnt vmcnt(0)
    v_lshlrev_b32 v32, 16, v12
    v_and_b32 v33, s46, v12
    v_lshlrev_b32 v40, 16, v16
    v_and_b32 v41, s46, v16
    v_lshlrev_b32 v34, 16, v13
    v_and_b32 v35, s46, v13
    v_lshlrev_b32 v42, 16, v17
    v_and_b32 v43, s46, v17
    v_lshlrev_b32 v36, 16, v14
    v_and_b32 v37, s46, v14
    v_lshlrev_b32 v44, 16, v18
    v_and_b32 v45, s46, v18
    v_lshlrev_b32 v38, 16, v15
    v_and_b32 v39, s46, v15
    v_lshlrev_b32 v46, 16, v19
    v_and_b32 v47, s46, v19
    v_mul_f32 v48, v26, v32
    v_fma_f32 v48, -v27, v40, v48
    v_mul_f32 v56, v26, v40
    v_fmac_f32 v56, v27, v32
    v_mul_f32 v49, v26, v33
    v_fma_f32 v49, -v27, v41, v49
    v_mul_f32 v57, v26, v41
    v_fmac_f32 v57, v27, v33
    v_mul_f32 v50, v26, v34
    v_fma_f32 v50, -v27, v42, v50
    v_mul_f32 v58, v26, v42
    v_fmac_f32 v58, v27, v34
    v_mul_f32 v51, v26, v35
    v_fma_f32 v51, -v27, v43, v51
    v_mul_f32 v59, v26, v43
    v_fmac_f32 v59, v27, v35
    v_mul_f32 v52, v26, v36
    v_fma_f32 v52, -v27, v44, v52
    v_mul_f32 v60, v26, v44
    v_fmac_f32 v60, v27, v36
    v_mul_f32 v53, v26, v37
    v_fma_f32 v53, -v27, v45, v53
    v_mul_f32 v61, v26, v45
    v_fmac_f32 v61, v27, v37
    v_mul_f32 v54, v26, v38
    v_fma_f32 v54, -v27, v46, v54
    v_mul_f32 v62, v26, v46
    v_fmac_f32 v62, v27, v38
    v_mul_f32 v55, v26, v39
    v_fma_f32 v55, -v27, v47, v55
    v_mul_f32 v63, v26, v47
    v_fmac_f32 v63, v27, v39
    v_cvt_pk_bf16_f32 v64, v48, v49
    v_cvt_pk_bf16_f32 v68, v56, v57
    v_cvt_pk_bf16_f32 v65, v50, v51
    v_cvt_pk_bf16_f32 v69, v58, v59
    v_cvt_pk_bf16_f32 v66, v52, v53
    v_cvt_pk_bf16_f32 v70, v60, v61
    v_cvt_pk_bf16_f32 v67, v54, v55
    v_cvt_pk_bf16_f32 v71, v62, v63
    v_lshrrev_b32 v6, 5, v3
    v_mul_u32_u24 v6, 18*16*1024, v6
    v_lshrrev_b32 v7, 2, v1
    v_mul_u32_u24 v7, 18*1024, v7
    v_add_u32 v6, v6, v7
    v_bfe_u32 v7, v3, 4, 1
    v_lshl_add_u32 v6, v7, 11, v6
    v_and_b32 v7, 15, v3
    v_lshl_add_u32 v6, v7, 4, v6
    v_and_b32 v7, 3, v1
    v_lshl_add_u32 v6, v7, 8, v6
    buffer_store_dwordx4 v[64:67], v6, s[20:23], 0 offen
    buffer_store_dwordx4 v[68:71], v6, s[20:23], 0 offen offset:1024
    s_endpgm
P_w2c:
    s_load_dwordx2 s[6:7], s[0:1], 40
    s_load_dwordx2 s[8:9], s[0:1], 48
    s_waitcnt lgkmcnt(0)
    s_mov_b32 s12, s6
    s_mov_b32 s13, s7
    s_mov_b32 s14, 524288
    s_mov_b32 s15, 0x00020000
    s_mov_b32 s16, s8
    s_mov_b32 s17, s9
    s_mov_b32 s18, 524288
    s_mov_b32 s19, 0x00020000
    s_add_u32 s20, s4, 10485760
    s_addc_u32 s21, s5, 0
    s_mov_b32 s22, 1048576
    s_mov_b32 s23, 0x00020000
    v_and_b32 v1, 127, v0
    v_lshrrev_b32 v2, 7, v0
    s_sub_u32 s3, s2, 1152
    s_lshl_b32 s3, s3, 1
    v_add_u32 v3, s3, v2
    v_lshlrev_b32 v4, 10, v3
    v_lshl_add_u32 v4, v1, 3, v4
    buffer_load_dwordx2 v[8:9], v4, s[12:15], 0 offen
    buffer_load_dwordx2 v[10:11], v4, s[16:19], 0 offen
    v_lshrrev_b32 v5, 4, v3
    v_lshlrev_b32 v5, 15, v5
    v_lshl_add_u32 v5, v1, 8, v5
    v_and_b32 v6, 15, v3
    v_lshl_add_u32 v5, v6, 4, v5
    s_mov_b32 s30, 0x05040100
    s_mov_b32 s31, 0x07060302
    s_mov_b32 s32, 0x80008000
    s_waitcnt vmcnt(0)
    v_xor_b32 v10, s32, v10
    v_xor_b32 v11, s32, v11
    v_perm_b32 v12, v10, v8, s30
    v_perm_b32 v13, v10, v8, s31
    v_perm_b32 v14, v11, v9, s30
    v_perm_b32 v15, v11, v9, s31
    buffer_store_dwordx4 v[12:15], v5, s[20:23], 0 offen
    s_endpgm
P_w2d:
    s_load_dwordx2 s[6:7], s[0:1], 96
    v_lshrrev_b32 v2, 6, v0
    s_nop 0
    v_readfirstlane_b32 s3, v2
    s_sub_u32 s10, s2, 1408
    s_lshl_b32 s10, s10, 2
    s_add_u32 s10, s10, s3
    s_and_b32 s11, s10, 7
    s_lshr_b32 s10, s10, 3
    s_waitcnt lgkmcnt(0)
    s_mov_b32 s12, s6
    s_mov_b32 s13, s7
    s_mov_b32 s14, 1835008
    s_mov_b32 s15, 0x00020000
    s_add_u32 s20, s4, 11534336
    s_addc_u32 s21, s5, 0
    s_mov_b32 s22, 1835008
    s_mov_b32 s23, 0x00020000
    v_and_b32 v1, 63, v0
    s_lshl_b32 s3, s11, 6
    v_add_u32 v3, s3, v1
    v_lshlrev_b32 v4, 1, v3
    s_lshl_b32 s28, s10, 13
    s_add_u32 s32, s28, 0
    s_add_u32 s33, s28, 1024
    s_add_u32 s34, s28, 2048
    s_add_u32 s35, s28, 3072
    s_add_u32 s36, s28, 4096
    s_add_u32 s37, s28, 5120
    s_add_u32 s38, s28, 6144
    s_add_u32 s39, s28, 7168
    buffer_load_ushort v8, v4, s[12:15], s32 offen
    buffer_load_ushort v9, v4, s[12:15], s33 offen
    buffer_load_ushort v10, v4, s[12:15], s34 offen
    buffer_load_ushort v11, v4, s[12:15], s35 offen
    buffer_load_ushort v12, v4, s[12:15], s36 offen
    buffer_load_ushort v13, v4, s[12:15], s37 offen
    buffer_load_ushort v14, v4, s[12:15], s38 offen
    buffer_load_ushort v15, v4, s[12:15], s39 offen
    v_lshrrev_b32 v5, 4, v3
    v_mul_u32_u24 v5, 56*1024, v5
    v_and_b32 v6, 15, v3
    v_lshl_add_u32 v5, v6, 4, v5
    s_lshl_b32 s29, s10, 8
    s_waitcnt vmcnt(0)
    v_lshl_or_b32 v24, v9, 16, v8
    v_lshl_or_b32 v25, v11, 16, v10
    v_lshl_or_b32 v26, v13, 16, v12
    v_lshl_or_b32 v27, v15, 16, v14
    buffer_store_dwordx4 v[24:27], v5, s[20:23], s29 offen
P_done:
    s_endpgm
.section .rodata,"a"
.p2align 6
.amdhsa_kernel prep_kernel
  .amdhsa_next_free_vgpr 72
  .amdhsa_next_free_sgpr 48
  .amdhsa_accum_offset 72
  .amdhsa_group_segment_fixed_size 0
  .amdhsa_kernarg_size 128
  .amdhsa_user_sgpr_count 2
  .amdhsa_user_sgpr_kernarg_segment_ptr 1
  .amdhsa_system_sgpr_workgroup_id_x 1
.end_amdhsa_kernel
.text
.globl k1_kernel
.p2align 8
.type k1_kernel,@function
k1_kernel:
    s_cmp_ge_u32 s2, 256
    s_cbranch_scc1 K1_done
    s_load_dwordx2 s[4:5], s[0:1], 120
    s_load_dwordx2 s[36:37], s[0:1], 112
    s_lshr_b32 s6, s2, 4
    s_and_b32 s7, s2, 15
    v_lshrrev_b32 v1, 6, v0
    v_and_b32 v2, 63, v0
    s_nop 0
    v_readfirstlane_b32 s8, v1
    s_and_b32 s9, s8, 1
    s_lshr_b32 s10, s8, 1
    s_waitcnt lgkmcnt(0)
    s_add_u32 s12, s4, 0
    s_addc_u32 s13, s5, 0
    s_mov_b32 s14, 2097152
    s_mov_b32 s15, 0x00020000
    s_add_u32 s16, s4, 4194304
    s_addc_u32 s17, s5, 0
    s_mov_b32 s18, 4718592
    s_mov_b32 s19, 0x00020000
    s_add_u32 s20, s4, 16777216
    s_addc_u32 s21, s5, 0
    s_mov_b32 s22, 4194304
    s_mov_b32 s23, 0x00020000
    s_add_u32 s24, s4, 20971520
    s_addc_u32 s25, s5, 0
    s_mov_b32 s26, 7340032
    s_mov_b32 s27, 0x00020000
    s_add_u32 s28, s4, 29360128
    s_addc_u32 s29, s5, 0
    s_mov_b32 s30, 131072
    s_mov_b32 s31, 0x00020000
    s_mov_b32 s32, s36
    s_mov_b32 s33, s37
    s_mov_b32 s34, 256
    s_mov_b32 s35, 0x00020000
    v_lshlrev_b32 v3, 4, v2
    s_lshl_b32 s40, s6, 3
    s_lshl_b32 s41, s8, 1
    s_add_u32 s40, s40, s41
    s_lshl_b32 s40, s40, 14
    v_add_u32 v4, s40, v3
    s_mul_i32 s41, s7, 294912
    s_lshl_b32 s42, s8, 12
    s_add_u32 s42, s42, s41
    v_add_u32 v5, s42, v3
    s_and_b32 s42, s8, 1
    s_lshl_b32 s42, s42, 10
    s_add_u32 s42, s42, 16384
    s_add_u32 s43, s42, s41
    v_add_u32 v6, s43, v3
    s_lshl_b32 s44, s8, 11
    s_lshl_b32 s45, s8, 12
    s_add_u32 s45, s45, 8192
    s_add_u32 s46, s42, 8192
    s_lshl_b32 s47, s9, 12
    v_add_u32 v7, s47, v3
    v_add_u32 v8, 53248, v7
    v_add_u32 v9, 106496, v7
    s_mul_i32 s47, s10, 9216
    s_add_u32 s47, s47, 8192
    v_add_u32 v10, s47, v3
    v_add_u32 v11, 53248, v10
    v_add_u32 v12, 106496, v10
    s_mov_b32 s48, 0
    s_add_u32 m0, s44, 0
    s_mov_b32 s49, 16384
    buffer_load_dwordx4 v4, s[12:15], s48 offen lds
    s_add_u32 m0, s44, 1024
    s_mov_b32 s50, 0
    buffer_load_dwordx4 v4, s[12:15], s49 offen lds
    s_add_u32 m0, s45, 0
    s_nop 0
    buffer_load_dwordx4 v5, s[16:19], s50 offen offset:0 lds
    buffer_load_dwordx4 v5, s[16:19], s50 offen offset:1024 lds
    buffer_load_dwordx4 v5, s[16:19], s50 offen offset:2048 lds
    buffer_load_dwordx4 v5, s[16:19], s50 offen offset:3072 lds
    s_add_u32 m0, s46, 0
    s_nop 0
    buffer_load_dwordx4 v6, s[16:19], s50 offen lds
    s_mov_b32 s48, 1024
    s_add_u32 m0, s44, 26624
    s_mov_b32 s49, 17408
    buffer_load_dwordx4 v4, s[12:15], s48 offen lds
    s_add_u32 m0, s44, 27648
    s_mov_b32 s50, 18432
    buffer_load_dwordx4 v4, s[12:15], s49 offen lds
    s_add_u32 m0, s45, 26624
    s_nop 0
    buffer_load_dwordx4 v5, s[16:19], s50 offen offset:0 lds
    buffer_load_dwordx4 v5, s[16:19], s50 offen offset:1024 lds
    buffer_load_dwordx4 v5, s[16:19], s50 offen offset:2048 lds
    buffer_load_dwordx4 v5, s[16:19], s50 offen offset:3072 lds
    s_add_u32 m0, s46, 26624
    s_nop 0
    buffer_load_dwordx4 v6, s[16:19], s50 offen lds
    s_mov_b32 s48, 2048
    s_add_u32 m0, s44, 53248
    s_mov_b32 s49, 18432
    buffer_load_dwordx4 v4, s[12:15], s48 offen lds
    s_add_u32 m0, s44, 54272
    s_mov_b32 s50, 36864
    buffer_load_dwordx4 v4, s[12:15], s49 offen lds
    s_add_u32 m0, s45, 53248
    s_nop 0
    buffer_load_dwordx4 v5, s[16:19], s50 offen offset:0 lds
    buffer_load_dwordx4 v5, s[16:19], s50 offen offset:1024 lds
    buffer_load_dwordx4 v5, s[16:19], s50 offen offset:2048 lds
    buffer_load_dwordx4 v5, s[16:19], s50 offen offset:3072 lds
    s_add_u32 m0, s46, 53248
    s_nop 0
    buffer_load_dwordx4 v6, s[16:19], s50 offen lds
    s_mov_b32 s48, 3072
    s_add_u32 m0, s44, 79872
    s_mov_b32 s49, 19456
    buffer_load_dwordx4 v4, s[12:15], s48 offen lds
    s_add_u32 m0, s44, 80896
    s_mov_b32 s50, 55296
    buffer_load_dwordx4 v4, s[12:15], s49 offen lds
    s_add_u32 m0, s45, 79872
    s_nop 0
    buffer_load_dwordx4 v5, s[16:19], s50 offen offset:0 lds
    buffer_load_dwordx4 v5, s[16:19], s50 offen offset:1024 lds
    buffer_load_dwordx4 v5, s[16:19], s50 offen offset:2048 lds
    buffer_load_dwordx4 v5, s[16:19], s50 offen offset:3072 lds
    s_add_u32 m0, s46, 79872
    s_nop 0
    buffer_load_dwordx4 v6, s[16:19], s50 offen lds
    s_mov_b32 s48, 4096
    s_add_u32 m0, s44, 106496
    s_mov_b32 s49, 20480
    buffer_load_dwordx4 v4, s[12:15], s48 offen lds
    s_add_u32 m0, s44, 107520
    s_mov_b32 s50, 73728
    buffer_load_dwordx4 v4, s[12:15], s49 offen lds
    s_add_u32 m0, s45, 106496
    s_nop 0
    buffer_load_dwordx4 v5, s[16:19], s50 offen offset:0 lds
    buffer_load_dwordx4 v5, s[16:19], s50 offen offset:1024 lds
    buffer_load_dwordx4 v5, s[16:19], s50 offen offset:2048 lds
    buffer_load_dwordx4 v5, s[16:19], s50 offen offset:3072 lds
    s_add_u32 m0, s46, 106496
    s_nop 0
    buffer_load_dwordx4 v6, s[16:19], s50 offen lds
    s_waitcnt vmcnt(28)
    s_barrier
    ds_read_b128 v[32:35], v7 offset:0
    ds_read_b128 v[48:51], v10 offset:0
    ds_read_b128 v[36:39], v7 offset:1024
    ds_read_b128 v[52:55], v10 offset:1024
    ds_read_b128 v[40:43], v7 offset:2048
    ds_read_b128 v[56:59], v10 offset:2048
    ds_read_b128 v[44:47], v7 offset:3072
    ds_read_b128 v[60:63], v10 offset:3072
    ds_read_b128 v[64:67], v10 offset:4096
    ds_read_b128 v[68:71], v10 offset:5120
    ds_read_b128 v[72:75], v10 offset:6144
    ds_read_b128 v[76:79], v10 offset:7168
    ds_read_b128 v[80:83], v10 offset:8192
    s_cmp_eq_u32 s10, 0
    s_cbranch_scc0 K1_main1
    s_waitcnt vmcnt(21) lgkmcnt(0)
    s_barrier
    v_mfma_f32_16x16x32_bf16 a[0:3], v[32:35], v[48:51], 0
    s_mov_b32 s48, 5120
    v_mfma_f32_16x16x32_bf16 a[4:7], v[36:39], v[48:51], 0
    s_add_u32 m0, s44, 0
    v_mfma_f32_16x16x32_bf16 a[8:11], v[40:43], v[48:51], 0
    s_mov_b32 s49, 21504
    v_mfma_f32_16x16x32_bf16 a[12:15], v[44:47], v[48:51], 0
    buffer_load_dwordx4 v4, s[12:15], s48 offen lds
    v_mfma_f32_16x16x32_bf16 a[16:19], v[32:35], v[52:55], 0
    s_add_u32 m0, s44, 1024
    v_mfma_f32_16x16x32_bf16 a[20:23], v[36:39], v[52:55], 0
    s_mov_b32 s50, 92160
    v_mfma_f32_16x16x32_bf16 a[24:27], v[40:43], v[52:55], 0
    buffer_load_dwordx4 v4, s[12:15], s49 offen lds
    v_mfma_f32_16x16x32_bf16 a[28:31], v[44:47], v[52:55], 0
    s_add_u32 m0, s45, 0
    v_mfma_f32_16x16x32_bf16 a[32:35], v[32:35], v[56:59], 0
    s_nop 0
    v_mfma_f32_16x16x32_bf16 a[36:39], v[36:39], v[56:59], 0
    buffer_load_dwordx4 v5, s[16:19], s50 offen offset:0 lds
    v_mfma_f32_16x16x32_bf16 a[40:43], v[40:43], v[56:59], 0
    buffer_load_dwordx4 v5, s[16:19], s50 offen offset:1024 lds
    v_mfma_f32_16x16x32_bf16 a[44:47], v[44:47], v[56:59], 0
    buffer_load_dwordx4 v5, s[16:19], s50 offen offset:2048 lds
    v_mfma_f32_16x16x32_bf16 a[48:51], v[32:35], v[60:63], 0
    buffer_load_dwordx4 v5, s[16:19], s50 offen offset:3072 lds
    v_mfma_f32_16x16x32_bf16 a[52:55], v[36:39], v[60:63], 0
    s_add_u32 m0, s46, 0
    v_mfma_f32_16x16x32_bf16 a[56:59], v[40:43], v[60:63], 0
    s_nop 0
    v_mfma_f32_16x16x32_bf16 a[60:63], v[44:47], v[60:63], 0
    buffer_load_dwordx4 v6, s[16:19], s50 offen lds
    v_mfma_f32_16x16x32_bf16 a[64:67], v[64:67], v[32:35], 0
    ds_read_b128 v[84:87], v7 offset:26624
    v_mfma_f32_16x16x32_bf16 a[68:71], v[64:67], v[36:39], 0
    ds_read_b128 v[100:103], v10 offset:26624
    v_mfma_f32_16x16x32_bf16 a[72:75], v[64:67], v[40:43], 0
    ds_read_b128 v[88:91], v7 offset:27648
    v_mfma_f32_16x16x32_bf16 a[76:79], v[64:67], v[44:47], 0
    ds_read_b128 v[104:107], v10 offset:27648
    v_mfma_f32_16x16x32_bf16 a[80:83], v[68:71], v[32:35], 0
    ds_read_b128 v[92:95], v7 offset:28672
    v_mfma_f32_16x16x32_bf16 a[84:87], v[68:71], v[36:39], 0
    ds_read_b128 v[108:111], v10 offset:28672
    v_mfma_f32_16x16x32_bf16 a[88:91], v[68:71], v[40:43], 0
    ds_read_b128 v[96:99], v7 offset:29696
    v_mfma_f32_16x16x32_bf16 a[92:95], v[68:71], v[44:47], 0
    ds_read_b128 v[112:115], v10 offset:29696
    v_mfma_f32_16x16x32_bf16 a[96:99], v[72:75], v[32:35], 0
    ds_read_b128 v[116:119], v10 offset:30720
    v_mfma_f32_16x16x32_bf16 a[100:103], v[72:75], v[36:39], 0
    ds_read_b128 v[120:123], v10 offset:31744
    v_mfma_f32_16x16x32_bf16 a[104:107], v[72:75], v[40:43], 0
    ds_read_b128 v[124:127], v10 offset:32768
    v_mfma_f32_16x16x32_bf16 a[108:111], v[72:75], v[44:47], 0
    ds_read_b128 v[128:131], v10 offset:33792
    v_mfma_f32_16x16x32_bf16 a[112:115], v[76:79], v[32:35], 0
    ds_read_b128 v[132:135], v10 offset:34816
    v_mfma_f32_16x16x32_bf16 a[116:119], v[76:79], v[36:39], 0
    v_mfma_f32_16x16x32_bf16 a[120:123], v[76:79], v[40:43], 0
    v_mfma_f32_16x16x32_bf16 a[124:127], v[76:79], v[44:47], 0
    v_mfma_f32_16x16x32_bf16 a[128:131], v[80:83], v[32:35], 0
    v_mfma_f32_16x16x32_bf16 a[132:135], v[80:83], v[36:39], 0
    v_mfma_f32_16x16x32_bf16 a[136:139], v[80:83], v[40:43], 0
    v_mfma_f32_16x16x32_bf16 a[140:143], v[80:83], v[44:47], 0
    s_waitcnt vmcnt(21) lgkmcnt(0)
    s_barrier
    v_mfma_f32_16x16x32_bf16 a[0:3], v[84:87], v[100:103], a[0:3]
    s_mov_b32 s48, 6144
    v_mfma_f32_16x16x32_bf16 a[4:7], v[88:91], v[100:103], a[4:7]
    s_add_u32 m0, s44, 26624
    v_mfma_f32_16x16x32_bf16 a[8:11], v[92:95], v[100:103], a[8:11]
    s_mov_b32 s49, 22528
    v_mfma_f32_16x16x32_bf16 a[12:15], v[96:99], v[100:103], a[12:15]
    buffer_load_dwordx4 v4, s[12:15], s48 offen lds
    v_mfma_f32_16x16x32_bf16 a[16:19], v[84:87], v[104:107], a[16:19]
    s_add_u32 m0, s44, 27648
    v_mfma_f32_16x16x32_bf16 a[20:23], v[88:91], v[104:107], a[20:23]
    s_mov_b32 s50, 110592
    v_mfma_f32_16x16x32_bf16 a[24:27], v[92:95], v[104:107], a[24:27]
    buffer_load_dwordx4 v4, s[12:15], s49 offen lds
    v_mfma_f32_16x16x32_bf16 a[28:31], v[96:99], v[104:107], a[28:31]
    s_add_u32 m0, s45, 26624
    v_mfma_f32_16x16x32_bf16 a[32:35], v[84:87], v[108:111], a[32:35]
    s_nop 0
    v_mfma_f32_16x16x32_bf16 a[36:39], v[88:91], v[108:111], a[36:39]
    buffer_load_dwordx4 v5, s[16:19], s50 offen offset:0 lds
    v_mfma_f32_16x16x32_bf16 a[40:43], v[92:95], v[108:111], a[40:43]
    buffer_load_dwordx4 v5, s[16:19], s50 offen offset:1024 lds
    v_mfma_f32_16x16x32_bf16 a[44:47], v[96:99], v[108:111], a[44:47]
    buffer_load_dwordx4 v5, s[16:19], s50 offen offset:2048 lds
    v_mfma_f32_16x16x32_bf16 a[48:51], v[84:87], v[112:115], a[48:51]
    buffer_load_dwordx4 v5, s[16:19], s50 offen offset:3072 lds
    v_mfma_f32_16x16x32_bf16 a[52:55], v[88:91], v[112:115], a[52:55]
    s_add_u32 m0, s46, 26624
    v_mfma_f32_16x16x32_bf16 a[56:59], v[92:95], v[112:115], a[56:59]
    s_nop 0
    v_mfma_f32_16x16x32_bf16 a[60:63], v[96:99], v[112:115], a[60:63]
    buffer_load_dwordx4 v6, s[16:19], s50 offen lds
    v_mfma_f32_16x16x32_bf16 a[64:67], v[116:119], v[84:87], a[64:67]
    ds_read_b128 v[32:35], v8 offset:0
    v_mfma_f32_16x16x32_bf16 a[68:71], v[116:119], v[88:91], a[68:71]
    ds_read_b128 v[48:51], v11 offset:0
    v_mfma_f32_16x16x32_bf16 a[72:75], v[116:119], v[92:95], a[72:75]
    ds_read_b128 v[36:39], v8 offset:1024
    v_mfma_f32_16x16x32_bf16 a[76:79], v[116:119], v[96:99], a[76:79]
    ds_read_b128 v[52:55], v11 offset:1024
    v_mfma_f32_16x16x32_bf16 a[80:83], v[120:123], v[84:87], a[80:83]
    ds_read_b128 v[40:43], v8 offset:2048
    v_mfma_f32_16x16x32_bf16 a[84:87], v[120:123], v[88:91], a[84:87]
    ds_read_b128 v[56:59], v11 offset:2048
    v_mfma_f32_16x16x32_bf16 a[88:91], v[120:123], v[92:95], a[88:91]
    ds_read_b128 v[44:47], v8 offset:3072
    v_mfma_f32_16x16x32_bf16 a[92:95], v[120:123], v[96:99], a[92:95]
    ds_read_b128 v[60:63], v11 offset:3072
    v_mfma_f32_16x16x32_bf16 a[96:99], v[124:127], v[84:87], a[96:99]
    ds_read_b128 v[64:67], v11 offset:4096
    v_mfma_f32_16x16x32_bf16 a[100:103], v[124:127], v[88:91], a[100:103]
    ds_read_b128 v[68:71], v11 offset:5120
    v_mfma_f32_16x16x32_bf16 a[104:107], v[124:127], v[92:95], a[104:107]
    ds_read_b128 v[72:75], v11 offset:6144
    v_mfma_f32_16x16x32_bf16 a[108:111], v[124:127], v[96:99], a[108:111]
    ds_read_b128 v[76:79], v11 offset:7168
    v_mfma_f32_16x16x32_bf16 a[112:115], v[128:131], v[84:87], a[112:115]
    ds_read_b128 v[80:83], v11 offset:8192
    v_mfma_f32_16x16x32_bf16 a[116:119], v[128:131], v[88:91], a[116:119]
    v_mfma_f32_16x16x32_bf16 a[120:123], v[128:131], v[92:95], a[120:123]
    v_mfma_f32_16x16x32_bf16 a[124:127], v[128:131], v[96:99], a[124:127]
    v_mfma_f32_16x16x32_bf16 a[128:131], v[132:135], v[84:87], a[128:131]
    v_mfma_f32_16x16x32_bf16 a[132:135], v[132:135], v[88:91], a[132:135]
    v_mfma_f32_16x16x32_bf16 a[136:139], v[132:135], v[92:95], a[136:139]
    v_mfma_f32_16x16x32_bf16 a[140:143], v[132:135], v[96:99], a[140:143]
    s_waitcnt vmcnt(21) lgkmcnt(0)
    s_barrier
    v_mfma_f32_16x16x32_bf16 a[0:3], v[32:35], v[48:51], a[0:3]
    s_mov_b32 s48, 7168
    v_mfma_f32_16x16x32_bf16 a[4:7], v[36:39], v[48:51], a[4:7]
    s_add_u32 m0, s44, 53248
    v_mfma_f32_16x16x32_bf16 a[8:11], v[40:43], v[48:51], a[8:11]
    s_mov_b32 s49, 23552
    v_mfma_f32_16x16x32_bf16 a[12:15], v[44:47], v[48:51], a[12:15]
    buffer_load_dwordx4 v4, s[12:15], s48 offen lds
    v_mfma_f32_16x16x32_bf16 a[16:19], v[32:35], v[52:55], a[16:19]
    s_add_u32 m0, s44, 54272
    v_mfma_f32_16x16x32_bf16 a[20:23], v[36:39], v[52:55], a[20:23]
    s_mov_b32 s50, 129024
    v_mfma_f32_16x16x32_bf16 a[24:27], v[40:43], v[52:55], a[24:27]
    buffer_load_dwordx4 v4, s[12:15], s49 offen lds
    v_mfma_f32_16x16x32_bf16 a[28:31], v[44:47], v[52:55], a[28:31]
    s_add_u32 m0, s45, 53248
    v_mfma_f32_16x16x32_bf16 a[32:35], v[32:35], v[56:59], a[32:35]
    s_nop 0
    v_mfma_f32_16x16x32_bf16 a[36:39], v[36:39], v[56:59], a[36:39]
    buffer_load_dwordx4 v5, s[16:19], s50 offen offset:0 lds
    v_mfma_f32_16x16x32_bf16 a[40:43], v[40:43], v[56:59], a[40:43]
    buffer_load_dwordx4 v5, s[16:19], s50 offen offset:1024 lds
    v_mfma_f32_16x16x32_bf16 a[44:47], v[44:47], v[56:59], a[44:47]
    buffer_load_dwordx4 v5, s[16:19], s50 offen offset:2048 lds
    v_mfma_f32_16x16x32_bf16 a[48:51], v[32:35], v[60:63], a[48:51]
    buffer_load_dwordx4 v5, s[16:19], s50 offen offset:3072 lds
    v_mfma_f32_16x16x32_bf16 a[52:55], v[36:39], v[60:63], a[52:55]
    s_add_u32 m0, s46, 53248
    v_mfma_f32_16x16x32_bf16 a[56:59], v[40:43], v[60:63], a[56:59]
    s_nop 0
    v_mfma_f32_16x16x32_bf16 a[60:63], v[44:47], v[60:63], a[60:63]
    buffer_load_dwordx4 v6, s[16:19], s50 offen lds
    v_mfma_f32_16x16x32_bf16 a[64:67], v[64:67], v[32:35], a[64:67]
    ds_read_b128 v[84:87], v8 offset:26624
    v_mfma_f32_16x16x32_bf16 a[68:71], v[64:67], v[36:39], a[68:71]
    ds_read_b128 v[100:103], v11 offset:26624
    v_mfma_f32_16x16x32_bf16 a[72:75], v[64:67], v[40:43], a[72:75]
    ds_read_b128 v[88:91], v8 offset:27648
    v_mfma_f32_16x16x32_bf16 a[76:79], v[64:67], v[44:47], a[76:79]
    ds_read_b128 v[104:107], v11 offset:27648
    v_mfma_f32_16x16x32_bf16 a[80:83], v[68:71], v[32:35], a[80:83]
    ds_read_b128 v[92:95], v8 offset:28672
    v_mfma_f32_16x16x32_bf16 a[84:87], v[68:71], v[36:39], a[84:87]
    ds_read_b128 v[108:111], v11 offset:28672
    v_mfma_f32_16x16x32_bf16 a[88:91], v[68:71], v[40:43], a[88:91]
    ds_read_b128 v[96:99], v8 offset:29696
    v_mfma_f32_16x16x32_bf16 a[92:95], v[68:71], v[44:47], a[92:95]
    ds_read_b128 v[112:115], v11 offset:29696
    v_mfma_f32_16x16x32_bf16 a[96:99], v[72:75], v[32:35], a[96:99]
    ds_read_b128 v[116:119], v11 offset:30720
    v_mfma_f32_16x16x32_bf16 a[100:103], v[72:75], v[36:39], a[100:103]
    ds_read_b128 v[120:123], v11 offset:31744
    v_mfma_f32_16x16x32_bf16 a[104:107], v[72:75], v[40:43], a[104:107]
    ds_read_b128 v[124:127], v11 offset:32768
    v_mfma_f32_16x16x32_bf16 a[108:111], v[72:75], v[44:47], a[108:111]
    ds_read_b128 v[128:131], v11 offset:33792
    v_mfma_f32_16x16x32_bf16 a[112:115], v[76:79], v[32:35], a[112:115]
    ds_read_b128 v[132:135], v11 offset:34816
    v_mfma_f32_16x16x32_bf16 a[116:119], v[76:79], v[36:39], a[116:119]
    v_mfma_f32_16x16x32_bf16 a[120:123], v[76:79], v[40:43], a[120:123]
    v_mfma_f32_16x16x32_bf16 a[124:127], v[76:79], v[44:47], a[124:127]
    v_mfma_f32_16x16x32_bf16 a[128:131], v[80:83], v[32:35], a[128:131]
    v_mfma_f32_16x16x32_bf16 a[132:135], v[80:83], v[36:39], a[132:135]
    v_mfma_f32_16x16x32_bf16 a[136:139], v[80:83], v[40:43], a[136:139]
    v_mfma_f32_16x16x32_bf16 a[140:143], v[80:83], v[44:47], a[140:143]
    s_waitcnt vmcnt(21) lgkmcnt(0)
    s_barrier
    v_mfma_f32_16x16x32_bf16 a[0:3], v[84:87], v[100:103], a[0:3]
    s_mov_b32 s48, 8192
    v_mfma_f32_16x16x32_bf16 a[4:7], v[88:91], v[100:103], a[4:7]
    s_add_u32 m0, s44, 79872
    v_mfma_f32_16x16x32_bf16 a[8:11], v[92:95], v[100:103], a[8:11]
    s_mov_b32 s49, 24576
    v_mfma_f32_16x16x32_bf16 a[12:15], v[96:99], v[100:103], a[12:15]
    buffer_load_dwordx4 v4, s[12:15], s48 offen lds
    v_mfma_f32_16x16x32_bf16 a[16:19], v[84:87], v[104:107], a[16:19]
    s_add_u32 m0, s44, 80896
    v_mfma_f32_16x16x32_bf16 a[20:23], v[88:91], v[104:107], a[20:23]
    s_mov_b32 s50, 147456
    v_mfma_f32_16x16x32_bf16 a[24:27], v[92:95], v[104:107], a[24:27]
    buffer_load_dwordx4 v4, s[12:15], s49 offen lds
    v_mfma_f32_16x16x32_bf16 a[28:31], v[96:99], v[104:107], a[28:31]
    s_add_u32 m0, s45, 79872
    v_mfma_f32_16x16x32_bf16 a[32:35], v[84:87], v[108:111], a[32:35]
    s_nop 0
    v_mfma_f32_16x16x32_bf16 a[36:39], v[88:91], v[108:111], a[36:39]
    buffer_load_dwordx4 v5, s[16:19], s50 offen offset:0 lds
    v_mfma_f32_16x16x32_bf16 a[40:43], v[92:95], v[108:111], a[40:43]
    buffer_load_dwordx4 v5, s[16:19], s50 offen offset:1024 lds
    v_mfma_f32_16x16x32_bf16 a[44:47], v[96:99], v[108:111], a[44:47]
    buffer_load_dwordx4 v5, s[16:19], s50 offen offset:2048 lds
    v_mfma_f32_16x16x32_bf16 a[48:51], v[84:87], v[112:115], a[48:51]
    buffer_load_dwordx4 v5, s[16:19], s50 offen offset:3072 lds
    v_mfma_f32_16x16x32_bf16 a[52:55], v[88:91], v[112:115], a[52:55]
    s_add_u32 m0, s46, 79872
    v_mfma_f32_16x16x32_bf16 a[56:59], v[92:95], v[112:115], a[56:59]
    s_nop 0
    v_mfma_f32_16x16x32_bf16 a[60:63], v[96:99], v[112:115], a[60:63]
    buffer_load_dwordx4 v6, s[16:19], s50 offen lds
    v_mfma_f32_16x16x32_bf16 a[64:67], v[116:119], v[84:87], a[64:67]
    ds_read_b128 v[32:35], v9 offset:0
    v_mfma_f32_16x16x32_bf16 a[68:71], v[116:119], v[88:91], a[68:71]
    ds_read_b128 v[48:51], v12 offset:0
    v_mfma_f32_16x16x32_bf16 a[72:75], v[116:119], v[92:95], a[72:75]
    ds_read_b128 v[36:39], v9 offset:1024
    v_mfma_f32_16x16x32_bf16 a[76:79], v[116:119], v[96:99], a[76:79]
    ds_read_b128 v[52:55], v12 offset:1024
    v_mfma_f32_16x16x32_bf16 a[80:83], v[120:123], v[84:87], a[80:83]
    ds_read_b128 v[40:43], v9 offset:2048
    v_mfma_f32_16x16x32_bf16 a[84:87], v[120:123], v[88:91], a[84:87]
    ds_read_b128 v[56:59], v12 offset:2048
    v_mfma_f32_16x16x32_bf16 a[88:91], v[120:123], v[92:95], a[88:91]
    ds_read_b128 v[44:47], v9 offset:3072
    v_mfma_f32_16x16x32_bf16 a[92:95], v[120:123], v[96:99], a[92:95]
    ds_read_b128 v[60:63], v12 offset:3072
    v_mfma_f32_16x16x32_bf16 a[96:99], v[124:127], v[84:87], a[96:99]
    ds_read_b128 v[64:67], v12 offset:4096
    v_mfma_f32_16x16x32_bf16 a[100:103], v[124:127], v[88:91], a[100:103]
    ds_read_b128 v[68:71], v12 offset:5120
    v_mfma_f32_16x16x32_bf16 a[104:107], v[124:127], v[92:95], a[104:107]
    ds_read_b128 v[72:75], v12 offset:6144
    v_mfma_f32_16x16x32_bf16 a[108:111], v[124:127], v[96:99], a[108:111]
    ds_read_b128 v[76:79], v12 offset:7168
    v_mfma_f32_16x16x32_bf16 a[112:115], v[128:131], v[84:87], a[112:115]
    ds_read_b128 v[80:83], v12 offset:8192
    v_mfma_f32_16x16x32_bf16 a[116:119], v[128:131], v[88:91], a[116:119]
    v_mfma_f32_16x16x32_bf16 a[120:123], v[128:131], v[92:95], a[120:123]
    v_mfma_f32_16x16x32_bf16 a[124:127], v[128:131], v[96:99], a[124:127]
    v_mfma_f32_16x16x32_bf16 a[128:131], v[132:135], v[84:87], a[128:131]
    v_mfma_f32_16x16x32_bf16 a[132:135], v[132:135], v[88:91], a[132:135]
    v_mfma_f32_16x16x32_bf16 a[136:139], v[132:135], v[92:95], a[136:139]
    v_mfma_f32_16x16x32_bf16 a[140:143], v[132:135], v[96:99], a[140:143]
    s_waitcnt vmcnt(21) lgkmcnt(0)
    s_barrier
    v_mfma_f32_16x16x32_bf16 a[0:3], v[32:35], v[48:51], a[0:3]
    s_mov_b32 s48, 9216
    v_mfma_f32_16x16x32_bf16 a[4:7], v[36:39], v[48:51], a[4:7]
    s_add_u32 m0, s44, 106496
    v_mfma_f32_16x16x32_bf16 a[8:11], v[40:43], v[48:51], a[8:11]
    s_mov_b32 s49, 25600
    v_mfma_f32_16x16x32_bf16 a[12:15], v[44:47], v[48:51], a[12:15]
    buffer_load_dwordx4 v4, s[12:15], s48 offen lds
    v_mfma_f32_16x16x32_bf16 a[16:19], v[32:35], v[52:55], a[16:19]
    s_add_u32 m0, s44, 107520
    v_mfma_f32_16x16x32_bf16 a[20:23], v[36:39], v[52:55], a[20:23]
    s_mov_b32 s50, 165888
    v_mfma_f32_16x16x32_bf16 a[24:27], v[40:43], v[52:55], a[24:27]
    buffer_load_dwordx4 v4, s[12:15], s49 offen lds
    v_mfma_f32_16x16x32_bf16 a[28:31], v[44:47], v[52:55], a[28:31]
    s_add_u32 m0, s45, 106496
    v_mfma_f32_16x16x32_bf16 a[32:35], v[32:35], v[56:59], a[32:35]
    s_nop 0
    v_mfma_f32_16x16x32_bf16 a[36:39], v[36:39], v[56:59], a[36:39]
    buffer_load_dwordx4 v5, s[16:19], s50 offen offset:0 lds
    v_mfma_f32_16x16x32_bf16 a[40:43], v[40:43], v[56:59], a[40:43]
    buffer_load_dwordx4 v5, s[16:19], s50 offen offset:1024 lds
    v_mfma_f32_16x16x32_bf16 a[44:47], v[44:47], v[56:59], a[44:47]
    buffer_load_dwordx4 v5, s[16:19], s50 offen offset:2048 lds
    v_mfma_f32_16x16x32_bf16 a[48:51], v[32:35], v[60:63], a[48:51]
    buffer_load_dwordx4 v5, s[16:19], s50 offen offset:3072 lds
    v_mfma_f32_16x16x32_bf16 a[52:55], v[36:39], v[60:63], a[52:55]
    s_add_u32 m0, s46, 106496
    v_mfma_f32_16x16x32_bf16 a[56:59], v[40:43], v[60:63], a[56:59]
    s_nop 0
    v_mfma_f32_16x16x32_bf16 a[60:63], v[44:47], v[60:63], a[60:63]
    buffer_load_dwordx4 v6, s[16:19], s50 offen lds
    v_mfma_f32_16x16x32_bf16 a[64:67], v[64:67], v[32:35], a[64:67]
    ds_read_b128 v[84:87], v7 offset:0
    v_mfma_f32_16x16x32_bf16 a[68:71], v[64:67], v[36:39], a[68:71]
    ds_read_b128 v[100:103], v10 offset:0
    v_mfma_f32_16x16x32_bf16 a[72:75], v[64:67], v[40:43], a[72:75]
    ds_read_b128 v[88:91], v7 offset:1024
    v_mfma_f32_16x16x32_bf16 a[76:79], v[64:67], v[44:47], a[76:79]
    ds_read_b128 v[104:107], v10 offset:1024
    v_mfma_f32_16x16x32_bf16 a[80:83], v[68:71], v[32:35], a[80:83]
    ds_read_b128 v[92:95], v7 offset:2048
    v_mfma_f32_16x16x32_bf16 a[84:87], v[68:71], v[36:39], a[84:87]
    ds_read_b128 v[108:111], v10 offset:2048
    v_mfma_f32_16x16x32_bf16 a[88:91], v[68:71], v[40:43], a[88:91]
    ds_read_b128 v[96:99], v7 offset:3072
    v_mfma_f32_16x16x32_bf16 a[92:95], v[68:71], v[44:47], a[92:95]
    ds_read_b128 v[112:115], v10 offset:3072
    v_mfma_f32_16x16x32_bf16 a[96:99], v[72:75], v[32:35], a[96:99]
    ds_read_b128 v[116:119], v10 offset:4096
    v_mfma_f32_16x16x32_bf16 a[100:103], v[72:75], v[36:39], a[100:103]
    ds_read_b128 v[120:123], v10 offset:5120
    v_mfma_f32_16x16x32_bf16 a[104:107], v[72:75], v[40:43], a[104:107]
    ds_read_b128 v[124:127], v10 offset:6144
    v_mfma_f32_16x16x32_bf16 a[108:111], v[72:75], v[44:47], a[108:111]
    ds_read_b128 v[128:131], v10 offset:7168
    v_mfma_f32_16x16x32_bf16 a[112:115], v[76:79], v[32:35], a[112:115]
    ds_read_b128 v[132:135], v10 offset:8192
    v_mfma_f32_16x16x32_bf16 a[116:119], v[76:79], v[36:39], a[116:119]
    v_mfma_f32_16x16x32_bf16 a[120:123], v[76:79], v[40:43], a[120:123]
    v_mfma_f32_16x16x32_bf16 a[124:127], v[76:79], v[44:47], a[124:127]
    v_mfma_f32_16x16x32_bf16 a[128:131], v[80:83], v[32:35], a[128:131]
    v_mfma_f32_16x16x32_bf16 a[132:135], v[80:83], v[36:39], a[132:135]
    v_mfma_f32_16x16x32_bf16 a[136:139], v[80:83], v[40:43], a[136:139]
    v_mfma_f32_16x16x32_bf16 a[140:143], v[80:83], v[44:47], a[140:143]
    s_waitcnt vmcnt(21) lgkmcnt(0)
    s_barrier
    v_mfma_f32_16x16x32_bf16 a[0:3], v[84:87], v[100:103], a[0:3]
    s_mov_b32 s48, 10240
    v_mfma_f32_16x16x32_bf16 a[4:7], v[88:91], v[100:103], a[4:7]
    s_add_u32 m0, s44, 0
    v_mfma_f32_16x16x32_bf16 a[8:11], v[92:95], v[100:103], a[8:11]
    s_mov_b32 s49, 26624
    v_mfma_f32_16x16x32_bf16 a[12:15], v[96:99], v[100:103], a[12:15]
    buffer_load_dwordx4 v4, s[12:15], s48 offen lds
    v_mfma_f32_16x16x32_bf16 a[16:19], v[84:87], v[104:107], a[16:19]
    s_add_u32 m0, s44, 1024
    v_mfma_f32_16x16x32_bf16 a[20:23], v[88:91], v[104:107], a[20:23]
    s_mov_b32 s50, 184320
    v_mfma_f32_16x16x32_bf16 a[24:27], v[92:95], v[104:107], a[24:27]
    buffer_load_dwordx4 v4, s[12:15], s49 offen lds
    v_mfma_f32_16x16x32_bf16 a[28:31], v[96:99], v[104:107], a[28:31]
    s_add_u32 m0, s45, 0
    v_mfma_f32_16x16x32_bf16 a[32:35], v[84:87], v[108:111], a[32:35]
    s_nop 0
    v_mfma_f32_16x16x32_bf16 a[36:39], v[88:91], v[108:111], a[36:39]
    buffer_load_dwordx4 v5, s[16:19], s50 offen offset:0 lds
    v_mfma_f32_16x16x32_bf16 a[40:43], v[92:95], v[108:111], a[40:43]
    buffer_load_dwordx4 v5, s[16:19], s50 offen offset:1024 lds
    v_mfma_f32_16x16x32_bf16 a[44:47], v[96:99], v[108:111], a[44:47]
    buffer_load_dwordx4 v5, s[16:19], s50 offen offset:2048 lds
    v_mfma_f32_16x16x32_bf16 a[48:51], v[84:87], v[112:115], a[48:51]
    buffer_load_dwordx4 v5, s[16:19], s50 offen offset:3072 lds
    v_mfma_f32_16x16x32_bf16 a[52:55], v[88:91], v[112:115], a[52:55]
    s_add_u32 m0, s46, 0
    v_mfma_f32_16x16x32_bf16 a[56:59], v[92:95], v[112:115], a[56:59]
    s_nop 0
    v_mfma_f32_16x16x32_bf16 a[60:63], v[96:99], v[112:115], a[60:63]
    buffer_load_dwordx4 v6, s[16:19], s50 offen lds
    v_mfma_f32_16x16x32_bf16 a[64:67], v[116:119], v[84:87], a[64:67]
    ds_read_b128 v[32:35], v7 offset:26624
    v_mfma_f32_16x16x32_bf16 a[68:71], v[116:119], v[88:91], a[68:71]
    ds_read_b128 v[48:51], v10 offset:26624
    v_mfma_f32_16x16x32_bf16 a[72:75], v[116:119], v[92:95], a[72:75]
    ds_read_b128 v[36:39], v7 offset:27648
    v_mfma_f32_16x16x32_bf16 a[76:79], v[116:119], v[96:99], a[76:79]
    ds_read_b128 v[52:55], v10 offset:27648
    v_mfma_f32_16x16x32_bf16 a[80:83], v[120:123], v[84:87], a[80:83]
    ds_read_b128 v[40:43], v7 offset:28672
    v_mfma_f32_16x16x32_bf16 a[84:87], v[120:123], v[88:91], a[84:87]
    ds_read_b128 v[56:59], v10 offset:28672
    v_mfma_f32_16x16x32_bf16 a[88:91], v[120:123], v[92:95], a[88:91]
    ds_read_b128 v[44:47], v7 offset:29696
    v_mfma_f32_16x16x32_bf16 a[92:95], v[120:123], v[96:99], a[92:95]
    ds_read_b128 v[60:63], v10 offset:29696
    v_mfma_f32_16x16x32_bf16 a[96:99], v[124:127], v[84:87], a[96:99]
    ds_read_b128 v[64:67], v10 offset:30720
    v_mfma_f32_16x16x32_bf16 a[100:103], v[124:127], v[88:91], a[100:103]
    ds_read_b128 v[68:71], v10 offset:31744
    v_mfma_f32_16x16x32_bf16 a[104:107], v[124:127], v[92:95], a[104:107]
    ds_read_b128 v[72:75], v10 offset:32768
    v_mfma_f32_16x16x32_bf16 a[108:111], v[124:127], v[96:99], a[108:111]
    ds_read_b128 v[76:79], v10 offset:33792
    v_mfma_f32_16x16x32_bf16 a[112:115], v[128:131], v[84:87], a[112:115]
    ds_read_b128 v[80:83], v10 offset:34816
    v_mfma_f32_16x16x32_bf16 a[116:119], v[128:131], v[88:91], a[116:119]
    v_mfma_f32_16x16x32_bf16 a[120:123], v[128:131], v[92:95], a[120:123]
    v_mfma_f32_16x16x32_bf16 a[124:127], v[128:131], v[96:99], a[124:127]
    v_mfma_f32_16x16x32_bf16 a[128:131], v[132:135], v[84:87], a[128:131]
    v_mfma_f32_16x16x32_bf16 a[132:135], v[132:135], v[88:91], a[132:135]
    v_mfma_f32_16x16x32_bf16 a[136:139], v[132:135], v[92:95], a[136:139]
    v_mfma_f32_16x16x32_bf16 a[140:143], v[132:135], v[96:99], a[140:143]
    s_waitcnt vmcnt(21) lgkmcnt(0)
    s_barrier
    v_mfma_f32_16x16x32_bf16 a[0:3], v[32:35], v[48:51], a[0:3]
    s_mov_b32 s48, 11264
    v_mfma_f32_16x16x32_bf16 a[4:7], v[36:39], v[48:51], a[4:7]
    s_add_u32 m0, s44, 26624
    v_mfma_f32_16x16x32_bf16 a[8:11], v[40:43], v[48:51], a[8:11]
    s_mov_b32 s49, 27648
    v_mfma_f32_16x16x32_bf16 a[12:15], v[44:47], v[48:51], a[12:15]
    buffer_load_dwordx4 v4, s[12:15], s48 offen lds
    v_mfma_f32_16x16x32_bf16 a[16:19], v[32:35], v[52:55], a[16:19]
    s_add_u32 m0, s44, 27648
    v_mfma_f32_16x16x32_bf16 a[20:23], v[36:39], v[52:55], a[20:23]
    s_mov_b32 s50, 202752
    v_mfma_f32_16x16x32_bf16 a[24:27], v[40:43], v[52:55], a[24:27]
    buffer_load_dwordx4 v4, s[12:15], s49 offen lds
    v_mfma_f32_16x16x32_bf16 a[28:31], v[44:47], v[52:55], a[28:31]
    s_add_u32 m0, s45, 26624
    v_mfma_f32_16x16x32_bf16 a[32:35], v[32:35], v[56:59], a[32:35]
    s_nop 0
    v_mfma_f32_16x16x32_bf16 a[36:39], v[36:39], v[56:59], a[36:39]
    buffer_load_dwordx4 v5, s[16:19], s50 offen offset:0 lds
    v_mfma_f32_16x16x32_bf16 a[40:43], v[40:43], v[56:59], a[40:43]
    buffer_load_dwordx4 v5, s[16:19], s50 offen offset:1024 lds
    v_mfma_f32_16x16x32_bf16 a[44:47], v[44:47], v[56:59], a[44:47]
    buffer_load_dwordx4 v5, s[16:19], s50 offen offset:2048 lds
    v_mfma_f32_16x16x32_bf16 a[48:51], v[32:35], v[60:63], a[48:51]
    buffer_load_dwordx4 v5, s[16:19], s50 offen offset:3072 lds
    v_mfma_f32_16x16x32_bf16 a[52:55], v[36:39], v[60:63], a[52:55]
    s_add_u32 m0, s46, 26624
    v_mfma_f32_16x16x32_bf16 a[56:59], v[40:43], v[60:63], a[56:59]
    s_nop 0
    v_mfma_f32_16x16x32_bf16 a[60:63], v[44:47], v[60:63], a[60:63]
    buffer_load_dwordx4 v6, s[16:19], s50 offen lds
    v_mfma_f32_16x16x32_bf16 a[64:67], v[64:67], v[32:35], a[64:67]
    ds_read_b128 v[84:87], v8 offset:0
    v_mfma_f32_16x16x32_bf16 a[68:71], v[64:67], v[36:39], a[68:71]
    ds_read_b128 v[100:103], v11 offset:0
    v_mfma_f32_16x16x32_bf16 a[72:75], v[64:67], v[40:43], a[72:75]
    ds_read_b128 v[88:91], v8 offset:1024
    v_mfma_f32_16x16x32_bf16 a[76:79], v[64:67], v[44:47], a[76:79]
    ds_read_b128 v[104:107], v11 offset:1024
    v_mfma_f32_16x16x32_bf16 a[80:83], v[68:71], v[32:35], a[80:83]
    ds_read_b128 v[92:95], v8 offset:2048
    v_mfma_f32_16x16x32_bf16 a[84:87], v[68:71], v[36:39], a[84:87]
    ds_read_b128 v[108:111], v11 offset:2048
    v_mfma_f32_16x16x32_bf16 a[88:91], v[68:71], v[40:43], a[88:91]
    ds_read_b128 v[96:99], v8 offset:3072
    v_mfma_f32_16x16x32_bf16 a[92:95], v[68:71], v[44:47], a[92:95]
    ds_read_b128 v[112:115], v11 offset:3072
    v_mfma_f32_16x16x32_bf16 a[96:99], v[72:75], v[32:35], a[96:99]
    ds_read_b128 v[116:119], v11 offset:4096
    v_mfma_f32_16x16x32_bf16 a[100:103], v[72:75], v[36:39], a[100:103]
    ds_read_b128 v[120:123], v11 offset:5120
    v_mfma_f32_16x16x32_bf16 a[104:107], v[72:75], v[40:43], a[104:107]
    ds_read_b128 v[124:127], v11 offset:6144
    v_mfma_f32_16x16x32_bf16 a[108:111], v[72:75], v[44:47], a[108:111]
    ds_read_b128 v[128:131], v11 offset:7168
    v_mfma_f32_16x16x32_bf16 a[112:115], v[76:79], v[32:35], a[112:115]
    ds_read_b128 v[132:135], v11 offset:8192
    v_mfma_f32_16x16x32_bf16 a[116:119], v[76:79], v[36:39], a[116:119]
    v_mfma_f32_16x16x32_bf16 a[120:123], v[76:79], v[40:43], a[120:123]
    v_mfma_f32_16x16x32_bf16 a[124:127], v[76:79], v[44:47], a[124:127]
    v_mfma_f32_16x16x32_bf16 a[128:131], v[80:83], v[32:35], a[128:131]
    v_mfma_f32_16x16x32_bf16 a[132:135], v[80:83], v[36:39], a[132:135]
    v_mfma_f32_16x16x32_bf16 a[136:139], v[80:83], v[40:43], a[136:139]
    v_mfma_f32_16x16x32_bf16 a[140:143], v[80:83], v[44:47], a[140:143]
    s_waitcnt vmcnt(21) lgkmcnt(0)
    s_barrier
    v_mfma_f32_16x16x32_bf16 a[0:3], v[84:87], v[100:103], a[0:3]
    s_mov_b32 s48, 12288
    v_mfma_f32_16x16x32_bf16 a[4:7], v[88:91], v[100:103], a[4:7]
    s_add_u32 m0, s44, 53248
    v_mfma_f32_16x16x32_bf16 a[8:11], v[92:95], v[100:103], a[8:11]
    s_mov_b32 s49, 28672
    v_mfma_f32_16x16x32_bf16 a[12:15], v[96:99], v[100:103], a[12:15]
    buffer_load_dwordx4 v4, s[12:15], s48 offen lds
    v_mfma_f32_16x16x32_bf16 a[16:19], v[84:87], v[104:107], a[16:19]
    s_add_u32 m0, s44, 54272
    v_mfma_f32_16x16x32_bf16 a[20:23], v[88:91], v[104:107], a[20:23]
    s_mov_b32 s50, 221184
    v_mfma_f32_16x16x32_bf16 a[24:27], v[92:95], v[104:107], a[24:27]
    buffer_load_dwordx4 v4, s[12:15], s49 offen lds
    v_mfma_f32_16x16x32_bf16 a[28:31], v[96:99], v[104:107], a[28:31]
    s_add_u32 m0, s45, 53248
    v_mfma_f32_16x16x32_bf16 a[32:35], v[84:87], v[108:111], a[32:35]
    s_nop 0
    v_mfma_f32_16x16x32_bf16 a[36:39], v[88:91], v[108:111], a[36:39]
    buffer_load_dwordx4 v5, s[16:19], s50 offen offset:0 lds
    v_mfma_f32_16x16x32_bf16 a[40:43], v[92:95], v[108:111], a[40:43]
    buffer_load_dwordx4 v5, s[16:19], s50 offen offset:1024 lds
    v_mfma_f32_16x16x32_bf16 a[44:47], v[96:99], v[108:111], a[44:47]
    buffer_load_dwordx4 v5, s[16:19], s50 offen offset:2048 lds
    v_mfma_f32_16x16x32_bf16 a[48:51], v[84:87], v[112:115], a[48:51]
    buffer_load_dwordx4 v5, s[16:19], s50 offen offset:3072 lds
    v_mfma_f32_16x16x32_bf16 a[52:55], v[88:91], v[112:115], a[52:55]
    s_add_u32 m0, s46, 53248
    v_mfma_f32_16x16x32_bf16 a[56:59], v[92:95], v[112:115], a[56:59]
    s_nop 0
    v_mfma_f32_16x16x32_bf16 a[60:63], v[96:99], v[112:115], a[60:63]
    buffer_load_dwordx4 v6, s[16:19], s50 offen lds
    v_mfma_f32_16x16x32_bf16 a[64:67], v[116:119], v[84:87], a[64:67]
    ds_read_b128 v[32:35], v8 offset:26624
    v_mfma_f32_16x16x32_bf16 a[68:71], v[116:119], v[88:91], a[68:71]
    ds_read_b128 v[48:51], v11 offset:26624
    v_mfma_f32_16x16x32_bf16 a[72:75], v[116:119], v[92:95], a[72:75]
    ds_read_b128 v[36:39], v8 offset:27648
    v_mfma_f32_16x16x32_bf16 a[76:79], v[116:119], v[96:99], a[76:79]
    ds_read_b128 v[52:55], v11 offset:27648
    v_mfma_f32_16x16x32_bf16 a[80:83], v[120:123], v[84:87], a[80:83]
    ds_read_b128 v[40:43], v8 offset:28672
    v_mfma_f32_16x16x32_bf16 a[84:87], v[120:123], v[88:91], a[84:87]
    ds_read_b128 v[56:59], v11 offset:28672
    v_mfma_f32_16x16x32_bf16 a[88:91], v[120:123], v[92:95], a[88:91]
    ds_read_b128 v[44:47], v8 offset:29696
    v_mfma_f32_16x16x32_bf16 a[92:95], v[120:123], v[96:99], a[92:95]
    ds_read_b128 v[60:63], v11 offset:29696
    v_mfma_f32_16x16x32_bf16 a[96:99], v[124:127], v[84:87], a[96:99]
    ds_read_b128 v[64:67], v11 offset:30720
    v_mfma_f32_16x16x32_bf16 a[100:103], v[124:127], v[88:91], a[100:103]
    ds_read_b128 v[68:71], v11 offset:31744
    v_mfma_f32_16x16x32_bf16 a[104:107], v[124:127], v[92:95], a[104:107]
    ds_read_b128 v[72:75], v11 offset:32768
    v_mfma_f32_16x16x32_bf16 a[108:111], v[124:127], v[96:99], a[108:111]
    ds_read_b128 v[76:79], v11 offset:33792
    v_mfma_f32_16x16x32_bf16 a[112:115], v[128:131], v[84:87], a[112:115]
    ds_read_b128 v[80:83], v11 offset:34816
    v_mfma_f32_16x16x32_bf16 a[116:119], v[128:131], v[88:91], a[116:119]
    v_mfma_f32_16x16x32_bf16 a[120:123], v[128:131], v[92:95], a[120:123]
    v_mfma_f32_16x16x32_bf16 a[124:127], v[128:131], v[96:99], a[124:127]
    v_mfma_f32_16x16x32_bf16 a[128:131], v[132:135], v[84:87], a[128:131]
    v_mfma_f32_16x16x32_bf16 a[132:135], v[132:135], v[88:91], a[132:135]
    v_mfma_f32_16x16x32_bf16 a[136:139], v[132:135], v[92:95], a[136:139]
    v_mfma_f32_16x16x32_bf16 a[140:143], v[132:135], v[96:99], a[140:143]
    s_waitcnt vmcnt(21) lgkmcnt(0)
    s_barrier
    v_mfma_f32_16x16x32_bf16 a[0:3], v[32:35], v[48:51], a[0:3]
    s_mov_b32 s48, 13312
    v_mfma_f32_16x16x32_bf16 a[4:7], v[36:39], v[48:51], a[4:7]
    s_add_u32 m0, s44, 79872
    v_mfma_f32_16x16x32_bf16 a[8:11], v[40:43], v[48:51], a[8:11]
    s_mov_b32 s49, 29696
    v_mfma_f32_16x16x32_bf16 a[12:15], v[44:47], v[48:51], a[12:15]
    buffer_load_dwordx4 v4, s[12:15], s48 offen lds
    v_mfma_f32_16x16x32_bf16 a[16:19], v[32:35], v[52:55], a[16:19]
    s_add_u32 m0, s44, 80896
    v_mfma_f32_16x16x32_bf16 a[20:23], v[36:39], v[52:55], a[20:23]
    s_mov_b32 s50, 239616
    v_mfma_f32_16x16x32_bf16 a[24:27], v[40:43], v[52:55], a[24:27]
    buffer_load_dwordx4 v4, s[12:15], s49 offen lds
    v_mfma_f32_16x16x32_bf16 a[28:31], v[44:47], v[52:55], a[28:31]
    s_add_u32 m0, s45, 79872
    v_mfma_f32_16x16x32_bf16 a[32:35], v[32:35], v[56:59], a[32:35]
    s_nop 0
    v_mfma_f32_16x16x32_bf16 a[36:39], v[36:39], v[56:59], a[36:39]
    buffer_load_dwordx4 v5, s[16:19], s50 offen offset:0 lds
    v_mfma_f32_16x16x32_bf16 a[40:43], v[40:43], v[56:59], a[40:43]
    buffer_load_dwordx4 v5, s[16:19], s50 offen offset:1024 lds
    v_mfma_f32_16x16x32_bf16 a[44:47], v[44:47], v[56:59], a[44:47]
    buffer_load_dwordx4 v5, s[16:19], s50 offen offset:2048 lds
    v_mfma_f32_16x16x32_bf16 a[48:51], v[32:35], v[60:63], a[48:51]
    buffer_load_dwordx4 v5, s[16:19], s50 offen offset:3072 lds
    v_mfma_f32_16x16x32_bf16 a[52:55], v[36:39], v[60:63], a[52:55]
    s_add_u32 m0, s46, 79872
    v_mfma_f32_16x16x32_bf16 a[56:59], v[40:43], v[60:63], a[56:59]
    s_nop 0
    v_mfma_f32_16x16x32_bf16 a[60:63], v[44:47], v[60:63], a[60:63]
    buffer_load_dwordx4 v6, s[16:19], s50 offen lds
    v_mfma_f32_16x16x32_bf16 a[64:67], v[64:67], v[32:35], a[64:67]
    ds_read_b128 v[84:87], v9 offset:0
    v_mfma_f32_16x16x32_bf16 a[68:71], v[64:67], v[36:39], a[68:71]
    ds_read_b128 v[100:103], v12 offset:0
    v_mfma_f32_16x16x32_bf16 a[72:75], v[64:67], v[40:43], a[72:75]
    ds_read_b128 v[88:91], v9 offset:1024
    v_mfma_f32_16x16x32_bf16 a[76:79], v[64:67], v[44:47], a[76:79]
    ds_read_b128 v[104:107], v12 offset:1024
    v_mfma_f32_16x16x32_bf16 a[80:83], v[68:71], v[32:35], a[80:83]
    ds_read_b128 v[92:95], v9 offset:2048
    v_mfma_f32_16x16x32_bf16 a[84:87], v[68:71], v[36:39], a[84:87]
    ds_read_b128 v[108:111], v12 offset:2048
    v_mfma_f32_16x16x32_bf16 a[88:91], v[68:71], v[40:43], a[88:91]
    ds_read_b128 v[96:99], v9 offset:3072
    v_mfma_f32_16x16x32_bf16 a[92:95], v[68:71], v[44:47], a[92:95]
    ds_read_b128 v[112:115], v12 offset:3072
    v_mfma_f32_16x16x32_bf16 a[96:99], v[72:75], v[32:35], a[96:99]
    ds_read_b128 v[116:119], v12 offset:4096
    v_mfma_f32_16x16x32_bf16 a[100:103], v[72:75], v[36:39], a[100:103]
    ds_read_b128 v[120:123], v12 offset:5120
    v_mfma_f32_16x16x32_bf16 a[104:107], v[72:75], v[40:43], a[104:107]
    ds_read_b128 v[124:127], v12 offset:6144
    v_mfma_f32_16x16x32_bf16 a[108:111], v[72:75], v[44:47], a[108:111]
    ds_read_b128 v[128:131], v12 offset:7168
    v_mfma_f32_16x16x32_bf16 a[112:115], v[76:79], v[32:35], a[112:115]
    ds_read_b128 v[132:135], v12 offset:8192
    v_mfma_f32_16x16x32_bf16 a[116:119], v[76:79], v[36:39], a[116:119]
    v_mfma_f32_16x16x32_bf16 a[120:123], v[76:79], v[40:43], a[120:123]
    v_mfma_f32_16x16x32_bf16 a[124:127], v[76:79], v[44:47], a[124:127]
    v_mfma_f32_16x16x32_bf16 a[128:131], v[80:83], v[32:35], a[128:131]
    v_mfma_f32_16x16x32_bf16 a[132:135], v[80:83], v[36:39], a[132:135]
    v_mfma_f32_16x16x32_bf16 a[136:139], v[80:83], v[40:43], a[136:139]
    v_mfma_f32_16x16x32_bf16 a[140:143], v[80:83], v[44:47], a[140:143]
    s_waitcnt vmcnt(21) lgkmcnt(0)
    s_barrier
    v_mfma_f32_16x16x32_bf16 a[0:3], v[84:87], v[100:103], a[0:3]
    s_mov_b32 s48, 14336
    v_mfma_f32_16x16x32_bf16 a[4:7], v[88:91], v[100:103], a[4:7]
    s_add_u32 m0, s44, 106496
    v_mfma_f32_16x16x32_bf16 a[8:11], v[92:95], v[100:103], a[8:11]
    s_mov_b32 s49, 30720
    v_mfma_f32_16x16x32_bf16 a[12:15], v[96:99], v[100:103], a[12:15]
    buffer_load_dwordx4 v4, s[12:15], s48 offen lds
    v_mfma_f32_16x16x32_bf16 a[16:19], v[84:87], v[104:107], a[16:19]
    s_add_u32 m0, s44, 107520
    v_mfma_f32_16x16x32_bf16 a[20:23], v[88:91], v[104:107], a[20:23]
    s_mov_b32 s50, 258048
    v_mfma_f32_16x16x32_bf16 a[24:27], v[92:95], v[104:107], a[24:27]
    buffer_load_dwordx4 v4, s[12:15], s49 offen lds
    v_mfma_f32_16x16x32_bf16 a[28:31], v[96:99], v[104:107], a[28:31]
    s_add_u32 m0, s45, 106496
    v_mfma_f32_16x16x32_bf16 a[32:35], v[84:87], v[108:111], a[32:35]
    s_nop 0
    v_mfma_f32_16x16x32_bf16 a[36:39], v[88:91], v[108:111], a[36:39]
    buffer_load_dwordx4 v5, s[16:19], s50 offen offset:0 lds
    v_mfma_f32_16x16x32_bf16 a[40:43], v[92:95], v[108:111], a[40:43]
    buffer_load_dwordx4 v5, s[16:19], s50 offen offset:1024 lds
    v_mfma_f32_16x16x32_bf16 a[44:47], v[96:99], v[108:111], a[44:47]
    buffer_load_dwordx4 v5, s[16:19], s50 offen offset:2048 lds
    v_mfma_f32_16x16x32_bf16 a[48:51], v[84:87], v[112:115], a[48:51]
    buffer_load_dwordx4 v5, s[16:19], s50 offen offset:3072 lds
    v_mfma_f32_16x16x32_bf16 a[52:55], v[88:91], v[112:115], a[52:55]
    s_add_u32 m0, s46, 106496
    v_mfma_f32_16x16x32_bf16 a[56:59], v[92:95], v[112:115], a[56:59]
    s_nop 0
    v_mfma_f32_16x16x32_bf16 a[60:63], v[96:99], v[112:115], a[60:63]
    buffer_load_dwordx4 v6, s[16:19], s50 offen lds
    v_mfma_f32_16x16x32_bf16 a[64:67], v[116:119], v[84:87], a[64:67]
    ds_read_b128 v[32:35], v7 offset:0
    v_mfma_f32_16x16x32_bf16 a[68:71], v[116:119], v[88:91], a[68:71]
    ds_read_b128 v[48:51], v10 offset:0
    v_mfma_f32_16x16x32_bf16 a[72:75], v[116:119], v[92:95], a[72:75]
    ds_read_b128 v[36:39], v7 offset:1024
    v_mfma_f32_16x16x32_bf16 a[76:79], v[116:119], v[96:99], a[76:79]
    ds_read_b128 v[52:55], v10 offset:1024
    v_mfma_f32_16x16x32_bf16 a[80:83], v[120:123], v[84:87], a[80:83]
    ds_read_b128 v[40:43], v7 offset:2048
    v_mfma_f32_16x16x32_bf16 a[84:87], v[120:123], v[88:91], a[84:87]
    ds_read_b128 v[56:59], v10 offset:2048
    v_mfma_f32_16x16x32_bf16 a[88:91], v[120:123], v[92:95], a[88:91]
    ds_read_b128 v[44:47], v7 offset:3072
    v_mfma_f32_16x16x32_bf16 a[92:95], v[120:123], v[96:99], a[92:95]
    ds_read_b128 v[60:63], v10 offset:3072
    v_mfma_f32_16x16x32_bf16 a[96:99], v[124:127], v[84:87], a[96:99]
    ds_read_b128 v[64:67], v10 offset:4096
    v_mfma_f32_16x16x32_bf16 a[100:103], v[124:127], v[88:91], a[100:103]
    ds_read_b128 v[68:71], v10 offset:5120
    v_mfma_f32_16x16x32_bf16 a[104:107], v[124:127], v[92:95], a[104:107]
    ds_read_b128 v[72:75], v10 offset:6144
    v_mfma_f32_16x16x32_bf16 a[108:111], v[124:127], v[96:99], a[108:111]
    ds_read_b128 v[76:79], v10 offset:7168
    v_mfma_f32_16x16x32_bf16 a[112:115], v[128:131], v[84:87], a[112:115]
    ds_read_b128 v[80:83], v10 offset:8192
    v_mfma_f32_16x16x32_bf16 a[116:119], v[128:131], v[88:91], a[116:119]
    v_mfma_f32_16x16x32_bf16 a[120:123], v[128:131], v[92:95], a[120:123]
    v_mfma_f32_16x16x32_bf16 a[124:127], v[128:131], v[96:99], a[124:127]
    v_mfma_f32_16x16x32_bf16 a[128:131], v[132:135], v[84:87], a[128:131]
    v_mfma_f32_16x16x32_bf16 a[132:135], v[132:135], v[88:91], a[132:135]
    v_mfma_f32_16x16x32_bf16 a[136:139], v[132:135], v[92:95], a[136:139]
    v_mfma_f32_16x16x32_bf16 a[140:143], v[132:135], v[96:99], a[140:143]
    s_waitcnt vmcnt(21) lgkmcnt(0)
    s_barrier
    v_mfma_f32_16x16x32_bf16 a[0:3], v[32:35], v[48:51], a[0:3]
    s_mov_b32 s48, 15360
    v_mfma_f32_16x16x32_bf16 a[4:7], v[36:39], v[48:51], a[4:7]
    s_add_u32 m0, s44, 0
    v_mfma_f32_16x16x32_bf16 a[8:11], v[40:43], v[48:51], a[8:11]
    s_mov_b32 s49, 31744
    v_mfma_f32_16x16x32_bf16 a[12:15], v[44:47], v[48:51], a[12:15]
    buffer_load_dwordx4 v4, s[12:15], s48 offen lds
    v_mfma_f32_16x16x32_bf16 a[16:19], v[32:35], v[52:55], a[16:19]
    s_add_u32 m0, s44, 1024
    v_mfma_f32_16x16x32_bf16 a[20:23], v[36:39], v[52:55], a[20:23]
    s_mov_b32 s50, 276480
    v_mfma_f32_16x16x32_bf16 a[24:27], v[40:43], v[52:55], a[24:27]
    buffer_load_dwordx4 v4, s[12:15], s49 offen lds
    v_mfma_f32_16x16x32_bf16 a[28:31], v[44:47], v[52:55], a[28:31]
    s_add_u32 m0, s45, 0
    v_mfma_f32_16x16x32_bf16 a[32:35], v[32:35], v[56:59], a[32:35]
    s_nop 0
    v_mfma_f32_16x16x32_bf16 a[36:39], v[36:39], v[56:59], a[36:39]
    buffer_load_dwordx4 v5, s[16:19], s50 offen offset:0 lds
    v_mfma_f32_16x16x32_bf16 a[40:43], v[40:43], v[56:59], a[40:43]
    buffer_load_dwordx4 v5, s[16:19], s50 offen offset:1024 lds
    v_mfma_f32_16x16x32_bf16 a[44:47], v[44:47], v[56:59], a[44:47]
    buffer_load_dwordx4 v5, s[16:19], s50 offen offset:2048 lds
    v_mfma_f32_16x16x32_bf16 a[48:51], v[32:35], v[60:63], a[48:51]
    buffer_load_dwordx4 v5, s[16:19], s50 offen offset:3072 lds
    v_mfma_f32_16x16x32_bf16 a[52:55], v[36:39], v[60:63], a[52:55]
    s_add_u32 m0, s46, 0
    v_mfma_f32_16x16x32_bf16 a[56:59], v[40:43], v[60:63], a[56:59]
    s_nop 0
    v_mfma_f32_16x16x32_bf16 a[60:63], v[44:47], v[60:63], a[60:63]
    buffer_load_dwordx4 v6, s[16:19], s50 offen lds
    v_mfma_f32_16x16x32_bf16 a[64:67], v[64:67], v[32:35], a[64:67]
    ds_read_b128 v[84:87], v7 offset:26624
    v_mfma_f32_16x16x32_bf16 a[68:71], v[64:67], v[36:39], a[68:71]
    ds_read_b128 v[100:103], v10 offset:26624
    v_mfma_f32_16x16x32_bf16 a[72:75], v[64:67], v[40:43], a[72:75]
    ds_read_b128 v[88:91], v7 offset:27648
    v_mfma_f32_16x16x32_bf16 a[76:79], v[64:67], v[44:47], a[76:79]
    ds_read_b128 v[104:107], v10 offset:27648
    v_mfma_f32_16x16x32_bf16 a[80:83], v[68:71], v[32:35], a[80:83]
    ds_read_b128 v[92:95], v7 offset:28672
    v_mfma_f32_16x16x32_bf16 a[84:87], v[68:71], v[36:39], a[84:87]
    ds_read_b128 v[108:111], v10 offset:28672
    v_mfma_f32_16x16x32_bf16 a[88:91], v[68:71], v[40:43], a[88:91]
    ds_read_b128 v[96:99], v7 offset:29696
    v_mfma_f32_16x16x32_bf16 a[92:95], v[68:71], v[44:47], a[92:95]
    ds_read_b128 v[112:115], v10 offset:29696
    v_mfma_f32_16x16x32_bf16 a[96:99], v[72:75], v[32:35], a[96:99]
    ds_read_b128 v[116:119], v10 offset:30720
    v_mfma_f32_16x16x32_bf16 a[100:103], v[72:75], v[36:39], a[100:103]
    ds_read_b128 v[120:123], v10 offset:31744
    v_mfma_f32_16x16x32_bf16 a[104:107], v[72:75], v[40:43], a[104:107]
    ds_read_b128 v[124:127], v10 offset:32768
    v_mfma_f32_16x16x32_bf16 a[108:111], v[72:75], v[44:47], a[108:111]
    ds_read_b128 v[128:131], v10 offset:33792
    v_mfma_f32_16x16x32_bf16 a[112:115], v[76:79], v[32:35], a[112:115]
    ds_read_b128 v[132:135], v10 offset:34816
    v_mfma_f32_16x16x32_bf16 a[116:119], v[76:79], v[36:39], a[116:119]
    v_mfma_f32_16x16x32_bf16 a[120:123], v[76:79], v[40:43], a[120:123]
    v_mfma_f32_16x16x32_bf16 a[124:127], v[76:79], v[44:47], a[124:127]
    v_mfma_f32_16x16x32_bf16 a[128:131], v[80:83], v[32:35], a[128:131]
    v_mfma_f32_16x16x32_bf16 a[132:135], v[80:83], v[36:39], a[132:135]
    v_mfma_f32_16x16x32_bf16 a[136:139], v[80:83], v[40:43], a[136:139]
    v_mfma_f32_16x16x32_bf16 a[140:143], v[80:83], v[44:47], a[140:143]
    s_waitcnt vmcnt(21) lgkmcnt(0)
    s_barrier
    v_mfma_f32_16x16x32_bf16 a[0:3], v[84:87], v[100:103], a[0:3]
    ds_read_b128 v[32:35], v8 offset:0
    v_mfma_f32_16x16x32_bf16 a[4:7], v[88:91], v[100:103], a[4:7]
    ds_read_b128 v[48:51], v11 offset:0
    v_mfma_f32_16x16x32_bf16 a[8:11], v[92:95], v[100:103], a[8:11]
    ds_read_b128 v[36:39], v8 offset:1024
    v_mfma_f32_16x16x32_bf16 a[12:15], v[96:99], v[100:103], a[12:15]
    ds_read_b128 v[52:55], v11 offset:1024
    v_mfma_f32_16x16x32_bf16 a[16:19], v[84:87], v[104:107], a[16:19]
    ds_read_b128 v[40:43], v8 offset:2048
    v_mfma_f32_16x16x32_bf16 a[20:23], v[88:91], v[104:107], a[20:23]
    ds_read_b128 v[56:59], v11 offset:2048
    v_mfma_f32_16x16x32_bf16 a[24:27], v[92:95], v[104:107], a[24:27]
    ds_read_b128 v[44:47], v8 offset:3072
    v_mfma_f32_16x16x32_bf16 a[28:31], v[96:99], v[104:107], a[28:31]
    ds_read_b128 v[60:63], v11 offset:3072
    v_mfma_f32_16x16x32_bf16 a[32:35], v[84:87], v[108:111], a[32:35]
    ds_read_b128 v[64:67], v11 offset:4096
    v_mfma_f32_16x16x32_bf16 a[36:39], v[88:91], v[108:111], a[36:39]
    ds_read_b128 v[68:71], v11 offset:5120
    v_mfma_f32_16x16x32_bf16 a[40:43], v[92:95], v[108:111], a[40:43]
    ds_read_b128 v[72:75], v11 offset:6144
    v_mfma_f32_16x16x32_bf16 a[44:47], v[96:99], v[108:111], a[44:47]
    ds_read_b128 v[76:79], v11 offset:7168
    v_mfma_f32_16x16x32_bf16 a[48:51], v[84:87], v[112:115], a[48:51]
    ds_read_b128 v[80:83], v11 offset:8192
    v_mfma_f32_16x16x32_bf16 a[52:55], v[88:91], v[112:115], a[52:55]
    v_mfma_f32_16x16x32_bf16 a[56:59], v[92:95], v[112:115], a[56:59]
    v_mfma_f32_16x16x32_bf16 a[60:63], v[96:99], v[112:115], a[60:63]
    v_mfma_f32_16x16x32_bf16 a[64:67], v[116:119], v[84:87], a[64:67]
    v_mfma_f32_16x16x32_bf16 a[68:71], v[116:119], v[88:91], a[68:71]
    v_mfma_f32_16x16x32_bf16 a[72:75], v[116:119], v[92:95], a[72:75]
    v_mfma_f32_16x16x32_bf16 a[76:79], v[116:119], v[96:99], a[76:79]
    v_mfma_f32_16x16x32_bf16 a[80:83], v[120:123], v[84:87], a[80:83]
    v_mfma_f32_16x16x32_bf16 a[84:87], v[120:123], v[88:91], a[84:87]
    v_mfma_f32_16x16x32_bf16 a[88:91], v[120:123], v[92:95], a[88:91]
    v_mfma_f32_16x16x32_bf16 a[92:95], v[120:123], v[96:99], a[92:95]
    v_mfma_f32_16x16x32_bf16 a[96:99], v[124:127], v[84:87], a[96:99]
    v_mfma_f32_16x16x32_bf16 a[100:103], v[124:127], v[88:91], a[100:103]
    v_mfma_f32_16x16x32_bf16 a[104:107], v[124:127], v[92:95], a[104:107]
    v_mfma_f32_16x16x32_bf16 a[108:111], v[124:127], v[96:99], a[108:111]
    v_mfma_f32_16x16x32_bf16 a[112:115], v[128:131], v[84:87], a[112:115]
    v_mfma_f32_16x16x32_bf16 a[116:119], v[128:131], v[88:91], a[116:119]
    v_mfma_f32_16x16x32_bf16 a[120:123], v[128:131], v[92:95], a[120:123]
    v_mfma_f32_16x16x32_bf16 a[124:127], v[128:131], v[96:99], a[124:127]
    v_mfma_f32_16x16x32_bf16 a[128:131], v[132:135], v[84:87], a[128:131]
    v_mfma_f32_16x16x32_bf16 a[132:135], v[132:135], v[88:91], a[132:135]
    v_mfma_f32_16x16x32_bf16 a[136:139], v[132:135], v[92:95], a[136:139]
    v_mfma_f32_16x16x32_bf16 a[140:143], v[132:135], v[96:99], a[140:143]
    s_waitcnt vmcnt(14) lgkmcnt(0)
    s_barrier
    v_mfma_f32_16x16x32_bf16 a[0:3], v[32:35], v[48:51], a[0:3]
    ds_read_b128 v[84:87], v8 offset:26624
    v_mfma_f32_16x16x32_bf16 a[4:7], v[36:39], v[48:51], a[4:7]
    ds_read_b128 v[100:103], v11 offset:26624
    v_mfma_f32_16x16x32_bf16 a[8:11], v[40:43], v[48:51], a[8:11]
    ds_read_b128 v[88:91], v8 offset:27648
    v_mfma_f32_16x16x32_bf16 a[12:15], v[44:47], v[48:51], a[12:15]
    ds_read_b128 v[104:107], v11 offset:27648
    v_mfma_f32_16x16x32_bf16 a[16:19], v[32:35], v[52:55], a[16:19]
    ds_read_b128 v[92:95], v8 offset:28672
    v_mfma_f32_16x16x32_bf16 a[20:23], v[36:39], v[52:55], a[20:23]
    ds_read_b128 v[108:111], v11 offset:28672
    v_mfma_f32_16x16x32_bf16 a[24:27], v[40:43], v[52:55], a[24:27]
    ds_read_b128 v[96:99], v8 offset:29696
    v_mfma_f32_16x16x32_bf16 a[28:31], v[44:47], v[52:55], a[28:31]
    ds_read_b128 v[112:115], v11 offset:29696
    v_mfma_f32_16x16x32_bf16 a[32:35], v[32:35], v[56:59], a[32:35]
    ds_read_b128 v[116:119], v11 offset:30720
    v_mfma_f32_16x16x32_bf16 a[36:39], v[36:39], v[56:59], a[36:39]
    ds_read_b128 v[120:123], v11 offset:31744
    v_mfma_f32_16x16x32_bf16 a[40:43], v[40:43], v[56:59], a[40:43]
    ds_read_b128 v[124:127], v11 offset:32768
    v_mfma_f32_16x16x32_bf16 a[44:47], v[44:47], v[56:59], a[44:47]
    ds_read_b128 v[128:131], v11 offset:33792
    v_mfma_f32_16x16x32_bf16 a[48:51], v[32:35], v[60:63], a[48:51]
    ds_read_b128 v[132:135], v11 offset:34816
    v_mfma_f32_16x16x32_bf16 a[52:55], v[36:39], v[60:63], a[52:55]
    v_mfma_f32_16x16x32_bf16 a[56:59], v[40:43], v[60:63], a[56:59]
    v_mfma_f32_16x16x32_bf16 a[60:63], v[44:47], v[60:63], a[60:63]
    v_mfma_f32_16x16x32_bf16 a[64:67], v[64:67], v[32:35], a[64:67]
    v_mfma_f32_16x16x32_bf16 a[68:71], v[64:67], v[36:39], a[68:71]
    v_mfma_f32_16x16x32_bf16 a[72:75], v[64:67], v[40:43], a[72:75]
    v_mfma_f32_16x16x32_bf16 a[76:79], v[64:67], v[44:47], a[76:79]
    v_mfma_f32_16x16x32_bf16 a[80:83], v[68:71], v[32:35], a[80:83]
    v_mfma_f32_16x16x32_bf16 a[84:87], v[68:71], v[36:39], a[84:87]
    v_mfma_f32_16x16x32_bf16 a[88:91], v[68:71], v[40:43], a[88:91]
    v_mfma_f32_16x16x32_bf16 a[92:95], v[68:71], v[44:47], a[92:95]
    v_mfma_f32_16x16x32_bf16 a[96:99], v[72:75], v[32:35], a[96:99]
    v_mfma_f32_16x16x32_bf16 a[100:103], v[72:75], v[36:39], a[100:103]
    v_mfma_f32_16x16x32_bf16 a[104:107], v[72:75], v[40:43], a[104:107]
    v_mfma_f32_16x16x32_bf16 a[108:111], v[72:75], v[44:47], a[108:111]
    v_mfma_f32_16x16x32_bf16 a[112:115], v[76:79], v[32:35], a[112:115]
    v_mfma_f32_16x16x32_bf16 a[116:119], v[76:79], v[36:39], a[116:119]
    v_mfma_f32_16x16x32_bf16 a[120:123], v[76:79], v[40:43], a[120:123]
    v_mfma_f32_16x16x32_bf16 a[124:127], v[76:79], v[44:47], a[124:127]
    v_mfma_f32_16x16x32_bf16 a[128:131], v[80:83], v[32:35], a[128:131]
    v_mfma_f32_16x16x32_bf16 a[132:135], v[80:83], v[36:39], a[132:135]
    v_mfma_f32_16x16x32_bf16 a[136:139], v[80:83], v[40:43], a[136:139]
    v_mfma_f32_16x16x32_bf16 a[140:143], v[80:83], v[44:47], a[140:143]
    s_waitcnt vmcnt(7) lgkmcnt(0)
    s_barrier
    v_mfma_f32_16x16x32_bf16 a[0:3], v[84:87], v[100:103], a[0:3]
    ds_read_b128 v[32:35], v9 offset:0
    v_mfma_f32_16x16x32_bf16 a[4:7], v[88:91], v[100:103], a[4:7]
    ds_read_b128 v[48:51], v12 offset:0
    v_mfma_f32_16x16x32_bf16 a[8:11], v[92:95], v[100:103], a[8:11]
    ds_read_b128 v[36:39], v9 offset:1024
    v_mfma_f32_16x16x32_bf16 a[12:15], v[96:99], v[100:103], a[12:15]
    ds_read_b128 v[52:55], v12 offset:1024
    v_mfma_f32_16x16x32_bf16 a[16:19], v[84:87], v[104:107], a[16:19]
    ds_read_b128 v[40:43], v9 offset:2048
    v_mfma_f32_16x16x32_bf16 a[20:23], v[88:91], v[104:107], a[20:23]
    ds_read_b128 v[56:59], v12 offset:2048
    v_mfma_f32_16x16x32_bf16 a[24:27], v[92:95], v[104:107], a[24:27]
    ds_read_b128 v[44:47], v9 offset:3072
    v_mfma_f32_16x16x32_bf16 a[28:31], v[96:99], v[104:107], a[28:31]
    ds_read_b128 v[60:63], v12 offset:3072
    v_mfma_f32_16x16x32_bf16 a[32:35], v[84:87], v[108:111], a[32:35]
    ds_read_b128 v[64:67], v12 offset:4096
    v_mfma_f32_16x16x32_bf16 a[36:39], v[88:91], v[108:111], a[36:39]
    ds_read_b128 v[68:71], v12 offset:5120
    v_mfma_f32_16x16x32_bf16 a[40:43], v[92:95], v[108:111], a[40:43]
    ds_read_b128 v[72:75], v12 offset:6144
    v_mfma_f32_16x16x32_bf16 a[44:47], v[96:99], v[108:111], a[44:47]
    ds_read_b128 v[76:79], v12 offset:7168
    v_mfma_f32_16x16x32_bf16 a[48:51], v[84:87], v[112:115], a[48:51]
    ds_read_b128 v[80:83], v12 offset:8192
    v_mfma_f32_16x16x32_bf16 a[52:55], v[88:91], v[112:115], a[52:55]
    v_mfma_f32_16x16x32_bf16 a[56:59], v[92:95], v[112:115], a[56:59]
    v_mfma_f32_16x16x32_bf16 a[60:63], v[96:99], v[112:115], a[60:63]
    v_mfma_f32_16x16x32_bf16 a[64:67], v[116:119], v[84:87], a[64:67]
    v_mfma_f32_16x16x32_bf16 a[68:71], v[116:119], v[88:91], a[68:71]
    v_mfma_f32_16x16x32_bf16 a[72:75], v[116:119], v[92:95], a[72:75]
    v_mfma_f32_16x16x32_bf16 a[76:79], v[116:119], v[96:99], a[76:79]
    v_mfma_f32_16x16x32_bf16 a[80:83], v[120:123], v[84:87], a[80:83]
    v_mfma_f32_16x16x32_bf16 a[84:87], v[120:123], v[88:91], a[84:87]
    v_mfma_f32_16x16x32_bf16 a[88:91], v[120:123], v[92:95], a[88:91]
    v_mfma_f32_16x16x32_bf16 a[92:95], v[120:123], v[96:99], a[92:95]
    v_mfma_f32_16x16x32_bf16 a[96:99], v[124:127], v[84:87], a[96:99]
    v_mfma_f32_16x16x32_bf16 a[100:103], v[124:127], v[88:91], a[100:103]
    v_mfma_f32_16x16x32_bf16 a[104:107], v[124:127], v[92:95], a[104:107]
    v_mfma_f32_16x16x32_bf16 a[108:111], v[124:127], v[96:99], a[108:111]
    v_mfma_f32_16x16x32_bf16 a[112:115], v[128:131], v[84:87], a[112:115]
    v_mfma_f32_16x16x32_bf16 a[116:119], v[128:131], v[88:91], a[116:119]
    v_mfma_f32_16x16x32_bf16 a[120:123], v[128:131], v[92:95], a[120:123]
    v_mfma_f32_16x16x32_bf16 a[124:127], v[128:131], v[96:99], a[124:127]
    v_mfma_f32_16x16x32_bf16 a[128:131], v[132:135], v[84:87], a[128:131]
    v_mfma_f32_16x16x32_bf16 a[132:135], v[132:135], v[88:91], a[132:135]
    v_mfma_f32_16x16x32_bf16 a[136:139], v[132:135], v[92:95], a[136:139]
    v_mfma_f32_16x16x32_bf16 a[140:143], v[132:135], v[96:99], a[140:143]
    s_waitcnt vmcnt(0) lgkmcnt(0)
    s_barrier
    v_mfma_f32_16x16x32_bf16 a[0:3], v[32:35], v[48:51], a[0:3]
    ds_read_b128 v[84:87], v7 offset:0
    v_mfma_f32_16x16x32_bf16 a[4:7], v[36:39], v[48:51], a[4:7]
    ds_read_b128 v[100:103], v10 offset:0
    v_mfma_f32_16x16x32_bf16 a[8:11], v[40:43], v[48:51], a[8:11]
    ds_read_b128 v[88:91], v7 offset:1024
    v_mfma_f32_16x16x32_bf16 a[12:15], v[44:47], v[48:51], a[12:15]
    ds_read_b128 v[104:107], v10 offset:1024
    v_mfma_f32_16x16x32_bf16 a[16:19], v[32:35], v[52:55], a[16:19]
    ds_read_b128 v[92:95], v7 offset:2048
    v_mfma_f32_16x16x32_bf16 a[20:23], v[36:39], v[52:55], a[20:23]
    ds_read_b128 v[108:111], v10 offset:2048
    v_mfma_f32_16x16x32_bf16 a[24:27], v[40:43], v[52:55], a[24:27]
    ds_read_b128 v[96:99], v7 offset:3072
    v_mfma_f32_16x16x32_bf16 a[28:31], v[44:47], v[52:55], a[28:31]
    ds_read_b128 v[112:115], v10 offset:3072
    v_mfma_f32_16x16x32_bf16 a[32:35], v[32:35], v[56:59], a[32:35]
    ds_read_b128 v[116:119], v10 offset:4096
    v_mfma_f32_16x16x32_bf16 a[36:39], v[36:39], v[56:59], a[36:39]
    ds_read_b128 v[120:123], v10 offset:5120
    v_mfma_f32_16x16x32_bf16 a[40:43], v[40:43], v[56:59], a[40:43]
    ds_read_b128 v[124:127], v10 offset:6144
    v_mfma_f32_16x16x32_bf16 a[44:47], v[44:47], v[56:59], a[44:47]
    ds_read_b128 v[128:131], v10 offset:7168
    v_mfma_f32_16x16x32_bf16 a[48:51], v[32:35], v[60:63], a[48:51]
    ds_read_b128 v[132:135], v10 offset:8192
    v_mfma_f32_16x16x32_bf16 a[52:55], v[36:39], v[60:63], a[52:55]
    v_mfma_f32_16x16x32_bf16 a[56:59], v[40:43], v[60:63], a[56:59]
    v_mfma_f32_16x16x32_bf16 a[60:63], v[44:47], v[60:63], a[60:63]
    v_mfma_f32_16x16x32_bf16 a[64:67], v[64:67], v[32:35], a[64:67]
    v_mfma_f32_16x16x32_bf16 a[68:71], v[64:67], v[36:39], a[68:71]
    v_mfma_f32_16x16x32_bf16 a[72:75], v[64:67], v[40:43], a[72:75]
    v_mfma_f32_16x16x32_bf16 a[76:79], v[64:67], v[44:47], a[76:79]
    v_mfma_f32_16x16x32_bf16 a[80:83], v[68:71], v[32:35], a[80:83]
    v_mfma_f32_16x16x32_bf16 a[84:87], v[68:71], v[36:39], a[84:87]
    v_mfma_f32_16x16x32_bf16 a[88:91], v[68:71], v[40:43], a[88:91]
    v_mfma_f32_16x16x32_bf16 a[92:95], v[68:71], v[44:47], a[92:95]
    v_mfma_f32_16x16x32_bf16 a[96:99], v[72:75], v[32:35], a[96:99]
    v_mfma_f32_16x16x32_bf16 a[100:103], v[72:75], v[36:39], a[100:103]
    v_mfma_f32_16x16x32_bf16 a[104:107], v[72:75], v[40:43], a[104:107]
    v_mfma_f32_16x16x32_bf16 a[108:111], v[72:75], v[44:47], a[108:111]
    v_mfma_f32_16x16x32_bf16 a[112:115], v[76:79], v[32:35], a[112:115]
    v_mfma_f32_16x16x32_bf16 a[116:119], v[76:79], v[36:39], a[116:119]
    v_mfma_f32_16x16x32_bf16 a[120:123], v[76:79], v[40:43], a[120:123]
    v_mfma_f32_16x16x32_bf16 a[124:127], v[76:79], v[44:47], a[124:127]
    v_mfma_f32_16x16x32_bf16 a[128:131], v[80:83], v[32:35], a[128:131]
    v_mfma_f32_16x16x32_bf16 a[132:135], v[80:83], v[36:39], a[132:135]
    v_mfma_f32_16x16x32_bf16 a[136:139], v[80:83], v[40:43], a[136:139]
    v_mfma_f32_16x16x32_bf16 a[140:143], v[80:83], v[44:47], a[140:143]
    s_waitcnt vmcnt(0) lgkmcnt(0)
    s_barrier
    v_mfma_f32_16x16x32_bf16 a[0:3], v[84:87], v[100:103], a[0:3]
    v_mfma_f32_16x16x32_bf16 a[4:7], v[88:91], v[100:103], a[4:7]
    v_mfma_f32_16x16x32_bf16 a[8:11], v[92:95], v[100:103], a[8:11]
    v_mfma_f32_16x16x32_bf16 a[12:15], v[96:99], v[100:103], a[12:15]
    v_mfma_f32_16x16x32_bf16 a[16:19], v[84:87], v[104:107], a[16:19]
    v_mfma_f32_16x16x32_bf16 a[20:23], v[88:91], v[104:107], a[20:23]
    v_mfma_f32_16x16x32_bf16 a[24:27], v[92:95], v[104:107], a[24:27]
    v_mfma_f32_16x16x32_bf16 a[28:31], v[96:99], v[104:107], a[28:31]
    v_mfma_f32_16x16x32_bf16 a[32:35], v[84:87], v[108:111], a[32:35]
    v_mfma_f32_16x16x32_bf16 a[36:39], v[88:91], v[108:111], a[36:39]
    v_mfma_f32_16x16x32_bf16 a[40:43], v[92:95], v[108:111], a[40:43]
    v_mfma_f32_16x16x32_bf16 a[44:47], v[96:99], v[108:111], a[44:47]
    v_mfma_f32_16x16x32_bf16 a[48:51], v[84:87], v[112:115], a[48:51]
    v_mfma_f32_16x16x32_bf16 a[52:55], v[88:91], v[112:115], a[52:55]
    v_mfma_f32_16x16x32_bf16 a[56:59], v[92:95], v[112:115], a[56:59]
    v_mfma_f32_16x16x32_bf16 a[60:63], v[96:99], v[112:115], a[60:63]
    v_mfma_f32_16x16x32_bf16 a[64:67], v[116:119], v[84:87], a[64:67]
    v_mfma_f32_16x16x32_bf16 a[68:71], v[116:119], v[88:91], a[68:71]
    v_mfma_f32_16x16x32_bf16 a[72:75], v[116:119], v[92:95], a[72:75]
    v_mfma_f32_16x16x32_bf16 a[76:79], v[116:119], v[96:99], a[76:79]
    v_mfma_f32_16x16x32_bf16 a[80:83], v[120:123], v[84:87], a[80:83]
    v_mfma_f32_16x16x32_bf16 a[84:87], v[120:123], v[88:91], a[84:87]
    v_mfma_f32_16x16x32_bf16 a[88:91], v[120:123], v[92:95], a[88:91]
    v_mfma_f32_16x16x32_bf16 a[92:95], v[120:123], v[96:99], a[92:95]
    v_mfma_f32_16x16x32_bf16 a[96:99], v[124:127], v[84:87], a[96:99]
    v_mfma_f32_16x16x32_bf16 a[100:103], v[124:127], v[88:91], a[100:103]
    v_mfma_f32_16x16x32_bf16 a[104:107], v[124:127], v[92:95], a[104:107]
    v_mfma_f32_16x16x32_bf16 a[108:111], v[124:127], v[96:99], a[108:111]
    v_mfma_f32_16x16x32_bf16 a[112:115], v[128:131], v[84:87], a[112:115]
    v_mfma_f32_16x16x32_bf16 a[116:119], v[128:131], v[88:91], a[116:119]
    v_mfma_f32_16x16x32_bf16 a[120:123], v[128:131], v[92:95], a[120:123]
    v_mfma_f32_16x16x32_bf16 a[124:127], v[128:131], v[96:99], a[124:127]
    v_mfma_f32_16x16x32_bf16 a[128:131], v[132:135], v[84:87], a[128:131]
    v_mfma_f32_16x16x32_bf16 a[132:135], v[132:135], v[88:91], a[132:135]
    v_mfma_f32_16x16x32_bf16 a[136:139], v[132:135], v[92:95], a[136:139]
    v_mfma_f32_16x16x32_bf16 a[140:143], v[132:135], v[96:99], a[140:143]
    s_nop 7
    s_nop 7
    s_barrier
    s_mul_i32 s60, s9, 24576
    v_and_b32 v140, 15, v2
    v_lshlrev_b32 v140, 3, v140
    v_lshrrev_b32 v141, 4, v2
    v_lshl_add_u32 v140, v141, 10, v140
    v_add_u32 v140, s60, v140
    v_accvgpr_read_b32 v142, a0
    v_accvgpr_read_b32 v143, a16
    ds_write_b64 v140, v[142:143] offset:0
    v_accvgpr_read_b32 v142, a1
    v_accvgpr_read_b32 v143, a17
    ds_write_b64 v140, v[142:143] offset:256
    v_accvgpr_read_b32 v142, a2
    v_accvgpr_read_b32 v143, a18
    ds_write_b64 v140, v[142:143] offset:512
    v_accvgpr_read_b32 v142, a3
    v_accvgpr_read_b32 v143, a19
    ds_write_b64 v140, v[142:143] offset:768
    v_accvgpr_read_b32 v142, a32
    v_accvgpr_read_b32 v143, a48
    ds_write_b64 v140, v[142:143] offset:128
    v_accvgpr_read_b32 v142, a33
    v_accvgpr_read_b32 v143, a49
    ds_write_b64 v140, v[142:143] offset:384
    v_accvgpr_read_b32 v142, a34
    v_accvgpr_read_b32 v143, a50
    ds_write_b64 v140, v[142:143] offset:640
    v_accvgpr_read_b32 v142, a35
    v_accvgpr_read_b32 v143, a51
    ds_write_b64 v140, v[142:143] offset:896
    v_accvgpr_read_b32 v142, a4
    v_accvgpr_read_b32 v143, a20
    ds_write_b64 v140, v[142:143] offset:4096
    v_accvgpr_read_b32 v142, a5
    v_accvgpr_read_b32 v143, a21
    ds_write_b64 v140, v[142:143] offset:4352
    v_accvgpr_read_b32 v142, a6
    v_accvgpr_read_b32 v143, a22
    ds_write_b64 v140, v[142:143] offset:4608
    v_accvgpr_read_b32 v142, a7
    v_accvgpr_read_b32 v143, a23
    ds_write_b64 v140, v[142:143] offset:4864
    v_accvgpr_read_b32 v142, a36
    v_accvgpr_read_b32 v143, a52
    ds_write_b64 v140, v[142:143] offset:4224
    v_accvgpr_read_b32 v142, a37
    v_accvgpr_read_b32 v143, a53
    ds_write_b64 v140, v[142:143] offset:4480
    v_accvgpr_read_b32 v142, a38
    v_accvgpr_read_b32 v143, a54
    ds_write_b64 v140, v[142:143] offset:4736
    v_accvgpr_read_b32 v142, a39
    v_accvgpr_read_b32 v143, a55
    ds_write_b64 v140, v[142:143] offset:4992
    v_accvgpr_read_b32 v142, a8
    v_accvgpr_read_b32 v143, a24
    ds_write_b64 v140, v[142:143] offset:8192
    v_accvgpr_read_b32 v142, a9
    v_accvgpr_read_b32 v143, a25
    ds_write_b64 v140, v[142:143] offset:8448
    v_accvgpr_read_b32 v142, a10
    v_accvgpr_read_b32 v143, a26
    ds_write_b64 v140, v[142:143] offset:8704
    v_accvgpr_read_b32 v142, a11
    v_accvgpr_read_b32 v143, a27
    ds_write_b64 v140, v[142:143] offset:8960
    v_accvgpr_read_b32 v142, a40
    v_accvgpr_read_b32 v143, a56
    ds_write_b64 v140, v[142:143] offset:8320
    v_accvgpr_read_b32 v142, a41
    v_accvgpr_read_b32 v143, a57
    ds_write_b64 v140, v[142:143] offset:8576
    v_accvgpr_read_b32 v142, a42
    v_accvgpr_read_b32 v143, a58
    ds_write_b64 v140, v[142:143] offset:8832
    v_accvgpr_read_b32 v142, a43
    v_accvgpr_read_b32 v143, a59
    ds_write_b64 v140, v[142:143] offset:9088
    v_accvgpr_read_b32 v142, a12
    v_accvgpr_read_b32 v143, a28
    ds_write_b64 v140, v[142:143] offset:12288
    v_accvgpr_read_b32 v142, a13
    v_accvgpr_read_b32 v143, a29
    ds_write_b64 v140, v[142:143] offset:12544
    v_accvgpr_read_b32 v142, a14
    v_accvgpr_read_b32 v143, a30
    ds_write_b64 v140, v[142:143] offset:12800
    v_accvgpr_read_b32 v142, a15
    v_accvgpr_read_b32 v143, a31
    ds_write_b64 v140, v[142:143] offset:13056
    v_accvgpr_read_b32 v142, a44
    v_accvgpr_read_b32 v143, a60
    ds_write_b64 v140, v[142:143] offset:12416
    v_accvgpr_read_b32 v142, a45
    v_accvgpr_read_b32 v143, a61
    ds_write_b64 v140, v[142:143] offset:12672
    v_accvgpr_read_b32 v142, a46
    v_accvgpr_read_b32 v143, a62
    ds_write_b64 v140, v[142:143] offset:12928
    v_accvgpr_read_b32 v142, a47
    v_accvgpr_read_b32 v143, a63
    ds_write_b64 v140, v[142:143] offset:13184
    s_load_dwordx2 s[62:63], s[0:1], 8
    s_load_dwordx2 s[64:65], s[0:1], 16
    s_load_dwordx2 s[66:67], s[0:1], 56
    s_waitcnt lgkmcnt(0)
    s_mov_b32 s68, s62
    s_mov_b32 s69, s63
    s_mov_b32 s70, 1024
    s_mov_b32 s71, 0x00020000
    s_mov_b32 s72, s64
    s_mov_b32 s73, s65
    s_mov_b32 s74, 1024
    s_mov_b32 s75, 0x00020000
    s_mov_b32 s76, s66
    s_mov_b32 s77, s67
    s_mov_b32 s78, 1024
    s_mov_b32 s79, 0x00020000
    v_and_b32 v106, 31, v2
    s_lshl_b32 s61, s7, 5
    v_add_u32 v107, s61, v106
    v_lshlrev_b32 v108, 1, v107
    buffer_load_ushort v109, v108, s[68:71], 0 offen
    buffer_load_ushort v110, v108, s[72:75], 0 offen
    buffer_load_ushort v111, v108, s[76:79], 0 offen
    v_lshl_add_u32 v104, v106, 3, s60
    v_lshl_add_u32 v105, v106, 2, s60
    v_add_u32 v105, 16384, v105
    s_waitcnt vmcnt(0)
    v_lshlrev_b32 v109, 16, v109
    v_lshlrev_b32 v110, 16, v110
    v_lshlrev_b32 v111, 16, v111
    v_mul_f32 v112, 0x3fb8aa3b, v111
    v_exp_f32 v112, v112
    s_nop 0
    v_cvt_pk_bf16_f32 v113, v112, v112
    v_lshlrev_b32 v112, 16, v113
    v_mul_f32 v113, v112, v109
    v_mul_f32 v114, v112, v110
    v_mul_f32 v113, 0x3fb8aa3b, v113
    v_exp_f32 v113, v113
    v_mul_f32 v114, 0x3e22f983, v114
    v_fract_f32 v114, v114
    v_cos_f32 v102, v114
    v_sin_f32 v103, v114
    s_nop 0
    v_mul_f32 v102, v102, v113
    v_mul_f32 v103, v103, v113
    v_mov_b32 v96, 0
    v_mov_b32 v97, 0
    s_waitcnt lgkmcnt(0)
    ds_read_b64 v[32:33], v104 offset:0
    ds_read_b64 v[34:35], v104 offset:256
    ds_read_b64 v[36:37], v104 offset:512
    ds_read_b64 v[38:39], v104 offset:768
    ds_read_b64 v[40:41], v104 offset:1024
    ds_read_b64 v[42:43], v104 offset:1280
    ds_read_b64 v[44:45], v104 offset:1536
    ds_read_b64 v[46:47], v104 offset:1792
    ds_read_b64 v[48:49], v104 offset:2048
    ds_read_b64 v[50:51], v104 offset:2304
    ds_read_b64 v[52:53], v104 offset:2560
    ds_read_b64 v[54:55], v104 offset:2816
    ds_read_b64 v[56:57], v104 offset:3072
    ds_read_b64 v[58:59], v104 offset:3328
    ds_read_b64 v[60:61], v104 offset:3584
    ds_read_b64 v[62:63], v104 offset:3840
    ds_read_b64 v[64:65], v104 offset:4096
    ds_read_b64 v[66:67], v104 offset:4352
    ds_read_b64 v[68:69], v104 offset:4608
    ds_read_b64 v[70:71], v104 offset:4864
    ds_read_b64 v[72:73], v104 offset:5120
    ds_read_b64 v[74:75], v104 offset:5376
    ds_read_b64 v[76:77], v104 offset:5632
    ds_read_b64 v[78:79], v104 offset:5888
    ds_read_b64 v[80:81], v104 offset:6144
    ds_read_b64 v[82:83], v104 offset:6400
    ds_read_b64 v[84:85], v104 offset:6656
    ds_read_b64 v[86:87], v104 offset:6912
    ds_read_b64 v[88:89], v104 offset:7168
    ds_read_b64 v[90:91], v104 offset:7424
    ds_read_b64 v[92:93], v104 offset:7680
    ds_read_b64 v[94:95], v104 offset:7936
    s_waitcnt lgkmcnt(15)
    v_fma_f32 v98, v102, v96, v32
    v_fma_f32 v99, v102, v97, v33
    v_fma_f32 v98, -v103, v97, v98
    v_fma_f32 v99, v103, v96, v99
    s_waitcnt lgkmcnt(15)
    v_fma_f32 v96, v102, v98, v34
    v_fma_f32 v97, v102, v99, v35
    v_fma_f32 v96, -v103, v99, v96
    v_fma_f32 v97, v103, v98, v97
    s_waitcnt lgkmcnt(15)
    v_fma_f32 v98, v102, v96, v36
    v_fma_f32 v99, v102, v97, v37
    v_fma_f32 v98, -v103, v97, v98
    v_fma_f32 v99, v103, v96, v99
    s_waitcnt lgkmcnt(15)
    v_fma_f32 v96, v102, v98, v38
    v_fma_f32 v97, v102, v99, v39
    v_fma_f32 v96, -v103, v99, v96
    v_fma_f32 v97, v103, v98, v97
    s_waitcnt lgkmcnt(15)
    v_fma_f32 v98, v102, v96, v40
    v_fma_f32 v99, v102, v97, v41
    v_fma_f32 v98, -v103, v97, v98
    v_fma_f32 v99, v103, v96, v99
    s_waitcnt lgkmcnt(15)
    v_fma_f32 v96, v102, v98, v42
    v_fma_f32 v97, v102, v99, v43
    v_fma_f32 v96, -v103, v99, v96
    v_fma_f32 v97, v103, v98, v97
    s_waitcnt lgkmcnt(15)
    v_fma_f32 v98, v102, v96, v44
    v_fma_f32 v99, v102, v97, v45
    v_fma_f32 v98, -v103, v97, v98
    v_fma_f32 v99, v103, v96, v99
    s_waitcnt lgkmcnt(15)
    v_fma_f32 v96, v102, v98, v46
    v_fma_f32 v97, v102, v99, v47
    v_fma_f32 v96, -v103, v99, v96
    v_fma_f32 v97, v103, v98, v97
    s_waitcnt lgkmcnt(15)
    v_fma_f32 v98, v102, v96, v48
    v_fma_f32 v99, v102, v97, v49
    v_fma_f32 v98, -v103, v97, v98
    v_fma_f32 v99, v103, v96, v99
    s_waitcnt lgkmcnt(15)
    v_fma_f32 v96, v102, v98, v50
    v_fma_f32 v97, v102, v99, v51
    v_fma_f32 v96, -v103, v99, v96
    v_fma_f32 v97, v103, v98, v97
    s_waitcnt lgkmcnt(15)
    v_fma_f32 v98, v102, v96, v52
    v_fma_f32 v99, v102, v97, v53
    v_fma_f32 v98, -v103, v97, v98
    v_fma_f32 v99, v103, v96, v99
    s_waitcnt lgkmcnt(15)
    v_fma_f32 v96, v102, v98, v54
    v_fma_f32 v97, v102, v99, v55
    v_fma_f32 v96, -v103, v99, v96
    v_fma_f32 v97, v103, v98, v97
    s_waitcnt lgkmcnt(15)
    v_fma_f32 v98, v102, v96, v56
    v_fma_f32 v99, v102, v97, v57
    v_fma_f32 v98, -v103, v97, v98
    v_fma_f32 v99, v103, v96, v99
    s_waitcnt lgkmcnt(15)
    v_fma_f32 v96, v102, v98, v58
    v_fma_f32 v97, v102, v99, v59
    v_fma_f32 v96, -v103, v99, v96
    v_fma_f32 v97, v103, v98, v97
    s_waitcnt lgkmcnt(15)
    v_fma_f32 v98, v102, v96, v60
    v_fma_f32 v99, v102, v97, v61
    v_fma_f32 v98, -v103, v97, v98
    v_fma_f32 v99, v103, v96, v99
    s_waitcnt lgkmcnt(15)
    v_fma_f32 v96, v102, v98, v62
    v_fma_f32 v97, v102, v99, v63
    v_fma_f32 v96, -v103, v99, v96
    v_fma_f32 v97, v103, v98, v97
    ds_read_b64 v[32:33], v104 offset:8192
    ds_read_b64 v[34:35], v104 offset:8448
    ds_read_b64 v[36:37], v104 offset:8704
    ds_read_b64 v[38:39], v104 offset:8960
    ds_read_b64 v[40:41], v104 offset:9216
    ds_read_b64 v[42:43], v104 offset:9472
    ds_read_b64 v[44:45], v104 offset:9728
    ds_read_b64 v[46:47], v104 offset:9984
    ds_read_b64 v[48:49], v104 offset:10240
    ds_read_b64 v[50:51], v104 offset:10496
    ds_read_b64 v[52:53], v104 offset:10752
    ds_read_b64 v[54:55], v104 offset:11008
    ds_read_b64 v[56:57], v104 offset:11264
    ds_read_b64 v[58:59], v104 offset:11520
    ds_read_b64 v[60:61], v104 offset:11776
    ds_read_b64 v[62:63], v104 offset:12032
    s_waitcnt lgkmcnt(15)
    v_fma_f32 v98, v102, v96, v64
    v_fma_f32 v99, v102, v97, v65
    v_fma_f32 v98, -v103, v97, v98
    v_fma_f32 v99, v103, v96, v99
    s_waitcnt lgkmcnt(15)
    v_fma_f32 v96, v102, v98, v66
    v_fma_f32 v97, v102, v99, v67
    v_fma_f32 v96, -v103, v99, v96
    v_fma_f32 v97, v103, v98, v97
    s_waitcnt lgkmcnt(15)
    v_fma_f32 v98, v102, v96, v68
    v_fma_f32 v99, v102, v97, v69
    v_fma_f32 v98, -v103, v97, v98
    v_fma_f32 v99, v103, v96, v99
    s_waitcnt lgkmcnt(15)
    v_fma_f32 v96, v102, v98, v70
    v_fma_f32 v97, v102, v99, v71
    v_fma_f32 v96, -v103, v99, v96
    v_fma_f32 v97, v103, v98, v97
    s_waitcnt lgkmcnt(15)
    v_fma_f32 v98, v102, v96, v72
    v_fma_f32 v99, v102, v97, v73
    v_fma_f32 v98, -v103, v97, v98
    v_fma_f32 v99, v103, v96, v99
    s_waitcnt lgkmcnt(15)
    v_fma_f32 v96, v102, v98, v74
    v_fma_f32 v97, v102, v99, v75
    v_fma_f32 v96, -v103, v99, v96
    v_fma_f32 v97, v103, v98, v97
    s_waitcnt lgkmcnt(15)
    v_fma_f32 v98, v102, v96, v76
    v_fma_f32 v99, v102, v97, v77
    v_fma_f32 v98, -v103, v97, v98
    v_fma_f32 v99, v103, v96, v99
    s_waitcnt lgkmcnt(15)
    v_fma_f32 v96, v102, v98, v78
    v_fma_f32 v97, v102, v99, v79
    v_fma_f32 v96, -v103, v99, v96
    v_fma_f32 v97, v103, v98, v97
    s_waitcnt lgkmcnt(15)
    v_fma_f32 v98, v102, v96, v80
    v_fma_f32 v99, v102, v97, v81
    v_fma_f32 v98, -v103, v97, v98
    v_fma_f32 v99, v103, v96, v99
    s_waitcnt lgkmcnt(15)
    v_fma_f32 v96, v102, v98, v82
    v_fma_f32 v97, v102, v99, v83
    v_fma_f32 v96, -v103, v99, v96
    v_fma_f32 v97, v103, v98, v97
    s_waitcnt lgkmcnt(15)
    v_fma_f32 v98, v102, v96, v84
    v_fma_f32 v99, v102, v97, v85
    v_fma_f32 v98, -v103, v97, v98
    v_fma_f32 v99, v103, v96, v99
    s_waitcnt lgkmcnt(15)
    v_fma_f32 v96, v102, v98, v86
    v_fma_f32 v97, v102, v99, v87
    v_fma_f32 v96, -v103, v99, v96
    v_fma_f32 v97, v103, v98, v97
    s_waitcnt lgkmcnt(15)
    v_fma_f32 v98, v102, v96, v88
    v_fma_f32 v99, v102, v97, v89
    v_fma_f32 v98, -v103, v97, v98
    v_fma_f32 v99, v103, v96, v99
    s_waitcnt lgkmcnt(15)
    v_fma_f32 v96, v102, v98, v90
    v_fma_f32 v97, v102, v99, v91
    v_fma_f32 v96, -v103, v99, v96
    v_fma_f32 v97, v103, v98, v97
    s_waitcnt lgkmcnt(15)
    v_fma_f32 v98, v102, v96, v92
    v_fma_f32 v99, v102, v97, v93
    v_fma_f32 v98, -v103, v97, v98
    v_fma_f32 v99, v103, v96, v99
    s_waitcnt lgkmcnt(15)
    v_fma_f32 v96, v102, v98, v94
    v_fma_f32 v97, v102, v99, v95
    v_fma_f32 v96, -v103, v99, v96
    v_fma_f32 v97, v103, v98, v97
    ds_read_b64 v[64:65], v104 offset:12288
    ds_read_b64 v[66:67], v104 offset:12544
    ds_read_b64 v[68:69], v104 offset:12800
    ds_read_b64 v[70:71], v104 offset:13056
    ds_read_b64 v[72:73], v104 offset:13312
    ds_read_b64 v[74:75], v104 offset:13568
    ds_read_b64 v[76:77], v104 offset:13824
    ds_read_b64 v[78:79], v104 offset:14080
    ds_read_b64 v[80:81], v104 offset:14336
    ds_read_b64 v[82:83], v104 offset:14592
    ds_read_b64 v[84:85], v104 offset:14848
    ds_read_b64 v[86:87], v104 offset:15104
    ds_read_b64 v[88:89], v104 offset:15360
    ds_read_b64 v[90:91], v104 offset:15616
    ds_read_b64 v[92:93], v104 offset:15872
    ds_read_b64 v[94:95], v104 offset:16128
    s_waitcnt lgkmcnt(15)
    v_fma_f32 v98, v102, v96, v32
    v_fma_f32 v99, v102, v97, v33
    v_fma_f32 v98, -v103, v97, v98
    v_fma_f32 v99, v103, v96, v99
    s_waitcnt lgkmcnt(15)
    v_fma_f32 v96, v102, v98, v34
    v_fma_f32 v97, v102, v99, v35
    v_fma_f32 v96, -v103, v99, v96
    v_fma_f32 v97, v103, v98, v97
    s_waitcnt lgkmcnt(15)
    v_fma_f32 v98, v102, v96, v36
    v_fma_f32 v99, v102, v97, v37
    v_fma_f32 v98, -v103, v97, v98
    v_fma_f32 v99, v103, v96, v99
    s_waitcnt lgkmcnt(15)
    v_fma_f32 v96, v102, v98, v38
    v_fma_f32 v97, v102, v99, v39
    v_fma_f32 v96, -v103, v99, v96
    v_fma_f32 v97, v103, v98, v97
    s_waitcnt lgkmcnt(15)
    v_fma_f32 v98, v102, v96, v40
    v_fma_f32 v99, v102, v97, v41
    v_fma_f32 v98, -v103, v97, v98
    v_fma_f32 v99, v103, v96, v99
    s_waitcnt lgkmcnt(15)
    v_fma_f32 v96, v102, v98, v42
    v_fma_f32 v97, v102, v99, v43
    v_fma_f32 v96, -v103, v99, v96
    v_fma_f32 v97, v103, v98, v97
    s_waitcnt lgkmcnt(15)
    v_fma_f32 v98, v102, v96, v44
    v_fma_f32 v99, v102, v97, v45
    v_fma_f32 v98, -v103, v97, v98
    v_fma_f32 v99, v103, v96, v99
    s_waitcnt lgkmcnt(15)
    v_fma_f32 v96, v102, v98, v46
    v_fma_f32 v97, v102, v99, v47
    v_fma_f32 v96, -v103, v99, v96
    v_fma_f32 v97, v103, v98, v97
    s_waitcnt lgkmcnt(15)
    v_fma_f32 v98, v102, v96, v48
    v_fma_f32 v99, v102, v97, v49
    v_fma_f32 v98, -v103, v97, v98
    v_fma_f32 v99, v103, v96, v99
    s_waitcnt lgkmcnt(15)
    v_fma_f32 v96, v102, v98, v50
    v_fma_f32 v97, v102, v99, v51
    v_fma_f32 v96, -v103, v99, v96
    v_fma_f32 v97, v103, v98, v97
    s_waitcnt lgkmcnt(15)
    v_fma_f32 v98, v102, v96, v52
    v_fma_f32 v99, v102, v97, v53
    v_fma_f32 v98, -v103, v97, v98
    v_fma_f32 v99, v103, v96, v99
    s_waitcnt lgkmcnt(15)
    v_fma_f32 v96, v102, v98, v54
    v_fma_f32 v97, v102, v99, v55
    v_fma_f32 v96, -v103, v99, v96
    v_fma_f32 v97, v103, v98, v97
    s_waitcnt lgkmcnt(15)
    v_fma_f32 v98, v102, v96, v56
    v_fma_f32 v99, v102, v97, v57
    v_fma_f32 v98, -v103, v97, v98
    v_fma_f32 v99, v103, v96, v99
    s_waitcnt lgkmcnt(15)
    v_fma_f32 v96, v102, v98, v58
    v_fma_f32 v97, v102, v99, v59
    v_fma_f32 v96, -v103, v99, v96
    v_fma_f32 v97, v103, v98, v97
    s_waitcnt lgkmcnt(15)
    v_fma_f32 v98, v102, v96, v60
    v_fma_f32 v99, v102, v97, v61
    v_fma_f32 v98, -v103, v97, v98
    v_fma_f32 v99, v103, v96, v99
    s_waitcnt lgkmcnt(15)
    v_fma_f32 v96, v102, v98, v62
    v_fma_f32 v97, v102, v99, v63
    v_fma_f32 v96, -v103, v99, v96
    v_fma_f32 v97, v103, v98, v97
    s_waitcnt lgkmcnt(15)
    v_fma_f32 v98, v102, v96, v64
    v_fma_f32 v99, v102, v97, v65
    v_fma_f32 v98, -v103, v97, v98
    v_fma_f32 v99, v103, v96, v99
    s_waitcnt lgkmcnt(14)
    v_fma_f32 v96, v102, v98, v66
    v_fma_f32 v97, v102, v99, v67
    v_fma_f32 v96, -v103, v99, v96
    v_fma_f32 v97, v103, v98, v97
    s_waitcnt lgkmcnt(13)
    v_fma_f32 v98, v102, v96, v68
    v_fma_f32 v99, v102, v97, v69
    v_fma_f32 v98, -v103, v97, v98
    v_fma_f32 v99, v103, v96, v99
    s_waitcnt lgkmcnt(12)
    v_fma_f32 v96, v102, v98, v70
    v_fma_f32 v97, v102, v99, v71
    v_fma_f32 v96, -v103, v99, v96
    v_fma_f32 v97, v103, v98, v97
    s_waitcnt lgkmcnt(11)
    v_fma_f32 v98, v102, v96, v72
    v_fma_f32 v99, v102, v97, v73
    v_fma_f32 v98, -v103, v97, v98
    v_fma_f32 v99, v103, v96, v99
    s_waitcnt lgkmcnt(10)
    v_fma_f32 v96, v102, v98, v74
    v_fma_f32 v97, v102, v99, v75
    v_fma_f32 v96, -v103, v99, v96
    v_fma_f32 v97, v103, v98, v97
    s_waitcnt lgkmcnt(9)
    v_fma_f32 v98, v102, v96, v76
    v_fma_f32 v99, v102, v97, v77
    v_fma_f32 v98, -v103, v97, v98
    v_fma_f32 v99, v103, v96, v99
    s_waitcnt lgkmcnt(8)
    v_fma_f32 v96, v102, v98, v78
    v_fma_f32 v97, v102, v99, v79
    v_fma_f32 v96, -v103, v99, v96
    v_fma_f32 v97, v103, v98, v97
    s_waitcnt lgkmcnt(7)
    v_fma_f32 v98, v102, v96, v80
    v_fma_f32 v99, v102, v97, v81
    v_fma_f32 v98, -v103, v97, v98
    v_fma_f32 v99, v103, v96, v99
    s_waitcnt lgkmcnt(6)
    v_fma_f32 v96, v102, v98, v82
    v_fma_f32 v97, v102, v99, v83
    v_fma_f32 v96, -v103, v99, v96
    v_fma_f32 v97, v103, v98, v97
    s_waitcnt lgkmcnt(5)
    v_fma_f32 v98, v102, v96, v84
    v_fma_f32 v99, v102, v97, v85
    v_fma_f32 v98, -v103, v97, v98
    v_fma_f32 v99, v103, v96, v99
    s_waitcnt lgkmcnt(4)
    v_fma_f32 v96, v102, v98, v86
    v_fma_f32 v97, v102, v99, v87
    v_fma_f32 v96, -v103, v99, v96
    v_fma_f32 v97, v103, v98, v97
    s_waitcnt lgkmcnt(3)
    v_fma_f32 v98, v102, v96, v88
    v_fma_f32 v99, v102, v97, v89
    v_fma_f32 v98, -v103, v97, v98
    v_fma_f32 v99, v103, v96, v99
    s_waitcnt lgkmcnt(2)
    v_fma_f32 v96, v102, v98, v90
    v_fma_f32 v97, v102, v99, v91
    v_fma_f32 v96, -v103, v99, v96
    v_fma_f32 v97, v103, v98, v97
    s_waitcnt lgkmcnt(1)
    v_fma_f32 v98, v102, v96, v92
    v_fma_f32 v99, v102, v97, v93
    v_fma_f32 v98, -v103, v97, v98
    v_fma_f32 v99, v103, v96, v99
    s_waitcnt lgkmcnt(0)
    v_fma_f32 v96, v102, v98, v94
    v_fma_f32 v97, v102, v99, v95
    v_fma_f32 v96, -v103, v99, v96
    v_fma_f32 v97, v103, v98, v97
    s_lshl_b32 s58, s6, 1
    s_add_u32 s58, s58, s9
    s_lshl_b32 s59, s58, 12
    v_lshlrev_b32 v115, 3, v107
    buffer_store_dwordx2 v[96:97], v115, s[28:31], s59 offen sc1
    s_lshl_b32 s61, 1, s58
    v_mov_b32 v116, s61
    s_lshl_b32 s80, s7, 2
    v_mov_b32 v117, s80
    s_waitcnt vmcnt(0)
    s_mov_b64 s[82:83], exec
    s_mov_b64 exec, 1
    buffer_atomic_or v116, v117, s[32:35], 0 offen
    s_mov_b64 exec, s[82:83]
    v_and_b32 v140, 15, v2
    v_lshlrev_b32 v140, 4, v140
    v_lshrrev_b32 v141, 4, v2
    v_lshl_add_u32 v140, v141, 2, v140
    s_mul_i32 s52, s7, 14
    s_lshl_b32 s53, s6, 3
    s_lshl_b32 s54, s9, 2
    s_add_u32 s53, s53, s54
    s_mul_i32 s53, s53, 57344
    s_mov_b32 s55, 0xffff0000
    s_add_u32 s56, s52, 0
    s_lshl_b32 s56, s56, 8
    s_add_u32 s56, s56, s53
    v_accvgpr_read_b32 v142, a64
    v_accvgpr_read_b32 v143, a65
    v_accvgpr_read_b32 v144, a66
    v_accvgpr_read_b32 v145, a67
    v_cvt_pk_bf16_f32 v146, v142, v143
    v_cvt_pk_bf16_f32 v147, v144, v145
    v_lshlrev_b32 v142, 16, v146
    v_and_b32 v143, s55, v146
    v_lshlrev_b32 v144, 16, v147
    v_and_b32 v145, s55, v147
    v_mul_f32 v142, v142, v143
    v_mul_f32 v144, v144, v145
    v_cvt_pk_bf16_f32 v148, v142, v144
    s_add_u32 s57, s56, 0
    buffer_store_dword v148, v140, s[24:27], s57 offen
    v_accvgpr_read_b32 v142, a68
    v_accvgpr_read_b32 v143, a69
    v_accvgpr_read_b32 v144, a70
    v_accvgpr_read_b32 v145, a71
    v_cvt_pk_bf16_f32 v146, v142, v143
    v_cvt_pk_bf16_f32 v147, v144, v145
    v_lshlrev_b32 v142, 16, v146
    v_and_b32 v143, s55, v146
    v_lshlrev_b32 v144, 16, v147
    v_and_b32 v145, s55, v147
    v_mul_f32 v142, v142, v143
    v_mul_f32 v144, v144, v145
    v_cvt_pk_bf16_f32 v149, v142, v144
    s_add_u32 s57, s56, 57344
    buffer_store_dword v149, v140, s[24:27], s57 offen
    v_accvgpr_read_b32 v142, a72
    v_accvgpr_read_b32 v143, a73
    v_accvgpr_read_b32 v144, a74
    v_accvgpr_read_b32 v145, a75
    v_cvt_pk_bf16_f32 v146, v142, v143
    v_cvt_pk_bf16_f32 v147, v144, v145
    v_lshlrev_b32 v142, 16, v146
    v_and_b32 v143, s55, v146
    v_lshlrev_b32 v144, 16, v147
    v_and_b32 v145, s55, v147
    v_mul_f32 v142, v142, v143
    v_mul_f32 v144, v144, v145
    v_cvt_pk_bf16_f32 v150, v142, v144
    s_add_u32 s57, s56, 114688
    buffer_store_dword v150, v140, s[24:27], s57 offen
    v_accvgpr_read_b32 v142, a76
    v_accvgpr_read_b32 v143, a77
    v_accvgpr_read_b32 v144, a78
    v_accvgpr_read_b32 v145, a79
    v_cvt_pk_bf16_f32 v146, v142, v143
    v_cvt_pk_bf16_f32 v147, v144, v145
    v_lshlrev_b32 v142, 16, v146
    v_and_b32 v143, s55, v146
    v_lshlrev_b32 v144, 16, v147
    v_and_b32 v145, s55, v147
    v_mul_f32 v142, v142, v143
    v_mul_f32 v144, v144, v145
    v_cvt_pk_bf16_f32 v151, v142, v144
    s_add_u32 s57, s56, 172032
    buffer_store_dword v151, v140, s[24:27], s57 offen
    s_add_u32 s56, s52, 1
    s_lshl_b32 s56, s56, 8
    s_add_u32 s56, s56, s53
    v_accvgpr_read_b32 v142, a80
    v_accvgpr_read_b32 v143, a81
    v_accvgpr_read_b32 v144, a82
    v_accvgpr_read_b32 v145, a83
    v_cvt_pk_bf16_f32 v146, v142, v143
    v_cvt_pk_bf16_f32 v147, v144, v145
    v_lshlrev_b32 v142, 16, v146
    v_and_b32 v143, s55, v146
    v_lshlrev_b32 v144, 16, v147
    v_and_b32 v145, s55, v147
    v_mul_f32 v142, v142, v143
    v_mul_f32 v144, v144, v145
    v_cvt_pk_bf16_f32 v148, v142, v144
    s_add_u32 s57, s56, 0
    buffer_store_dword v148, v140, s[24:27], s57 offen
    v_accvgpr_read_b32 v142, a84
    v_accvgpr_read_b32 v143, a85
    v_accvgpr_read_b32 v144, a86
    v_accvgpr_read_b32 v145, a87
    v_cvt_pk_bf16_f32 v146, v142, v143
    v_cvt_pk_bf16_f32 v147, v144, v145
    v_lshlrev_b32 v142, 16, v146
    v_and_b32 v143, s55, v146
    v_lshlrev_b32 v144, 16, v147
    v_and_b32 v145, s55, v147
    v_mul_f32 v142, v142, v143
    v_mul_f32 v144, v144, v145
    v_cvt_pk_bf16_f32 v149, v142, v144
    s_add_u32 s57, s56, 57344
    buffer_store_dword v149, v140, s[24:27], s57 offen
    v_accvgpr_read_b32 v142, a88
    v_accvgpr_read_b32 v143, a89
    v_accvgpr_read_b32 v144, a90
    v_accvgpr_read_b32 v145, a91
    v_cvt_pk_bf16_f32 v146, v142, v143
    v_cvt_pk_bf16_f32 v147, v144, v145
    v_lshlrev_b32 v142, 16, v146
    v_and_b32 v143, s55, v146
    v_lshlrev_b32 v144, 16, v147
    v_and_b32 v145, s55, v147
    v_mul_f32 v142, v142, v143
    v_mul_f32 v144, v144, v145
    v_cvt_pk_bf16_f32 v150, v142, v144
    s_add_u32 s57, s56, 114688
    buffer_store_dword v150, v140, s[24:27], s57 offen
    v_accvgpr_read_b32 v142, a92
    v_accvgpr_read_b32 v143, a93
    v_accvgpr_read_b32 v144, a94
    v_accvgpr_read_b32 v145, a95
    v_cvt_pk_bf16_f32 v146, v142, v143
    v_cvt_pk_bf16_f32 v147, v144, v145
    v_lshlrev_b32 v142, 16, v146
    v_and_b32 v143, s55, v146
    v_lshlrev_b32 v144, 16, v147
    v_and_b32 v145, s55, v147
    v_mul_f32 v142, v142, v143
    v_mul_f32 v144, v144, v145
    v_cvt_pk_bf16_f32 v151, v142, v144
    s_add_u32 s57, s56, 172032
    buffer_store_dword v151, v140, s[24:27], s57 offen
    s_add_u32 s56, s52, 2
    s_lshl_b32 s56, s56, 8
    s_add_u32 s56, s56, s53
    v_accvgpr_read_b32 v142, a96
    v_accvgpr_read_b32 v143, a97
    v_accvgpr_read_b32 v144, a98
    v_accvgpr_read_b32 v145, a99
    v_cvt_pk_bf16_f32 v146, v142, v143
    v_cvt_pk_bf16_f32 v147, v144, v145
    v_lshlrev_b32 v142, 16, v146
    v_and_b32 v143, s55, v146
    v_lshlrev_b32 v144, 16, v147
    v_and_b32 v145, s55, v147
    v_mul_f32 v142, v142, v143
    v_mul_f32 v144, v144, v145
    v_cvt_pk_bf16_f32 v148, v142, v144
    s_add_u32 s57, s56, 0
    buffer_store_dword v148, v140, s[24:27], s57 offen
    v_accvgpr_read_b32 v142, a100
    v_accvgpr_read_b32 v143, a101
    v_accvgpr_read_b32 v144, a102
    v_accvgpr_read_b32 v145, a103
    v_cvt_pk_bf16_f32 v146, v142, v143
    v_cvt_pk_bf16_f32 v147, v144, v145
    v_lshlrev_b32 v142, 16, v146
    v_and_b32 v143, s55, v146
    v_lshlrev_b32 v144, 16, v147
    v_and_b32 v145, s55, v147
    v_mul_f32 v142, v142, v143
    v_mul_f32 v144, v144, v145
    v_cvt_pk_bf16_f32 v149, v142, v144
    s_add_u32 s57, s56, 57344
    buffer_store_dword v149, v140, s[24:27], s57 offen
    v_accvgpr_read_b32 v142, a104
    v_accvgpr_read_b32 v143, a105
    v_accvgpr_read_b32 v144, a106
    v_accvgpr_read_b32 v145, a107
    v_cvt_pk_bf16_f32 v146, v142, v143
    v_cvt_pk_bf16_f32 v147, v144, v145
    v_lshlrev_b32 v142, 16, v146
    v_and_b32 v143, s55, v146
    v_lshlrev_b32 v144, 16, v147
    v_and_b32 v145, s55, v147
    v_mul_f32 v142, v142, v143
    v_mul_f32 v144, v144, v145
    v_cvt_pk_bf16_f32 v150, v142, v144
    s_add_u32 s57, s56, 114688
    buffer_store_dword v150, v140, s[24:27], s57 offen
    v_accvgpr_read_b32 v142, a108
    v_accvgpr_read_b32 v143, a109
    v_accvgpr_read_b32 v144, a110
    v_accvgpr_read_b32 v145, a111
    v_cvt_pk_bf16_f32 v146, v142, v143
    v_cvt_pk_bf16_f32 v147, v144, v145
    v_lshlrev_b32 v142, 16, v146
    v_and_b32 v143, s55, v146
    v_lshlrev_b32 v144, 16, v147
    v_and_b32 v145, s55, v147
    v_mul_f32 v142, v142, v143
    v_mul_f32 v144, v144, v145
    v_cvt_pk_bf16_f32 v151, v142, v144
    s_add_u32 s57, s56, 172032
    buffer_store_dword v151, v140, s[24:27], s57 offen
    s_add_u32 s56, s52, 3
    s_lshl_b32 s56, s56, 8
    s_add_u32 s56, s56, s53
    v_accvgpr_read_b32 v142, a112
    v_accvgpr_read_b32 v143, a113
    v_accvgpr_read_b32 v144, a114
    v_accvgpr_read_b32 v145, a115
    v_cvt_pk_bf16_f32 v146, v142, v143
    v_cvt_pk_bf16_f32 v147, v144, v145
    v_lshlrev_b32 v142, 16, v146
    v_and_b32 v143, s55, v146
    v_lshlrev_b32 v144, 16, v147
    v_and_b32 v145, s55, v147
    v_mul_f32 v142, v142, v143
    v_mul_f32 v144, v144, v145
    v_cvt_pk_bf16_f32 v148, v142, v144
    s_add_u32 s57, s56, 0
    buffer_store_dword v148, v140, s[24:27], s57 offen
    v_accvgpr_read_b32 v142, a116
    v_accvgpr_read_b32 v143, a117
    v_accvgpr_read_b32 v144, a118
    v_accvgpr_read_b32 v145, a119
    v_cvt_pk_bf16_f32 v146, v142, v143
    v_cvt_pk_bf16_f32 v147, v144, v145
    v_lshlrev_b32 v142, 16, v146
    v_and_b32 v143, s55, v146
    v_lshlrev_b32 v144, 16, v147
    v_and_b32 v145, s55, v147
    v_mul_f32 v142, v142, v143
    v_mul_f32 v144, v144, v145
    v_cvt_pk_bf16_f32 v149, v142, v144
    s_add_u32 s57, s56, 57344
    buffer_store_dword v149, v140, s[24:27], s57 offen
    v_accvgpr_read_b32 v142, a120
    v_accvgpr_read_b32 v143, a121
    v_accvgpr_read_b32 v144, a122
    v_accvgpr_read_b32 v145, a123
    v_cvt_pk_bf16_f32 v146, v142, v143
    v_cvt_pk_bf16_f32 v147, v144, v145
    v_lshlrev_b32 v142, 16, v146
    v_and_b32 v143, s55, v146
    v_lshlrev_b32 v144, 16, v147
    v_and_b32 v145, s55, v147
    v_mul_f32 v142, v142, v143
    v_mul_f32 v144, v144, v145
    v_cvt_pk_bf16_f32 v150, v142, v144
    s_add_u32 s57, s56, 114688
    buffer_store_dword v150, v140, s[24:27], s57 offen
    v_accvgpr_read_b32 v142, a124
    v_accvgpr_read_b32 v143, a125
    v_accvgpr_read_b32 v144, a126
    v_accvgpr_read_b32 v145, a127
    v_cvt_pk_bf16_f32 v146, v142, v143
    v_cvt_pk_bf16_f32 v147, v144, v145
    v_lshlrev_b32 v142, 16, v146
    v_and_b32 v143, s55, v146
    v_lshlrev_b32 v144, 16, v147
    v_and_b32 v145, s55, v147
    v_mul_f32 v142, v142, v143
    v_mul_f32 v144, v144, v145
    v_cvt_pk_bf16_f32 v151, v142, v144
    s_add_u32 s57, s56, 172032
    buffer_store_dword v151, v140, s[24:27], s57 offen
    s_add_u32 s56, s52, 4
    s_lshl_b32 s56, s56, 8
    s_add_u32 s56, s56, s53
    v_accvgpr_read_b32 v142, a128
    v_accvgpr_read_b32 v143, a129
    v_accvgpr_read_b32 v144, a130
    v_accvgpr_read_b32 v145, a131
    v_cvt_pk_bf16_f32 v146, v142, v143
    v_cvt_pk_bf16_f32 v147, v144, v145
    v_lshlrev_b32 v142, 16, v146
    v_and_b32 v143, s55, v146
    v_lshlrev_b32 v144, 16, v147
    v_and_b32 v145, s55, v147
    v_mul_f32 v142, v142, v143
    v_mul_f32 v144, v144, v145
    v_cvt_pk_bf16_f32 v148, v142, v144
    s_add_u32 s57, s56, 0
    buffer_store_dword v148, v140, s[24:27], s57 offen
    v_accvgpr_read_b32 v142, a132
    v_accvgpr_read_b32 v143, a133
    v_accvgpr_read_b32 v144, a134
    v_accvgpr_read_b32 v145, a135
    v_cvt_pk_bf16_f32 v146, v142, v143
    v_cvt_pk_bf16_f32 v147, v144, v145
    v_lshlrev_b32 v142, 16, v146
    v_and_b32 v143, s55, v146
    v_lshlrev_b32 v144, 16, v147
    v_and_b32 v145, s55, v147
    v_mul_f32 v142, v142, v143
    v_mul_f32 v144, v144, v145
    v_cvt_pk_bf16_f32 v149, v142, v144
    s_add_u32 s57, s56, 57344
    buffer_store_dword v149, v140, s[24:27], s57 offen
    v_accvgpr_read_b32 v142, a136
    v_accvgpr_read_b32 v143, a137
    v_accvgpr_read_b32 v144, a138
    v_accvgpr_read_b32 v145, a139
    v_cvt_pk_bf16_f32 v146, v142, v143
    v_cvt_pk_bf16_f32 v147, v144, v145
    v_lshlrev_b32 v142, 16, v146
    v_and_b32 v143, s55, v146
    v_lshlrev_b32 v144, 16, v147
    v_and_b32 v145, s55, v147
    v_mul_f32 v142, v142, v143
    v_mul_f32 v144, v144, v145
    v_cvt_pk_bf16_f32 v150, v142, v144
    s_add_u32 s57, s56, 114688
    buffer_store_dword v150, v140, s[24:27], s57 offen
    v_accvgpr_read_b32 v142, a140
    v_accvgpr_read_b32 v143, a141
    v_accvgpr_read_b32 v144, a142
    v_accvgpr_read_b32 v145, a143
    v_cvt_pk_bf16_f32 v146, v142, v143
    v_cvt_pk_bf16_f32 v147, v144, v145
    v_lshlrev_b32 v142, 16, v146
    v_and_b32 v143, s55, v146
    v_lshlrev_b32 v144, 16, v147
    v_and_b32 v145, s55, v147
    v_mul_f32 v142, v142, v143
    v_mul_f32 v144, v144, v145
    v_cvt_pk_bf16_f32 v151, v142, v144
    s_add_u32 s57, s56, 172032
    buffer_store_dword v151, v140, s[24:27], s57 offen
    s_lshl_b32 s61, 1, s58
    s_sub_u32 s61, s61, 1
    s_mov_b32 s84, 0
K1_poll:
    buffer_load_dword v118, v117, s[32:35], 0 offen sc1
    s_waitcnt vmcnt(0)
    v_readfirstlane_b32 s85, v118
    s_and_b32 s85, s85, s61
    s_cmp_eq_u32 s85, s61
    s_cbranch_scc1 K1_polled
    s_add_u32 s84, s84, 1
    s_cmp_ge_u32 s84, 0x400000
    s_cbranch_scc1 K1_polled
    s_sleep 2
    s_branch K1_poll
K1_polled:
    s_mov_b32 s86, 0
    buffer_load_dwordx2 v[32:33], v115, s[28:31], s86 offen sc1
    s_mov_b32 s87, 4096
    buffer_load_dwordx2 v[34:35], v115, s[28:31], s87 offen sc1
    s_mov_b32 s86, 8192
    buffer_load_dwordx2 v[36:37], v115, s[28:31], s86 offen sc1
    s_mov_b32 s87, 12288
    buffer_load_dwordx2 v[38:39], v115, s[28:31], s87 offen sc1
    s_mov_b32 s86, 16384
    buffer_load_dwordx2 v[40:41], v115, s[28:31], s86 offen sc1
    s_mov_b32 s87, 20480
    buffer_load_dwordx2 v[42:43], v115, s[28:31], s87 offen sc1
    s_mov_b32 s86, 24576
    buffer_load_dwordx2 v[44:45], v115, s[28:31], s86 offen sc1
    s_mov_b32 s87, 28672
    buffer_load_dwordx2 v[46:47], v115, s[28:31], s87 offen sc1
    s_mov_b32 s86, 32768
    buffer_load_dwordx2 v[48:49], v115, s[28:31], s86 offen sc1
    s_mov_b32 s87, 36864
    buffer_load_dwordx2 v[50:51], v115, s[28:31], s87 offen sc1
    s_mov_b32 s86, 40960
    buffer_load_dwordx2 v[52:53], v115, s[28:31], s86 offen sc1
    s_mov_b32 s87, 45056
    buffer_load_dwordx2 v[54:55], v115, s[28:31], s87 offen sc1
    s_mov_b32 s86, 49152
    buffer_load_dwordx2 v[56:57], v115, s[28:31], s86 offen sc1
    s_mov_b32 s87, 53248
    buffer_load_dwordx2 v[58:59], v115, s[28:31], s87 offen sc1
    s_mov_b32 s86, 57344
    buffer_load_dwordx2 v[60:61], v115, s[28:31], s86 offen sc1
    s_mov_b32 s87, 61440
    buffer_load_dwordx2 v[62:63], v115, s[28:31], s87 offen sc1
    s_mov_b32 s86, 65536
    buffer_load_dwordx2 v[64:65], v115, s[28:31], s86 offen sc1
    s_mov_b32 s87, 69632
    buffer_load_dwordx2 v[66:67], v115, s[28:31], s87 offen sc1
    s_mov_b32 s86, 73728
    buffer_load_dwordx2 v[68:69], v115, s[28:31], s86 offen sc1
    s_mov_b32 s87, 77824
    buffer_load_dwordx2 v[70:71], v115, s[28:31], s87 offen sc1
    s_mov_b32 s86, 81920
    buffer_load_dwordx2 v[72:73], v115, s[28:31], s86 offen sc1
    s_mov_b32 s87, 86016
    buffer_load_dwordx2 v[74:75], v115, s[28:31], s87 offen sc1
    s_mov_b32 s86, 90112
    buffer_load_dwordx2 v[76:77], v115, s[28:31], s86 offen sc1
    s_mov_b32 s87, 94208
    buffer_load_dwordx2 v[78:79], v115, s[28:31], s87 offen sc1
    s_mov_b32 s86, 98304
    buffer_load_dwordx2 v[80:81], v115, s[28:31], s86 offen sc1
    s_mov_b32 s87, 102400
    buffer_load_dwordx2 v[82:83], v115, s[28:31], s87 offen sc1
    s_mov_b32 s86, 106496
    buffer_load_dwordx2 v[84:85], v115, s[28:31], s86 offen sc1
    s_mov_b32 s87, 110592
    buffer_load_dwordx2 v[86:87], v115, s[28:31], s87 offen sc1
    s_mov_b32 s86, 114688
    buffer_load_dwordx2 v[88:89], v115, s[28:31], s86 offen sc1
    s_mov_b32 s87, 118784
    buffer_load_dwordx2 v[90:91], v115, s[28:31], s87 offen sc1
    s_mov_b32 s86, 122880
    buffer_load_dwordx2 v[92:93], v115, s[28:31], s86 offen sc1
    v_mov_b32 v120, v102
    v_mov_b32 v121, v103
    v_mul_f32 v122, v121, v121
    v_mul_f32 v123, v120, v121
    v_fma_f32 v120, v120, v120, -v122
    v_add_f32 v121, v123, v123
    v_mul_f32 v122, v121, v121
    v_mul_f32 v123, v120, v121
    v_fma_f32 v120, v120, v120, -v122
    v_add_f32 v121, v123, v123
    v_mul_f32 v122, v121, v121
    v_mul_f32 v123, v120, v121
    v_fma_f32 v120, v120, v120, -v122
    v_add_f32 v121, v123, v123
    v_mul_f32 v122, v121, v121
    v_mul_f32 v123, v120, v121
    v_fma_f32 v120, v120, v120, -v122
    v_add_f32 v121, v123, v123
    v_mul_f32 v122, v121, v121
    v_mul_f32 v123, v120, v121
    v_fma_f32 v120, v120, v120, -v122
    v_add_f32 v121, v123, v123
    v_mul_f32 v122, v121, v121
    v_mul_f32 v123, v120, v121
    v_fma_f32 v120, v120, v120, -v122
    v_add_f32 v121, v123, v123
    v_mov_b32 v96, 0
    v_mov_b32 v97, 0
    s_waitcnt vmcnt(0)
    s_cmp_le_u32 s58, 0
    s_cbranch_scc1 K1_carry_done
    v_fma_f32 v98, v120, v96, v32
    v_fma_f32 v99, v120, v97, v33
    v_fma_f32 v98, -v121, v97, v98
    v_fma_f32 v97, v121, v96, v99
    v_mov_b32 v96, v98
    s_cmp_le_u32 s58, 1
    s_cbranch_scc1 K1_carry_done
    v_fma_f32 v98, v120, v96, v34
    v_fma_f32 v99, v120, v97, v35
    v_fma_f32 v98, -v121, v97, v98
    v_fma_f32 v97, v121, v96, v99
    v_mov_b32 v96, v98
    s_cmp_le_u32 s58, 2
    s_cbranch_scc1 K1_carry_done
    v_fma_f32 v98, v120, v96, v36
    v_fma_f32 v99, v120, v97, v37
    v_fma_f32 v98, -v121, v97, v98
    v_fma_f32 v97, v121, v96, v99
    v_mov_b32 v96, v98
    s_cmp_le_u32 s58, 3
    s_cbranch_scc1 K1_carry_done
    v_fma_f32 v98, v120, v96, v38
    v_fma_f32 v99, v120, v97, v39
    v_fma_f32 v98, -v121, v97, v98
    v_fma_f32 v97, v121, v96, v99
    v_mov_b32 v96, v98
    s_cmp_le_u32 s58, 4
    s_cbranch_scc1 K1_carry_done
    v_fma_f32 v98, v120, v96, v40
    v_fma_f32 v99, v120, v97, v41
    v_fma_f32 v98, -v121, v97, v98
    v_fma_f32 v97, v121, v96, v99
    v_mov_b32 v96, v98
    s_cmp_le_u32 s58, 5
    s_cbranch_scc1 K1_carry_done
    v_fma_f32 v98, v120, v96, v42
    v_fma_f32 v99, v120, v97, v43
    v_fma_f32 v98, -v121, v97, v98
    v_fma_f32 v97, v121, v96, v99
    v_mov_b32 v96, v98
    s_cmp_le_u32 s58, 6
    s_cbranch_scc1 K1_carry_done
    v_fma_f32 v98, v120, v96, v44
    v_fma_f32 v99, v120, v97, v45
    v_fma_f32 v98, -v121, v97, v98
    v_fma_f32 v97, v121, v96, v99
    v_mov_b32 v96, v98
    s_cmp_le_u32 s58, 7
    s_cbranch_scc1 K1_carry_done
    v_fma_f32 v98, v120, v96, v46
    v_fma_f32 v99, v120, v97, v47
    v_fma_f32 v98, -v121, v97, v98
    v_fma_f32 v97, v121, v96, v99
    v_mov_b32 v96, v98
    s_cmp_le_u32 s58, 8
    s_cbranch_scc1 K1_carry_done
    v_fma_f32 v98, v120, v96, v48
    v_fma_f32 v99, v120, v97, v49
    v_fma_f32 v98, -v121, v97, v98
    v_fma_f32 v97, v121, v96, v99
    v_mov_b32 v96, v98
    s_cmp_le_u32 s58, 9
    s_cbranch_scc1 K1_carry_done
    v_fma_f32 v98, v120, v96, v50
    v_fma_f32 v99, v120, v97, v51
    v_fma_f32 v98, -v121, v97, v98
    v_fma_f32 v97, v121, v96, v99
    v_mov_b32 v96, v98
    s_cmp_le_u32 s58, 10
    s_cbranch_scc1 K1_carry_done
    v_fma_f32 v98, v120, v96, v52
    v_fma_f32 v99, v120, v97, v53
    v_fma_f32 v98, -v121, v97, v98
    v_fma_f32 v97, v121, v96, v99
    v_mov_b32 v96, v98
    s_cmp_le_u32 s58, 11
    s_cbranch_scc1 K1_carry_done
    v_fma_f32 v98, v120, v96, v54
    v_fma_f32 v99, v120, v97, v55
    v_fma_f32 v98, -v121, v97, v98
    v_fma_f32 v97, v121, v96, v99
    v_mov_b32 v96, v98
    s_cmp_le_u32 s58, 12
    s_cbranch_scc1 K1_carry_done
    v_fma_f32 v98, v120, v96, v56
    v_fma_f32 v99, v120, v97, v57
    v_fma_f32 v98, -v121, v97, v98
    v_fma_f32 v97, v121, v96, v99
    v_mov_b32 v96, v98
    s_cmp_le_u32 s58, 13
    s_cbranch_scc1 K1_carry_done
    v_fma_f32 v98, v120, v96, v58
    v_fma_f32 v99, v120, v97, v59
    v_fma_f32 v98, -v121, v97, v98
    v_fma_f32 v97, v121, v96, v99
    v_mov_b32 v96, v98
    s_cmp_le_u32 s58, 14
    s_cbranch_scc1 K1_carry_done
    v_fma_f32 v98, v120, v96, v60
    v_fma_f32 v99, v120, v97, v61
    v_fma_f32 v98, -v121, v97, v98
    v_fma_f32 v97, v121, v96, v99
    v_mov_b32 v96, v98
    s_cmp_le_u32 s58, 15
    s_cbranch_scc1 K1_carry_done
    v_fma_f32 v98, v120, v96, v62
    v_fma_f32 v99, v120, v97, v63
    v_fma_f32 v98, -v121, v97, v98
    v_fma_f32 v97, v121, v96, v99
    v_mov_b32 v96, v98
    s_cmp_le_u32 s58, 16
    s_cbranch_scc1 K1_carry_done
    v_fma_f32 v98, v120, v96, v64
    v_fma_f32 v99, v120, v97, v65
    v_fma_f32 v98, -v121, v97, v98
    v_fma_f32 v97, v121, v96, v99
    v_mov_b32 v96, v98
    s_cmp_le_u32 s58, 17
    s_cbranch_scc1 K1_carry_done
    v_fma_f32 v98, v120, v96, v66
    v_fma_f32 v99, v120, v97, v67
    v_fma_f32 v98, -v121, v97, v98
    v_fma_f32 v97, v121, v96, v99
    v_mov_b32 v96, v98
    s_cmp_le_u32 s58, 18
    s_cbranch_scc1 K1_carry_done
    v_fma_f32 v98, v120, v96, v68
    v_fma_f32 v99, v120, v97, v69
    v_fma_f32 v98, -v121, v97, v98
    v_fma_f32 v97, v121, v96, v99
    v_mov_b32 v96, v98
    s_cmp_le_u32 s58, 19
    s_cbranch_scc1 K1_carry_done
    v_fma_f32 v98, v120, v96, v70
    v_fma_f32 v99, v120, v97, v71
    v_fma_f32 v98, -v121, v97, v98
    v_fma_f32 v97, v121, v96, v99
    v_mov_b32 v96, v98
    s_cmp_le_u32 s58, 20
    s_cbranch_scc1 K1_carry_done
    v_fma_f32 v98, v120, v96, v72
    v_fma_f32 v99, v120, v97, v73
    v_fma_f32 v98, -v121, v97, v98
    v_fma_f32 v97, v121, v96, v99
    v_mov_b32 v96, v98
    s_cmp_le_u32 s58, 21
    s_cbranch_scc1 K1_carry_done
    v_fma_f32 v98, v120, v96, v74
    v_fma_f32 v99, v120, v97, v75
    v_fma_f32 v98, -v121, v97, v98
    v_fma_f32 v97, v121, v96, v99
    v_mov_b32 v96, v98
    s_cmp_le_u32 s58, 22
    s_cbranch_scc1 K1_carry_done
    v_fma_f32 v98, v120, v96, v76
    v_fma_f32 v99, v120, v97, v77
    v_fma_f32 v98, -v121, v97, v98
    v_fma_f32 v97, v121, v96, v99
    v_mov_b32 v96, v98
    s_cmp_le_u32 s58, 23
    s_cbranch_scc1 K1_carry_done
    v_fma_f32 v98, v120, v96, v78
    v_fma_f32 v99, v120, v97, v79
    v_fma_f32 v98, -v121, v97, v98
    v_fma_f32 v97, v121, v96, v99
    v_mov_b32 v96, v98
    s_cmp_le_u32 s58, 24
    s_cbranch_scc1 K1_carry_done
    v_fma_f32 v98, v120, v96, v80
    v_fma_f32 v99, v120, v97, v81
    v_fma_f32 v98, -v121, v97, v98
    v_fma_f32 v97, v121, v96, v99
    v_mov_b32 v96, v98
    s_cmp_le_u32 s58, 25
    s_cbranch_scc1 K1_carry_done
    v_fma_f32 v98, v120, v96, v82
    v_fma_f32 v99, v120, v97, v83
    v_fma_f32 v98, -v121, v97, v98
    v_fma_f32 v97, v121, v96, v99
    v_mov_b32 v96, v98
    s_cmp_le_u32 s58, 26
    s_cbranch_scc1 K1_carry_done
    v_fma_f32 v98, v120, v96, v84
    v_fma_f32 v99, v120, v97, v85
    v_fma_f32 v98, -v121, v97, v98
    v_fma_f32 v97, v121, v96, v99
    v_mov_b32 v96, v98
    s_cmp_le_u32 s58, 27
    s_cbranch_scc1 K1_carry_done
    v_fma_f32 v98, v120, v96, v86
    v_fma_f32 v99, v120, v97, v87
    v_fma_f32 v98, -v121, v97, v98
    v_fma_f32 v97, v121, v96, v99
    v_mov_b32 v96, v98
    s_cmp_le_u32 s58, 28
    s_cbranch_scc1 K1_carry_done
    v_fma_f32 v98, v120, v96, v88
    v_fma_f32 v99, v120, v97, v89
    v_fma_f32 v98, -v121, v97, v98
    v_fma_f32 v97, v121, v96, v99
    v_mov_b32 v96, v98
    s_cmp_le_u32 s58, 29
    s_cbranch_scc1 K1_carry_done
    v_fma_f32 v98, v120, v96, v90
    v_fma_f32 v99, v120, v97, v91
    v_fma_f32 v98, -v121, v97, v98
    v_fma_f32 v97, v121, v96, v99
    v_mov_b32 v96, v98
    s_cmp_le_u32 s58, 30
    s_cbranch_scc1 K1_carry_done
    v_fma_f32 v98, v120, v96, v92
    v_fma_f32 v99, v120, v97, v93
    v_fma_f32 v98, -v121, v97, v98
    v_fma_f32 v97, v121, v96, v99
    v_mov_b32 v96, v98
K1_carry_done:
    ds_read_b64 v[32:33], v104 offset:0
    ds_read_b64 v[34:35], v104 offset:256
    ds_read_b64 v[36:37], v104 offset:512
    ds_read_b64 v[38:39], v104 offset:768
    ds_read_b64 v[40:41], v104 offset:1024
    ds_read_b64 v[42:43], v104 offset:1280
    ds_read_b64 v[44:45], v104 offset:1536
    ds_read_b64 v[46:47], v104 offset:1792
    ds_read_b64 v[48:49], v104 offset:2048
    ds_read_b64 v[50:51], v104 offset:2304
    ds_read_b64 v[52:53], v104 offset:2560
    ds_read_b64 v[54:55], v104 offset:2816
    ds_read_b64 v[56:57], v104 offset:3072
    ds_read_b64 v[58:59], v104 offset:3328
    ds_read_b64 v[60:61], v104 offset:3584
    ds_read_b64 v[62:63], v104 offset:3840
    ds_read_b64 v[64:65], v104 offset:4096
    ds_read_b64 v[66:67], v104 offset:4352
    ds_read_b64 v[68:69], v104 offset:4608
    ds_read_b64 v[70:71], v104 offset:4864
    ds_read_b64 v[72:73], v104 offset:5120
    ds_read_b64 v[74:75], v104 offset:5376
    ds_read_b64 v[76:77], v104 offset:5632
    ds_read_b64 v[78:79], v104 offset:5888
    ds_read_b64 v[80:81], v104 offset:6144
    ds_read_b64 v[82:83], v104 offset:6400
    ds_read_b64 v[84:85], v104 offset:6656
    ds_read_b64 v[86:87], v104 offset:6912
    ds_read_b64 v[88:89], v104 offset:7168
    ds_read_b64 v[90:91], v104 offset:7424
    ds_read_b64 v[92:93], v104 offset:7680
    ds_read_b64 v[94:95], v104 offset:7936
    s_waitcnt lgkmcnt(15)
    v_fma_f32 v98, v102, v96, v32
    v_fma_f32 v99, v102, v97, v33
    v_fma_f32 v98, -v103, v97, v98
    v_fma_f32 v99, v103, v96, v99
    v_cvt_pk_bf16_f32 v100, v98, v99
    ds_write_b32 v105, v100 offset:0
    s_waitcnt lgkmcnt(15)
    v_fma_f32 v96, v102, v98, v34
    v_fma_f32 v97, v102, v99, v35
    v_fma_f32 v96, -v103, v99, v96
    v_fma_f32 v97, v103, v98, v97
    v_cvt_pk_bf16_f32 v100, v96, v97
    ds_write_b32 v105, v100 offset:128
    s_waitcnt lgkmcnt(15)
    v_fma_f32 v98, v102, v96, v36
    v_fma_f32 v99, v102, v97, v37
    v_fma_f32 v98, -v103, v97, v98
    v_fma_f32 v99, v103, v96, v99
    v_cvt_pk_bf16_f32 v100, v98, v99
    ds_write_b32 v105, v100 offset:256
    s_waitcnt lgkmcnt(15)
    v_fma_f32 v96, v102, v98, v38
    v_fma_f32 v97, v102, v99, v39
    v_fma_f32 v96, -v103, v99, v96
    v_fma_f32 v97, v103, v98, v97
    v_cvt_pk_bf16_f32 v100, v96, v97
    ds_write_b32 v105, v100 offset:384
    s_waitcnt lgkmcnt(15)
    v_fma_f32 v98, v102, v96, v40
    v_fma_f32 v99, v102, v97, v41
    v_fma_f32 v98, -v103, v97, v98
    v_fma_f32 v99, v103, v96, v99
    v_cvt_pk_bf16_f32 v100, v98, v99
    ds_write_b32 v105, v100 offset:512
    s_waitcnt lgkmcnt(15)
    v_fma_f32 v96, v102, v98, v42
    v_fma_f32 v97, v102, v99, v43
    v_fma_f32 v96, -v103, v99, v96
    v_fma_f32 v97, v103, v98, v97
    v_cvt_pk_bf16_f32 v100, v96, v97
    ds_write_b32 v105, v100 offset:640
    s_waitcnt lgkmcnt(15)
    v_fma_f32 v98, v102, v96, v44
    v_fma_f32 v99, v102, v97, v45
    v_fma_f32 v98, -v103, v97, v98
    v_fma_f32 v99, v103, v96, v99
    v_cvt_pk_bf16_f32 v100, v98, v99
    ds_write_b32 v105, v100 offset:768
    s_waitcnt lgkmcnt(15)
    v_fma_f32 v96, v102, v98, v46
    v_fma_f32 v97, v102, v99, v47
    v_fma_f32 v96, -v103, v99, v96
    v_fma_f32 v97, v103, v98, v97
    v_cvt_pk_bf16_f32 v100, v96, v97
    ds_write_b32 v105, v100 offset:896
    s_waitcnt lgkmcnt(15)
    v_fma_f32 v98, v102, v96, v48
    v_fma_f32 v99, v102, v97, v49
    v_fma_f32 v98, -v103, v97, v98
    v_fma_f32 v99, v103, v96, v99
    v_cvt_pk_bf16_f32 v100, v98, v99
    ds_write_b32 v105, v100 offset:1024
    s_waitcnt lgkmcnt(15)
    v_fma_f32 v96, v102, v98, v50
    v_fma_f32 v97, v102, v99, v51
    v_fma_f32 v96, -v103, v99, v96
    v_fma_f32 v97, v103, v98, v97
    v_cvt_pk_bf16_f32 v100, v96, v97
    ds_write_b32 v105, v100 offset:1152
    s_waitcnt lgkmcnt(15)
    v_fma_f32 v98, v102, v96, v52
    v_fma_f32 v99, v102, v97, v53
    v_fma_f32 v98, -v103, v97, v98
    v_fma_f32 v99, v103, v96, v99
    v_cvt_pk_bf16_f32 v100, v98, v99
    ds_write_b32 v105, v100 offset:1280
    s_waitcnt lgkmcnt(15)
    v_fma_f32 v96, v102, v98, v54
    v_fma_f32 v97, v102, v99, v55
    v_fma_f32 v96, -v103, v99, v96
    v_fma_f32 v97, v103, v98, v97
    v_cvt_pk_bf16_f32 v100, v96, v97
    ds_write_b32 v105, v100 offset:1408
    s_waitcnt lgkmcnt(15)
    v_fma_f32 v98, v102, v96, v56
    v_fma_f32 v99, v102, v97, v57
    v_fma_f32 v98, -v103, v97, v98
    v_fma_f32 v99, v103, v96, v99
    v_cvt_pk_bf16_f32 v100, v98, v99
    ds_write_b32 v105, v100 offset:1536
    s_waitcnt lgkmcnt(15)
    v_fma_f32 v96, v102, v98, v58
    v_fma_f32 v97, v102, v99, v59
    v_fma_f32 v96, -v103, v99, v96
    v_fma_f32 v97, v103, v98, v97
    v_cvt_pk_bf16_f32 v100, v96, v97
    ds_write_b32 v105, v100 offset:1664
    s_waitcnt lgkmcnt(15)
    v_fma_f32 v98, v102, v96, v60
    v_fma_f32 v99, v102, v97, v61
    v_fma_f32 v98, -v103, v97, v98
    v_fma_f32 v99, v103, v96, v99
    v_cvt_pk_bf16_f32 v100, v98, v99
    ds_write_b32 v105, v100 offset:1792
    s_waitcnt lgkmcnt(15)
    v_fma_f32 v96, v102, v98, v62
    v_fma_f32 v97, v102, v99, v63
    v_fma_f32 v96, -v103, v99, v96
    v_fma_f32 v97, v103, v98, v97
    v_cvt_pk_bf16_f32 v100, v96, v97
    ds_write_b32 v105, v100 offset:1920
    ds_read_b64 v[32:33], v104 offset:8192
    ds_read_b64 v[34:35], v104 offset:8448
    ds_read_b64 v[36:37], v104 offset:8704
    ds_read_b64 v[38:39], v104 offset:8960
    ds_read_b64 v[40:41], v104 offset:9216
    ds_read_b64 v[42:43], v104 offset:9472
    ds_read_b64 v[44:45], v104 offset:9728
    ds_read_b64 v[46:47], v104 offset:9984
    ds_read_b64 v[48:49], v104 offset:10240
    ds_read_b64 v[50:51], v104 offset:10496
    ds_read_b64 v[52:53], v104 offset:10752
    ds_read_b64 v[54:55], v104 offset:11008
    ds_read_b64 v[56:57], v104 offset:11264
    ds_read_b64 v[58:59], v104 offset:11520
    ds_read_b64 v[60:61], v104 offset:11776
    ds_read_b64 v[62:63], v104 offset:12032
    s_waitcnt lgkmcnt(15)
    v_fma_f32 v98, v102, v96, v64
    v_fma_f32 v99, v102, v97, v65
    v_fma_f32 v98, -v103, v97, v98
    v_fma_f32 v99, v103, v96, v99
    v_cvt_pk_bf16_f32 v100, v98, v99
    ds_write_b32 v105, v100 offset:2048
    s_waitcnt lgkmcnt(15)
    v_fma_f32 v96, v102, v98, v66
    v_fma_f32 v97, v102, v99, v67
    v_fma_f32 v96, -v103, v99, v96
    v_fma_f32 v97, v103, v98, v97
    v_cvt_pk_bf16_f32 v100, v96, v97
    ds_write_b32 v105, v100 offset:2176
    s_waitcnt lgkmcnt(15)
    v_fma_f32 v98, v102, v96, v68
    v_fma_f32 v99, v102, v97, v69
    v_fma_f32 v98, -v103, v97, v98
    v_fma_f32 v99, v103, v96, v99
    v_cvt_pk_bf16_f32 v100, v98, v99
    ds_write_b32 v105, v100 offset:2304
    s_waitcnt lgkmcnt(15)
    v_fma_f32 v96, v102, v98, v70
    v_fma_f32 v97, v102, v99, v71
    v_fma_f32 v96, -v103, v99, v96
    v_fma_f32 v97, v103, v98, v97
    v_cvt_pk_bf16_f32 v100, v96, v97
    ds_write_b32 v105, v100 offset:2432
    s_waitcnt lgkmcnt(15)
    v_fma_f32 v98, v102, v96, v72
    v_fma_f32 v99, v102, v97, v73
    v_fma_f32 v98, -v103, v97, v98
    v_fma_f32 v99, v103, v96, v99
    v_cvt_pk_bf16_f32 v100, v98, v99
    ds_write_b32 v105, v100 offset:2560
    s_waitcnt lgkmcnt(15)
    v_fma_f32 v96, v102, v98, v74
    v_fma_f32 v97, v102, v99, v75
    v_fma_f32 v96, -v103, v99, v96
    v_fma_f32 v97, v103, v98, v97
    v_cvt_pk_bf16_f32 v100, v96, v97
    ds_write_b32 v105, v100 offset:2688
    s_waitcnt lgkmcnt(15)
    v_fma_f32 v98, v102, v96, v76
    v_fma_f32 v99, v102, v97, v77
    v_fma_f32 v98, -v103, v97, v98
    v_fma_f32 v99, v103, v96, v99
    v_cvt_pk_bf16_f32 v100, v98, v99
    ds_write_b32 v105, v100 offset:2816
    s_waitcnt lgkmcnt(15)
    v_fma_f32 v96, v102, v98, v78
    v_fma_f32 v97, v102, v99, v79
    v_fma_f32 v96, -v103, v99, v96
    v_fma_f32 v97, v103, v98, v97
    v_cvt_pk_bf16_f32 v100, v96, v97
    ds_write_b32 v105, v100 offset:2944
    s_waitcnt lgkmcnt(15)
    v_fma_f32 v98, v102, v96, v80
    v_fma_f32 v99, v102, v97, v81
    v_fma_f32 v98, -v103, v97, v98
    v_fma_f32 v99, v103, v96, v99
    v_cvt_pk_bf16_f32 v100, v98, v99
    ds_write_b32 v105, v100 offset:3072
    s_waitcnt lgkmcnt(15)
    v_fma_f32 v96, v102, v98, v82
    v_fma_f32 v97, v102, v99, v83
    v_fma_f32 v96, -v103, v99, v96
    v_fma_f32 v97, v103, v98, v97
    v_cvt_pk_bf16_f32 v100, v96, v97
    ds_write_b32 v105, v100 offset:3200
    s_waitcnt lgkmcnt(15)
    v_fma_f32 v98, v102, v96, v84
    v_fma_f32 v99, v102, v97, v85
    v_fma_f32 v98, -v103, v97, v98
    v_fma_f32 v99, v103, v96, v99
    v_cvt_pk_bf16_f32 v100, v98, v99
    ds_write_b32 v105, v100 offset:3328
    s_waitcnt lgkmcnt(15)
    v_fma_f32 v96, v102, v98, v86
    v_fma_f32 v97, v102, v99, v87
    v_fma_f32 v96, -v103, v99, v96
    v_fma_f32 v97, v103, v98, v97
    v_cvt_pk_bf16_f32 v100, v96, v97
    ds_write_b32 v105, v100 offset:3456
    s_waitcnt lgkmcnt(15)
    v_fma_f32 v98, v102, v96, v88
    v_fma_f32 v99, v102, v97, v89
    v_fma_f32 v98, -v103, v97, v98
    v_fma_f32 v99, v103, v96, v99
    v_cvt_pk_bf16_f32 v100, v98, v99
    ds_write_b32 v105, v100 offset:3584
    s_waitcnt lgkmcnt(15)
    v_fma_f32 v96, v102, v98, v90
    v_fma_f32 v97, v102, v99, v91
    v_fma_f32 v96, -v103, v99, v96
    v_fma_f32 v97, v103, v98, v97
    v_cvt_pk_bf16_f32 v100, v96, v97
    ds_write_b32 v105, v100 offset:3712
    s_waitcnt lgkmcnt(15)
    v_fma_f32 v98, v102, v96, v92
    v_fma_f32 v99, v102, v97, v93
    v_fma_f32 v98, -v103, v97, v98
    v_fma_f32 v99, v103, v96, v99
    v_cvt_pk_bf16_f32 v100, v98, v99
    ds_write_b32 v105, v100 offset:3840
    s_waitcnt lgkmcnt(15)
    v_fma_f32 v96, v102, v98, v94
    v_fma_f32 v97, v102, v99, v95
    v_fma_f32 v96, -v103, v99, v96
    v_fma_f32 v97, v103, v98, v97
    v_cvt_pk_bf16_f32 v100, v96, v97
    ds_write_b32 v105, v100 offset:3968
    ds_read_b64 v[64:65], v104 offset:12288
    ds_read_b64 v[66:67], v104 offset:12544
    ds_read_b64 v[68:69], v104 offset:12800
    ds_read_b64 v[70:71], v104 offset:13056
    ds_read_b64 v[72:73], v104 offset:13312
    ds_read_b64 v[74:75], v104 offset:13568
    ds_read_b64 v[76:77], v104 offset:13824
    ds_read_b64 v[78:79], v104 offset:14080
    ds_read_b64 v[80:81], v104 offset:14336
    ds_read_b64 v[82:83], v104 offset:14592
    ds_read_b64 v[84:85], v104 offset:14848
    ds_read_b64 v[86:87], v104 offset:15104
    ds_read_b64 v[88:89], v104 offset:15360
    ds_read_b64 v[90:91], v104 offset:15616
    ds_read_b64 v[92:93], v104 offset:15872
    ds_read_b64 v[94:95], v104 offset:16128
    s_waitcnt lgkmcnt(15)
    v_fma_f32 v98, v102, v96, v32
    v_fma_f32 v99, v102, v97, v33
    v_fma_f32 v98, -v103, v97, v98
    v_fma_f32 v99, v103, v96, v99
    v_cvt_pk_bf16_f32 v100, v98, v99
    ds_write_b32 v105, v100 offset:4096
    s_waitcnt lgkmcnt(15)
    v_fma_f32 v96, v102, v98, v34
    v_fma_f32 v97, v102, v99, v35
    v_fma_f32 v96, -v103, v99, v96
    v_fma_f32 v97, v103, v98, v97
    v_cvt_pk_bf16_f32 v100, v96, v97
    ds_write_b32 v105, v100 offset:4224
    s_waitcnt lgkmcnt(15)
    v_fma_f32 v98, v102, v96, v36
    v_fma_f32 v99, v102, v97, v37
    v_fma_f32 v98, -v103, v97, v98
    v_fma_f32 v99, v103, v96, v99
    v_cvt_pk_bf16_f32 v100, v98, v99
    ds_write_b32 v105, v100 offset:4352
    s_waitcnt lgkmcnt(15)
    v_fma_f32 v96, v102, v98, v38
    v_fma_f32 v97, v102, v99, v39
    v_fma_f32 v96, -v103, v99, v96
    v_fma_f32 v97, v103, v98, v97
    v_cvt_pk_bf16_f32 v100, v96, v97
    ds_write_b32 v105, v100 offset:4480
    s_waitcnt lgkmcnt(15)
    v_fma_f32 v98, v102, v96, v40
    v_fma_f32 v99, v102, v97, v41
    v_fma_f32 v98, -v103, v97, v98
    v_fma_f32 v99, v103, v96, v99
    v_cvt_pk_bf16_f32 v100, v98, v99
    ds_write_b32 v105, v100 offset:4608
    s_waitcnt lgkmcnt(15)
    v_fma_f32 v96, v102, v98, v42
    v_fma_f32 v97, v102, v99, v43
    v_fma_f32 v96, -v103, v99, v96
    v_fma_f32 v97, v103, v98, v97
    v_cvt_pk_bf16_f32 v100, v96, v97
    ds_write_b32 v105, v100 offset:4736
    s_waitcnt lgkmcnt(15)
    v_fma_f32 v98, v102, v96, v44
    v_fma_f32 v99, v102, v97, v45
    v_fma_f32 v98, -v103, v97, v98
    v_fma_f32 v99, v103, v96, v99
    v_cvt_pk_bf16_f32 v100, v98, v99
    ds_write_b32 v105, v100 offset:4864
    s_waitcnt lgkmcnt(15)
    v_fma_f32 v96, v102, v98, v46
    v_fma_f32 v97, v102, v99, v47
    v_fma_f32 v96, -v103, v99, v96
    v_fma_f32 v97, v103, v98, v97
    v_cvt_pk_bf16_f32 v100, v96, v97
    ds_write_b32 v105, v100 offset:4992
    s_waitcnt lgkmcnt(15)
    v_fma_f32 v98, v102, v96, v48
    v_fma_f32 v99, v102, v97, v49
    v_fma_f32 v98, -v103, v97, v98
    v_fma_f32 v99, v103, v96, v99
    v_cvt_pk_bf16_f32 v100, v98, v99
    ds_write_b32 v105, v100 offset:5120
    s_waitcnt lgkmcnt(15)
    v_fma_f32 v96, v102, v98, v50
    v_fma_f32 v97, v102, v99, v51
    v_fma_f32 v96, -v103, v99, v96
    v_fma_f32 v97, v103, v98, v97
    v_cvt_pk_bf16_f32 v100, v96, v97
    ds_write_b32 v105, v100 offset:5248
    s_waitcnt lgkmcnt(15)
    v_fma_f32 v98, v102, v96, v52
    v_fma_f32 v99, v102, v97, v53
    v_fma_f32 v98, -v103, v97, v98
    v_fma_f32 v99, v103, v96, v99
    v_cvt_pk_bf16_f32 v100, v98, v99
    ds_write_b32 v105, v100 offset:5376
    s_waitcnt lgkmcnt(15)
    v_fma_f32 v96, v102, v98, v54
    v_fma_f32 v97, v102, v99, v55
    v_fma_f32 v96, -v103, v99, v96
    v_fma_f32 v97, v103, v98, v97
    v_cvt_pk_bf16_f32 v100, v96, v97
    ds_write_b32 v105, v100 offset:5504
    s_waitcnt lgkmcnt(15)
    v_fma_f32 v98, v102, v96, v56
    v_fma_f32 v99, v102, v97, v57
    v_fma_f32 v98, -v103, v97, v98
    v_fma_f32 v99, v103, v96, v99
    v_cvt_pk_bf16_f32 v100, v98, v99
    ds_write_b32 v105, v100 offset:5632
    s_waitcnt lgkmcnt(15)
    v_fma_f32 v96, v102, v98, v58
    v_fma_f32 v97, v102, v99, v59
    v_fma_f32 v96, -v103, v99, v96
    v_fma_f32 v97, v103, v98, v97
    v_cvt_pk_bf16_f32 v100, v96, v97
    ds_write_b32 v105, v100 offset:5760
    s_waitcnt lgkmcnt(15)
    v_fma_f32 v98, v102, v96, v60
    v_fma_f32 v99, v102, v97, v61
    v_fma_f32 v98, -v103, v97, v98
    v_fma_f32 v99, v103, v96, v99
    v_cvt_pk_bf16_f32 v100, v98, v99
    ds_write_b32 v105, v100 offset:5888
    s_waitcnt lgkmcnt(15)
    v_fma_f32 v96, v102, v98, v62
    v_fma_f32 v97, v102, v99, v63
    v_fma_f32 v96, -v103, v99, v96
    v_fma_f32 v97, v103, v98, v97
    v_cvt_pk_bf16_f32 v100, v96, v97
    ds_write_b32 v105, v100 offset:6016
    s_waitcnt lgkmcnt(15)
    v_fma_f32 v98, v102, v96, v64
    v_fma_f32 v99, v102, v97, v65
    v_fma_f32 v98, -v103, v97, v98
    v_fma_f32 v99, v103, v96, v99
    v_cvt_pk_bf16_f32 v100, v98, v99
    ds_write_b32 v105, v100 offset:6144
    s_waitcnt lgkmcnt(14)
    v_fma_f32 v96, v102, v98, v66
    v_fma_f32 v97, v102, v99, v67
    v_fma_f32 v96, -v103, v99, v96
    v_fma_f32 v97, v103, v98, v97
    v_cvt_pk_bf16_f32 v100, v96, v97
    ds_write_b32 v105, v100 offset:6272
    s_waitcnt lgkmcnt(13)
    v_fma_f32 v98, v102, v96, v68
    v_fma_f32 v99, v102, v97, v69
    v_fma_f32 v98, -v103, v97, v98
    v_fma_f32 v99, v103, v96, v99
    v_cvt_pk_bf16_f32 v100, v98, v99
    ds_write_b32 v105, v100 offset:6400
    s_waitcnt lgkmcnt(12)
    v_fma_f32 v96, v102, v98, v70
    v_fma_f32 v97, v102, v99, v71
    v_fma_f32 v96, -v103, v99, v96
    v_fma_f32 v97, v103, v98, v97
    v_cvt_pk_bf16_f32 v100, v96, v97
    ds_write_b32 v105, v100 offset:6528
    s_waitcnt lgkmcnt(11)
    v_fma_f32 v98, v102, v96, v72
    v_fma_f32 v99, v102, v97, v73
    v_fma_f32 v98, -v103, v97, v98
    v_fma_f32 v99, v103, v96, v99
    v_cvt_pk_bf16_f32 v100, v98, v99
    ds_write_b32 v105, v100 offset:6656
    s_waitcnt lgkmcnt(10)
    v_fma_f32 v96, v102, v98, v74
    v_fma_f32 v97, v102, v99, v75
    v_fma_f32 v96, -v103, v99, v96
    v_fma_f32 v97, v103, v98, v97
    v_cvt_pk_bf16_f32 v100, v96, v97
    ds_write_b32 v105, v100 offset:6784
    s_waitcnt lgkmcnt(9)
    v_fma_f32 v98, v102, v96, v76
    v_fma_f32 v99, v102, v97, v77
    v_fma_f32 v98, -v103, v97, v98
    v_fma_f32 v99, v103, v96, v99
    v_cvt_pk_bf16_f32 v100, v98, v99
    ds_write_b32 v105, v100 offset:6912
    s_waitcnt lgkmcnt(8)
    v_fma_f32 v96, v102, v98, v78
    v_fma_f32 v97, v102, v99, v79
    v_fma_f32 v96, -v103, v99, v96
    v_fma_f32 v97, v103, v98, v97
    v_cvt_pk_bf16_f32 v100, v96, v97
    ds_write_b32 v105, v100 offset:7040
    s_waitcnt lgkmcnt(7)
    v_fma_f32 v98, v102, v96, v80
    v_fma_f32 v99, v102, v97, v81
    v_fma_f32 v98, -v103, v97, v98
    v_fma_f32 v99, v103, v96, v99
    v_cvt_pk_bf16_f32 v100, v98, v99
    ds_write_b32 v105, v100 offset:7168
    s_waitcnt lgkmcnt(6)
    v_fma_f32 v96, v102, v98, v82
    v_fma_f32 v97, v102, v99, v83
    v_fma_f32 v96, -v103, v99, v96
    v_fma_f32 v97, v103, v98, v97
    v_cvt_pk_bf16_f32 v100, v96, v97
    ds_write_b32 v105, v100 offset:7296
    s_waitcnt lgkmcnt(5)
    v_fma_f32 v98, v102, v96, v84
    v_fma_f32 v99, v102, v97, v85
    v_fma_f32 v98, -v103, v97, v98
    v_fma_f32 v99, v103, v96, v99
    v_cvt_pk_bf16_f32 v100, v98, v99
    ds_write_b32 v105, v100 offset:7424
    s_waitcnt lgkmcnt(4)
    v_fma_f32 v96, v102, v98, v86
    v_fma_f32 v97, v102, v99, v87
    v_fma_f32 v96, -v103, v99, v96
    v_fma_f32 v97, v103, v98, v97
    v_cvt_pk_bf16_f32 v100, v96, v97
    ds_write_b32 v105, v100 offset:7552
    s_waitcnt lgkmcnt(3)
    v_fma_f32 v98, v102, v96, v88
    v_fma_f32 v99, v102, v97, v89
    v_fma_f32 v98, -v103, v97, v98
    v_fma_f32 v99, v103, v96, v99
    v_cvt_pk_bf16_f32 v100, v98, v99
    ds_write_b32 v105, v100 offset:7680
    s_waitcnt lgkmcnt(2)
    v_fma_f32 v96, v102, v98, v90
    v_fma_f32 v97, v102, v99, v91
    v_fma_f32 v96, -v103, v99, v96
    v_fma_f32 v97, v103, v98, v97
    v_cvt_pk_bf16_f32 v100, v96, v97
    ds_write_b32 v105, v100 offset:7808
    s_waitcnt lgkmcnt(1)
    v_fma_f32 v98, v102, v96, v92
    v_fma_f32 v99, v102, v97, v93
    v_fma_f32 v98, -v103, v97, v98
    v_fma_f32 v99, v103, v96, v99
    v_cvt_pk_bf16_f32 v100, v98, v99
    ds_write_b32 v105, v100 offset:7936
    s_waitcnt lgkmcnt(0)
    v_fma_f32 v96, v102, v98, v94
    v_fma_f32 v97, v102, v99, v95
    v_fma_f32 v96, -v103, v99, v96
    v_fma_f32 v97, v103, v98, v97
    v_cvt_pk_bf16_f32 v100, v96, v97
    ds_write_b32 v105, v100 offset:8064
    s_waitcnt lgkmcnt(0)
    v_and_b32 v140, 15, v2
    v_lshlrev_b32 v140, 7, v140
    v_lshrrev_b32 v141, 4, v2
    v_lshl_add_u32 v140, v141, 4, v140
    s_add_u32 s60, s60, 16384
    v_add_u32 v140, s60, v140
    s_lshl_b32 s53, s6, 3
    s_lshl_b32 s54, s9, 2
    s_add_u32 s53, s53, s54
    s_lshl_b32 s53, s53, 15
    s_lshl_b32 s54, s7, 11
    s_add_u32 s53, s53, s54
    ds_read_b128 v[32:35], v140 offset:0
    ds_read_b128 v[36:39], v140 offset:64
    ds_read_b128 v[40:43], v140 offset:2048
    ds_read_b128 v[44:47], v140 offset:2112
    ds_read_b128 v[48:51], v140 offset:4096
    ds_read_b128 v[52:55], v140 offset:4160
    ds_read_b128 v[56:59], v140 offset:6144
    ds_read_b128 v[60:63], v140 offset:6208
    s_add_u32 s57, s53, 0
    s_waitcnt lgkmcnt(7)
    buffer_store_dwordx4 v[32:35], v3, s[20:23], s57 offen
    s_add_u32 s57, s53, 1024
    s_waitcnt lgkmcnt(6)
    buffer_store_dwordx4 v[36:39], v3, s[20:23], s57 offen
    s_add_u32 s57, s53, 32768
    s_waitcnt lgkmcnt(5)
    buffer_store_dwordx4 v[40:43], v3, s[20:23], s57 offen
    s_add_u32 s57, s53, 33792
    s_waitcnt lgkmcnt(4)
    buffer_store_dwordx4 v[44:47], v3, s[20:23], s57 offen
    s_add_u32 s57, s53, 65536
    s_waitcnt lgkmcnt(3)
    buffer_store_dwordx4 v[48:51], v3, s[20:23], s57 offen
    s_add_u32 s57, s53, 66560
    s_waitcnt lgkmcnt(2)
    buffer_store_dwordx4 v[52:55], v3, s[20:23], s57 offen
    s_add_u32 s57, s53, 98304
    s_waitcnt lgkmcnt(1)
    buffer_store_dwordx4 v[56:59], v3, s[20:23], s57 offen
    s_add_u32 s57, s53, 99328
    s_waitcnt lgkmcnt(0)
    buffer_store_dwordx4 v[60:63], v3, s[20:23], s57 offen
    s_endpgm
K1_main1:
    s_waitcnt vmcnt(21) lgkmcnt(0)
    s_barrier
    v_mfma_f32_16x16x32_bf16 a[0:3], v[48:51], v[32:35], 0
    s_mov_b32 s48, 5120
    v_mfma_f32_16x16x32_bf16 a[4:7], v[48:51], v[36:39], 0
    s_add_u32 m0, s44, 0
    v_mfma_f32_16x16x32_bf16 a[8:11], v[48:51], v[40:43], 0
    s_mov_b32 s49, 21504
    v_mfma_f32_16x16x32_bf16 a[12:15], v[48:51], v[44:47], 0
    buffer_load_dwordx4 v4, s[12:15], s48 offen lds
    v_mfma_f32_16x16x32_bf16 a[16:19], v[52:55], v[32:35], 0
    s_add_u32 m0, s44, 1024
    v_mfma_f32_16x16x32_bf16 a[20:23], v[52:55], v[36:39], 0
    s_mov_b32 s50, 92160
    v_mfma_f32_16x16x32_bf16 a[24:27], v[52:55], v[40:43], 0
    buffer_load_dwordx4 v4, s[12:15], s49 offen lds
    v_mfma_f32_16x16x32_bf16 a[28:31], v[52:55], v[44:47], 0
    s_add_u32 m0, s45, 0
    v_mfma_f32_16x16x32_bf16 a[32:35], v[56:59], v[32:35], 0
    s_nop 0
    v_mfma_f32_16x16x32_bf16 a[36:39], v[56:59], v[36:39], 0
    buffer_load_dwordx4 v5, s[16:19], s50 offen offset:0 lds
    v_mfma_f32_16x16x32_bf16 a[40:43], v[56:59], v[40:43], 0
    buffer_load_dwordx4 v5, s[16:19], s50 offen offset:1024 lds
    v_mfma_f32_16x16x32_bf16 a[44:47], v[56:59], v[44:47], 0
    buffer_load_dwordx4 v5, s[16:19], s50 offen offset:2048 lds
    v_mfma_f32_16x16x32_bf16 a[48:51], v[60:63], v[32:35], 0
    buffer_load_dwordx4 v5, s[16:19], s50 offen offset:3072 lds
    v_mfma_f32_16x16x32_bf16 a[52:55], v[60:63], v[36:39], 0
    s_add_u32 m0, s46, 0
    v_mfma_f32_16x16x32_bf16 a[56:59], v[60:63], v[40:43], 0
    s_nop 0
    v_mfma_f32_16x16x32_bf16 a[60:63], v[60:63], v[44:47], 0
    buffer_load_dwordx4 v6, s[16:19], s50 offen lds
    v_mfma_f32_16x16x32_bf16 a[64:67], v[64:67], v[32:35], 0
    ds_read_b128 v[84:87], v7 offset:26624
    v_mfma_f32_16x16x32_bf16 a[68:71], v[64:67], v[36:39], 0
    ds_read_b128 v[100:103], v10 offset:26624
    v_mfma_f32_16x16x32_bf16 a[72:75], v[64:67], v[40:43], 0
    ds_read_b128 v[88:91], v7 offset:27648
    v_mfma_f32_16x16x32_bf16 a[76:79], v[64:67], v[44:47], 0
    ds_read_b128 v[104:107], v10 offset:27648
    v_mfma_f32_16x16x32_bf16 a[80:83], v[68:71], v[32:35], 0
    ds_read_b128 v[92:95], v7 offset:28672
    v_mfma_f32_16x16x32_bf16 a[84:87], v[68:71], v[36:39], 0
    ds_read_b128 v[108:111], v10 offset:28672
    v_mfma_f32_16x16x32_bf16 a[88:91], v[68:71], v[40:43], 0
    ds_read_b128 v[96:99], v7 offset:29696
    v_mfma_f32_16x16x32_bf16 a[92:95], v[68:71], v[44:47], 0
    ds_read_b128 v[112:115], v10 offset:29696
    v_mfma_f32_16x16x32_bf16 a[96:99], v[72:75], v[32:35], 0
    ds_read_b128 v[116:119], v10 offset:30720
    v_mfma_f32_16x16x32_bf16 a[100:103], v[72:75], v[36:39], 0
    ds_read_b128 v[120:123], v10 offset:31744
    v_mfma_f32_16x16x32_bf16 a[104:107], v[72:75], v[40:43], 0
    ds_read_b128 v[124:127], v10 offset:32768
    v_mfma_f32_16x16x32_bf16 a[108:111], v[72:75], v[44:47], 0
    ds_read_b128 v[128:131], v10 offset:33792
    v_mfma_f32_16x16x32_bf16 a[112:115], v[76:79], v[32:35], 0
    ds_read_b128 v[132:135], v10 offset:34816
    v_mfma_f32_16x16x32_bf16 a[116:119], v[76:79], v[36:39], 0
    v_mfma_f32_16x16x32_bf16 a[120:123], v[76:79], v[40:43], 0
    v_mfma_f32_16x16x32_bf16 a[124:127], v[76:79], v[44:47], 0
    v_mfma_f32_16x16x32_bf16 a[128:131], v[80:83], v[32:35], 0
    v_mfma_f32_16x16x32_bf16 a[132:135], v[80:83], v[36:39], 0
    v_mfma_f32_16x16x32_bf16 a[136:139], v[80:83], v[40:43], 0
    v_mfma_f32_16x16x32_bf16 a[140:143], v[80:83], v[44:47], 0
    s_waitcnt vmcnt(21) lgkmcnt(0)
    s_barrier
    v_mfma_f32_16x16x32_bf16 a[0:3], v[100:103], v[84:87], a[0:3]
    s_mov_b32 s48, 6144
    v_mfma_f32_16x16x32_bf16 a[4:7], v[100:103], v[88:91], a[4:7]
    s_add_u32 m0, s44, 26624
    v_mfma_f32_16x16x32_bf16 a[8:11], v[100:103], v[92:95], a[8:11]
    s_mov_b32 s49, 22528
    v_mfma_f32_16x16x32_bf16 a[12:15], v[100:103], v[96:99], a[12:15]
    buffer_load_dwordx4 v4, s[12:15], s48 offen lds
    v_mfma_f32_16x16x32_bf16 a[16:19], v[104:107], v[84:87], a[16:19]
    s_add_u32 m0, s44, 27648
    v_mfma_f32_16x16x32_bf16 a[20:23], v[104:107], v[88:91], a[20:23]
    s_mov_b32 s50, 110592
    v_mfma_f32_16x16x32_bf16 a[24:27], v[104:107], v[92:95], a[24:27]
    buffer_load_dwordx4 v4, s[12:15], s49 offen lds
    v_mfma_f32_16x16x32_bf16 a[28:31], v[104:107], v[96:99], a[28:31]
    s_add_u32 m0, s45, 26624
    v_mfma_f32_16x16x32_bf16 a[32:35], v[108:111], v[84:87], a[32:35]
    s_nop 0
    v_mfma_f32_16x16x32_bf16 a[36:39], v[108:111], v[88:91], a[36:39]
    buffer_load_dwordx4 v5, s[16:19], s50 offen offset:0 lds
    v_mfma_f32_16x16x32_bf16 a[40:43], v[108:111], v[92:95], a[40:43]
    buffer_load_dwordx4 v5, s[16:19], s50 offen offset:1024 lds
    v_mfma_f32_16x16x32_bf16 a[44:47], v[108:111], v[96:99], a[44:47]
    buffer_load_dwordx4 v5, s[16:19], s50 offen offset:2048 lds
    v_mfma_f32_16x16x32_bf16 a[48:51], v[112:115], v[84:87], a[48:51]
    buffer_load_dwordx4 v5, s[16:19], s50 offen offset:3072 lds
    v_mfma_f32_16x16x32_bf16 a[52:55], v[112:115], v[88:91], a[52:55]
    s_add_u32 m0, s46, 26624
    v_mfma_f32_16x16x32_bf16 a[56:59], v[112:115], v[92:95], a[56:59]
    s_nop 0
    v_mfma_f32_16x16x32_bf16 a[60:63], v[112:115], v[96:99], a[60:63]
    buffer_load_dwordx4 v6, s[16:19], s50 offen lds
    v_mfma_f32_16x16x32_bf16 a[64:67], v[116:119], v[84:87], a[64:67]
    ds_read_b128 v[32:35], v8 offset:0
    v_mfma_f32_16x16x32_bf16 a[68:71], v[116:119], v[88:91], a[68:71]
    ds_read_b128 v[48:51], v11 offset:0
    v_mfma_f32_16x16x32_bf16 a[72:75], v[116:119], v[92:95], a[72:75]
    ds_read_b128 v[36:39], v8 offset:1024
    v_mfma_f32_16x16x32_bf16 a[76:79], v[116:119], v[96:99], a[76:79]
    ds_read_b128 v[52:55], v11 offset:1024
    v_mfma_f32_16x16x32_bf16 a[80:83], v[120:123], v[84:87], a[80:83]
    ds_read_b128 v[40:43], v8 offset:2048
    v_mfma_f32_16x16x32_bf16 a[84:87], v[120:123], v[88:91], a[84:87]
    ds_read_b128 v[56:59], v11 offset:2048
    v_mfma_f32_16x16x32_bf16 a[88:91], v[120:123], v[92:95], a[88:91]
    ds_read_b128 v[44:47], v8 offset:3072
    v_mfma_f32_16x16x32_bf16 a[92:95], v[120:123], v[96:99], a[92:95]
    ds_read_b128 v[60:63], v11 offset:3072
    v_mfma_f32_16x16x32_bf16 a[96:99], v[124:127], v[84:87], a[96:99]
    ds_read_b128 v[64:67], v11 offset:4096
    v_mfma_f32_16x16x32_bf16 a[100:103], v[124:127], v[88:91], a[100:103]
    ds_read_b128 v[68:71], v11 offset:5120
    v_mfma_f32_16x16x32_bf16 a[104:107], v[124:127], v[92:95], a[104:107]
    ds_read_b128 v[72:75], v11 offset:6144
    v_mfma_f32_16x16x32_bf16 a[108:111], v[124:127], v[96:99], a[108:111]
    ds_read_b128 v[76:79], v11 offset:7168
    v_mfma_f32_16x16x32_bf16 a[112:115], v[128:131], v[84:87], a[112:115]
    ds_read_b128 v[80:83], v11 offset:8192
    v_mfma_f32_16x16x32_bf16 a[116:119], v[128:131], v[88:91], a[116:119]
    v_mfma_f32_16x16x32_bf16 a[120:123], v[128:131], v[92:95], a[120:123]
    v_mfma_f32_16x16x32_bf16 a[124:127], v[128:131], v[96:99], a[124:127]
    v_mfma_f32_16x16x32_bf16 a[128:131], v[132:135], v[84:87], a[128:131]
    v_mfma_f32_16x16x32_bf16 a[132:135], v[132:135], v[88:91], a[132:135]
    v_mfma_f32_16x16x32_bf16 a[136:139], v[132:135], v[92:95], a[136:139]
    v_mfma_f32_16x16x32_bf16 a[140:143], v[132:135], v[96:99], a[140:143]
    s_waitcnt vmcnt(21) lgkmcnt(0)
    s_barrier
    v_mfma_f32_16x16x32_bf16 a[0:3], v[48:51], v[32:35], a[0:3]
    s_mov_b32 s48, 7168
    v_mfma_f32_16x16x32_bf16 a[4:7], v[48:51], v[36:39], a[4:7]
    s_add_u32 m0, s44, 53248
    v_mfma_f32_16x16x32_bf16 a[8:11], v[48:51], v[40:43], a[8:11]
    s_mov_b32 s49, 23552
    v_mfma_f32_16x16x32_bf16 a[12:15], v[48:51], v[44:47], a[12:15]
    buffer_load_dwordx4 v4, s[12:15], s48 offen lds
    v_mfma_f32_16x16x32_bf16 a[16:19], v[52:55], v[32:35], a[16:19]
    s_add_u32 m0, s44, 54272
    v_mfma_f32_16x16x32_bf16 a[20:23], v[52:55], v[36:39], a[20:23]
    s_mov_b32 s50, 129024
    v_mfma_f32_16x16x32_bf16 a[24:27], v[52:55], v[40:43], a[24:27]
    buffer_load_dwordx4 v4, s[12:15], s49 offen lds
    v_mfma_f32_16x16x32_bf16 a[28:31], v[52:55], v[44:47], a[28:31]
    s_add_u32 m0, s45, 53248
    v_mfma_f32_16x16x32_bf16 a[32:35], v[56:59], v[32:35], a[32:35]
    s_nop 0
    v_mfma_f32_16x16x32_bf16 a[36:39], v[56:59], v[36:39], a[36:39]
    buffer_load_dwordx4 v5, s[16:19], s50 offen offset:0 lds
    v_mfma_f32_16x16x32_bf16 a[40:43], v[56:59], v[40:43], a[40:43]
    buffer_load_dwordx4 v5, s[16:19], s50 offen offset:1024 lds
    v_mfma_f32_16x16x32_bf16 a[44:47], v[56:59], v[44:47], a[44:47]
    buffer_load_dwordx4 v5, s[16:19], s50 offen offset:2048 lds
    v_mfma_f32_16x16x32_bf16 a[48:51], v[60:63], v[32:35], a[48:51]
    buffer_load_dwordx4 v5, s[16:19], s50 offen offset:3072 lds
    v_mfma_f32_16x16x32_bf16 a[52:55], v[60:63], v[36:39], a[52:55]
    s_add_u32 m0, s46, 53248
    v_mfma_f32_16x16x32_bf16 a[56:59], v[60:63], v[40:43], a[56:59]
    s_nop 0
    v_mfma_f32_16x16x32_bf16 a[60:63], v[60:63], v[44:47], a[60:63]
    buffer_load_dwordx4 v6, s[16:19], s50 offen lds
    v_mfma_f32_16x16x32_bf16 a[64:67], v[64:67], v[32:35], a[64:67]
    ds_read_b128 v[84:87], v8 offset:26624
    v_mfma_f32_16x16x32_bf16 a[68:71], v[64:67], v[36:39], a[68:71]
    ds_read_b128 v[100:103], v11 offset:26624
    v_mfma_f32_16x16x32_bf16 a[72:75], v[64:67], v[40:43], a[72:75]
    ds_read_b128 v[88:91], v8 offset:27648
    v_mfma_f32_16x16x32_bf16 a[76:79], v[64:67], v[44:47], a[76:79]
    ds_read_b128 v[104:107], v11 offset:27648
    v_mfma_f32_16x16x32_bf16 a[80:83], v[68:71], v[32:35], a[80:83]
    ds_read_b128 v[92:95], v8 offset:28672
    v_mfma_f32_16x16x32_bf16 a[84:87], v[68:71], v[36:39], a[84:87]
    ds_read_b128 v[108:111], v11 offset:28672
    v_mfma_f32_16x16x32_bf16 a[88:91], v[68:71], v[40:43], a[88:91]
    ds_read_b128 v[96:99], v8 offset:29696
    v_mfma_f32_16x16x32_bf16 a[92:95], v[68:71], v[44:47], a[92:95]
    ds_read_b128 v[112:115], v11 offset:29696
    v_mfma_f32_16x16x32_bf16 a[96:99], v[72:75], v[32:35], a[96:99]
    ds_read_b128 v[116:119], v11 offset:30720
    v_mfma_f32_16x16x32_bf16 a[100:103], v[72:75], v[36:39], a[100:103]
    ds_read_b128 v[120:123], v11 offset:31744
    v_mfma_f32_16x16x32_bf16 a[104:107], v[72:75], v[40:43], a[104:107]
    ds_read_b128 v[124:127], v11 offset:32768
    v_mfma_f32_16x16x32_bf16 a[108:111], v[72:75], v[44:47], a[108:111]
    ds_read_b128 v[128:131], v11 offset:33792
    v_mfma_f32_16x16x32_bf16 a[112:115], v[76:79], v[32:35], a[112:115]
    ds_read_b128 v[132:135], v11 offset:34816
    v_mfma_f32_16x16x32_bf16 a[116:119], v[76:79], v[36:39], a[116:119]
    v_mfma_f32_16x16x32_bf16 a[120:123], v[76:79], v[40:43], a[120:123]
    v_mfma_f32_16x16x32_bf16 a[124:127], v[76:79], v[44:47], a[124:127]
    v_mfma_f32_16x16x32_bf16 a[128:131], v[80:83], v[32:35], a[128:131]
    v_mfma_f32_16x16x32_bf16 a[132:135], v[80:83], v[36:39], a[132:135]
    v_mfma_f32_16x16x32_bf16 a[136:139], v[80:83], v[40:43], a[136:139]
    v_mfma_f32_16x16x32_bf16 a[140:143], v[80:83], v[44:47], a[140:143]
    s_waitcnt vmcnt(21) lgkmcnt(0)
    s_barrier
    v_mfma_f32_16x16x32_bf16 a[0:3], v[100:103], v[84:87], a[0:3]
    s_mov_b32 s48, 8192
    v_mfma_f32_16x16x32_bf16 a[4:7], v[100:103], v[88:91], a[4:7]
    s_add_u32 m0, s44, 79872
    v_mfma_f32_16x16x32_bf16 a[8:11], v[100:103], v[92:95], a[8:11]
    s_mov_b32 s49, 24576
    v_mfma_f32_16x16x32_bf16 a[12:15], v[100:103], v[96:99], a[12:15]
    buffer_load_dwordx4 v4, s[12:15], s48 offen lds
    v_mfma_f32_16x16x32_bf16 a[16:19], v[104:107], v[84:87], a[16:19]
    s_add_u32 m0, s44, 80896
    v_mfma_f32_16x16x32_bf16 a[20:23], v[104:107], v[88:91], a[20:23]
    s_mov_b32 s50, 147456
    v_mfma_f32_16x16x32_bf16 a[24:27], v[104:107], v[92:95], a[24:27]
    buffer_load_dwordx4 v4, s[12:15], s49 offen lds
    v_mfma_f32_16x16x32_bf16 a[28:31], v[104:107], v[96:99], a[28:31]
    s_add_u32 m0, s45, 79872
    v_mfma_f32_16x16x32_bf16 a[32:35], v[108:111], v[84:87], a[32:35]
    s_nop 0
    v_mfma_f32_16x16x32_bf16 a[36:39], v[108:111], v[88:91], a[36:39]
    buffer_load_dwordx4 v5, s[16:19], s50 offen offset:0 lds
    v_mfma_f32_16x16x32_bf16 a[40:43], v[108:111], v[92:95], a[40:43]
    buffer_load_dwordx4 v5, s[16:19], s50 offen offset:1024 lds
    v_mfma_f32_16x16x32_bf16 a[44:47], v[108:111], v[96:99], a[44:47]
    buffer_load_dwordx4 v5, s[16:19], s50 offen offset:2048 lds
    v_mfma_f32_16x16x32_bf16 a[48:51], v[112:115], v[84:87], a[48:51]
    buffer_load_dwordx4 v5, s[16:19], s50 offen offset:3072 lds
    v_mfma_f32_16x16x32_bf16 a[52:55], v[112:115], v[88:91], a[52:55]
    s_add_u32 m0, s46, 79872
    v_mfma_f32_16x16x32_bf16 a[56:59], v[112:115], v[92:95], a[56:59]
    s_nop 0
    v_mfma_f32_16x16x32_bf16 a[60:63], v[112:115], v[96:99], a[60:63]
    buffer_load_dwordx4 v6, s[16:19], s50 offen lds
    v_mfma_f32_16x16x32_bf16 a[64:67], v[116:119], v[84:87], a[64:67]
    ds_read_b128 v[32:35], v9 offset:0
    v_mfma_f32_16x16x32_bf16 a[68:71], v[116:119], v[88:91], a[68:71]
    ds_read_b128 v[48:51], v12 offset:0
    v_mfma_f32_16x16x32_bf16 a[72:75], v[116:119], v[92:95], a[72:75]
    ds_read_b128 v[36:39], v9 offset:1024
    v_mfma_f32_16x16x32_bf16 a[76:79], v[116:119], v[96:99], a[76:79]
    ds_read_b128 v[52:55], v12 offset:1024
    v_mfma_f32_16x16x32_bf16 a[80:83], v[120:123], v[84:87], a[80:83]
    ds_read_b128 v[40:43], v9 offset:2048
    v_mfma_f32_16x16x32_bf16 a[84:87], v[120:123], v[88:91], a[84:87]
    ds_read_b128 v[56:59], v12 offset:2048
    v_mfma_f32_16x16x32_bf16 a[88:91], v[120:123], v[92:95], a[88:91]
    ds_read_b128 v[44:47], v9 offset:3072
    v_mfma_f32_16x16x32_bf16 a[92:95], v[120:123], v[96:99], a[92:95]
    ds_read_b128 v[60:63], v12 offset:3072
    v_mfma_f32_16x16x32_bf16 a[96:99], v[124:127], v[84:87], a[96:99]
    ds_read_b128 v[64:67], v12 offset:4096
    v_mfma_f32_16x16x32_bf16 a[100:103], v[124:127], v[88:91], a[100:103]
    ds_read_b128 v[68:71], v12 offset:5120
    v_mfma_f32_16x16x32_bf16 a[104:107], v[124:127], v[92:95], a[104:107]
    ds_read_b128 v[72:75], v12 offset:6144
    v_mfma_f32_16x16x32_bf16 a[108:111], v[124:127], v[96:99], a[108:111]
    ds_read_b128 v[76:79], v12 offset:7168
    v_mfma_f32_16x16x32_bf16 a[112:115], v[128:131], v[84:87], a[112:115]
    ds_read_b128 v[80:83], v12 offset:8192
    v_mfma_f32_16x16x32_bf16 a[116:119], v[128:131], v[88:91], a[116:119]
    v_mfma_f32_16x16x32_bf16 a[120:123], v[128:131], v[92:95], a[120:123]
    v_mfma_f32_16x16x32_bf16 a[124:127], v[128:131], v[96:99], a[124:127]
    v_mfma_f32_16x16x32_bf16 a[128:131], v[132:135], v[84:87], a[128:131]
    v_mfma_f32_16x16x32_bf16 a[132:135], v[132:135], v[88:91], a[132:135]
    v_mfma_f32_16x16x32_bf16 a[136:139], v[132:135], v[92:95], a[136:139]
    v_mfma_f32_16x16x32_bf16 a[140:143], v[132:135], v[96:99], a[140:143]
    s_waitcnt vmcnt(21) lgkmcnt(0)
    s_barrier
    v_mfma_f32_16x16x32_bf16 a[0:3], v[48:51], v[32:35], a[0:3]
    s_mov_b32 s48, 9216
    v_mfma_f32_16x16x32_bf16 a[4:7], v[48:51], v[36:39], a[4:7]
    s_add_u32 m0, s44, 106496
    v_mfma_f32_16x16x32_bf16 a[8:11], v[48:51], v[40:43], a[8:11]
    s_mov_b32 s49, 25600
    v_mfma_f32_16x16x32_bf16 a[12:15], v[48:51], v[44:47], a[12:15]
    buffer_load_dwordx4 v4, s[12:15], s48 offen lds
    v_mfma_f32_16x16x32_bf16 a[16:19], v[52:55], v[32:35], a[16:19]
    s_add_u32 m0, s44, 107520
    v_mfma_f32_16x16x32_bf16 a[20:23], v[52:55], v[36:39], a[20:23]
    s_mov_b32 s50, 165888
    v_mfma_f32_16x16x32_bf16 a[24:27], v[52:55], v[40:43], a[24:27]
    buffer_load_dwordx4 v4, s[12:15], s49 offen lds
    v_mfma_f32_16x16x32_bf16 a[28:31], v[52:55], v[44:47], a[28:31]
    s_add_u32 m0, s45, 106496
    v_mfma_f32_16x16x32_bf16 a[32:35], v[56:59], v[32:35], a[32:35]
    s_nop 0
    v_mfma_f32_16x16x32_bf16 a[36:39], v[56:59], v[36:39], a[36:39]
    buffer_load_dwordx4 v5, s[16:19], s50 offen offset:0 lds
    v_mfma_f32_16x16x32_bf16 a[40:43], v[56:59], v[40:43], a[40:43]
    buffer_load_dwordx4 v5, s[16:19], s50 offen offset:1024 lds
    v_mfma_f32_16x16x32_bf16 a[44:47], v[56:59], v[44:47], a[44:47]
    buffer_load_dwordx4 v5, s[16:19], s50 offen offset:2048 lds
    v_mfma_f32_16x16x32_bf16 a[48:51], v[60:63], v[32:35], a[48:51]
    buffer_load_dwordx4 v5, s[16:19], s50 offen offset:3072 lds
    v_mfma_f32_16x16x32_bf16 a[52:55], v[60:63], v[36:39], a[52:55]
    s_add_u32 m0, s46, 106496
    v_mfma_f32_16x16x32_bf16 a[56:59], v[60:63], v[40:43], a[56:59]
    s_nop 0
    v_mfma_f32_16x16x32_bf16 a[60:63], v[60:63], v[44:47], a[60:63]
    buffer_load_dwordx4 v6, s[16:19], s50 offen lds
    v_mfma_f32_16x16x32_bf16 a[64:67], v[64:67], v[32:35], a[64:67]
    ds_read_b128 v[84:87], v7 offset:0
    v_mfma_f32_16x16x32_bf16 a[68:71], v[64:67], v[36:39], a[68:71]
    ds_read_b128 v[100:103], v10 offset:0
    v_mfma_f32_16x16x32_bf16 a[72:75], v[64:67], v[40:43], a[72:75]
    ds_read_b128 v[88:91], v7 offset:1024
    v_mfma_f32_16x16x32_bf16 a[76:79], v[64:67], v[44:47], a[76:79]
    ds_read_b128 v[104:107], v10 offset:1024
    v_mfma_f32_16x16x32_bf16 a[80:83], v[68:71], v[32:35], a[80:83]
    ds_read_b128 v[92:95], v7 offset:2048
    v_mfma_f32_16x16x32_bf16 a[84:87], v[68:71], v[36:39], a[84:87]
    ds_read_b128 v[108:111], v10 offset:2048
    v_mfma_f32_16x16x32_bf16 a[88:91], v[68:71], v[40:43], a[88:91]
    ds_read_b128 v[96:99], v7 offset:3072
    v_mfma_f32_16x16x32_bf16 a[92:95], v[68:71], v[44:47], a[92:95]
    ds_read_b128 v[112:115], v10 offset:3072
    v_mfma_f32_16x16x32_bf16 a[96:99], v[72:75], v[32:35], a[96:99]
    ds_read_b128 v[116:119], v10 offset:4096
    v_mfma_f32_16x16x32_bf16 a[100:103], v[72:75], v[36:39], a[100:103]
    ds_read_b128 v[120:123], v10 offset:5120
    v_mfma_f32_16x16x32_bf16 a[104:107], v[72:75], v[40:43], a[104:107]
    ds_read_b128 v[124:127], v10 offset:6144
    v_mfma_f32_16x16x32_bf16 a[108:111], v[72:75], v[44:47], a[108:111]
    ds_read_b128 v[128:131], v10 offset:7168
    v_mfma_f32_16x16x32_bf16 a[112:115], v[76:79], v[32:35], a[112:115]
    ds_read_b128 v[132:135], v10 offset:8192
    v_mfma_f32_16x16x32_bf16 a[116:119], v[76:79], v[36:39], a[116:119]
    v_mfma_f32_16x16x32_bf16 a[120:123], v[76:79], v[40:43], a[120:123]
    v_mfma_f32_16x16x32_bf16 a[124:127], v[76:79], v[44:47], a[124:127]
    v_mfma_f32_16x16x32_bf16 a[128:131], v[80:83], v[32:35], a[128:131]
    v_mfma_f32_16x16x32_bf16 a[132:135], v[80:83], v[36:39], a[132:135]
    v_mfma_f32_16x16x32_bf16 a[136:139], v[80:83], v[40:43], a[136:139]
    v_mfma_f32_16x16x32_bf16 a[140:143], v[80:83], v[44:47], a[140:143]
    s_waitcnt vmcnt(21) lgkmcnt(0)
    s_barrier
    v_mfma_f32_16x16x32_bf16 a[0:3], v[100:103], v[84:87], a[0:3]
    s_mov_b32 s48, 10240
    v_mfma_f32_16x16x32_bf16 a[4:7], v[100:103], v[88:91], a[4:7]
    s_add_u32 m0, s44, 0
    v_mfma_f32_16x16x32_bf16 a[8:11], v[100:103], v[92:95], a[8:11]
    s_mov_b32 s49, 26624
    v_mfma_f32_16x16x32_bf16 a[12:15], v[100:103], v[96:99], a[12:15]
    buffer_load_dwordx4 v4, s[12:15], s48 offen lds
    v_mfma_f32_16x16x32_bf16 a[16:19], v[104:107], v[84:87], a[16:19]
    s_add_u32 m0, s44, 1024
    v_mfma_f32_16x16x32_bf16 a[20:23], v[104:107], v[88:91], a[20:23]
    s_mov_b32 s50, 184320
    v_mfma_f32_16x16x32_bf16 a[24:27], v[104:107], v[92:95], a[24:27]
    buffer_load_dwordx4 v4, s[12:15], s49 offen lds
    v_mfma_f32_16x16x32_bf16 a[28:31], v[104:107], v[96:99], a[28:31]
    s_add_u32 m0, s45, 0
    v_mfma_f32_16x16x32_bf16 a[32:35], v[108:111], v[84:87], a[32:35]
    s_nop 0
    v_mfma_f32_16x16x32_bf16 a[36:39], v[108:111], v[88:91], a[36:39]
    buffer_load_dwordx4 v5, s[16:19], s50 offen offset:0 lds
    v_mfma_f32_16x16x32_bf16 a[40:43], v[108:111], v[92:95], a[40:43]
    buffer_load_dwordx4 v5, s[16:19], s50 offen offset:1024 lds
    v_mfma_f32_16x16x32_bf16 a[44:47], v[108:111], v[96:99], a[44:47]
    buffer_load_dwordx4 v5, s[16:19], s50 offen offset:2048 lds
    v_mfma_f32_16x16x32_bf16 a[48:51], v[112:115], v[84:87], a[48:51]
    buffer_load_dwordx4 v5, s[16:19], s50 offen offset:3072 lds
    v_mfma_f32_16x16x32_bf16 a[52:55], v[112:115], v[88:91], a[52:55]
    s_add_u32 m0, s46, 0
    v_mfma_f32_16x16x32_bf16 a[56:59], v[112:115], v[92:95], a[56:59]
    s_nop 0
    v_mfma_f32_16x16x32_bf16 a[60:63], v[112:115], v[96:99], a[60:63]
    buffer_load_dwordx4 v6, s[16:19], s50 offen lds
    v_mfma_f32_16x16x32_bf16 a[64:67], v[116:119], v[84:87], a[64:67]
    ds_read_b128 v[32:35], v7 offset:26624
    v_mfma_f32_16x16x32_bf16 a[68:71], v[116:119], v[88:91], a[68:71]
    ds_read_b128 v[48:51], v10 offset:26624
    v_mfma_f32_16x16x32_bf16 a[72:75], v[116:119], v[92:95], a[72:75]
    ds_read_b128 v[36:39], v7 offset:27648
    v_mfma_f32_16x16x32_bf16 a[76:79], v[116:119], v[96:99], a[76:79]
    ds_read_b128 v[52:55], v10 offset:27648
    v_mfma_f32_16x16x32_bf16 a[80:83], v[120:123], v[84:87], a[80:83]
    ds_read_b128 v[40:43], v7 offset:28672
    v_mfma_f32_16x16x32_bf16 a[84:87], v[120:123], v[88:91], a[84:87]
    ds_read_b128 v[56:59], v10 offset:28672
    v_mfma_f32_16x16x32_bf16 a[88:91], v[120:123], v[92:95], a[88:91]
    ds_read_b128 v[44:47], v7 offset:29696
    v_mfma_f32_16x16x32_bf16 a[92:95], v[120:123], v[96:99], a[92:95]
    ds_read_b128 v[60:63], v10 offset:29696
    v_mfma_f32_16x16x32_bf16 a[96:99], v[124:127], v[84:87], a[96:99]
    ds_read_b128 v[64:67], v10 offset:30720
    v_mfma_f32_16x16x32_bf16 a[100:103], v[124:127], v[88:91], a[100:103]
    ds_read_b128 v[68:71], v10 offset:31744
    v_mfma_f32_16x16x32_bf16 a[104:107], v[124:127], v[92:95], a[104:107]
    ds_read_b128 v[72:75], v10 offset:32768
    v_mfma_f32_16x16x32_bf16 a[108:111], v[124:127], v[96:99], a[108:111]
    ds_read_b128 v[76:79], v10 offset:33792
    v_mfma_f32_16x16x32_bf16 a[112:115], v[128:131], v[84:87], a[112:115]
    ds_read_b128 v[80:83], v10 offset:34816
    v_mfma_f32_16x16x32_bf16 a[116:119], v[128:131], v[88:91], a[116:119]
    v_mfma_f32_16x16x32_bf16 a[120:123], v[128:131], v[92:95], a[120:123]
    v_mfma_f32_16x16x32_bf16 a[124:127], v[128:131], v[96:99], a[124:127]
    v_mfma_f32_16x16x32_bf16 a[128:131], v[132:135], v[84:87], a[128:131]
    v_mfma_f32_16x16x32_bf16 a[132:135], v[132:135], v[88:91], a[132:135]
    v_mfma_f32_16x16x32_bf16 a[136:139], v[132:135], v[92:95], a[136:139]
    v_mfma_f32_16x16x32_bf16 a[140:143], v[132:135], v[96:99], a[140:143]
    s_waitcnt vmcnt(21) lgkmcnt(0)
    s_barrier
    v_mfma_f32_16x16x32_bf16 a[0:3], v[48:51], v[32:35], a[0:3]
    s_mov_b32 s48, 11264
    v_mfma_f32_16x16x32_bf16 a[4:7], v[48:51], v[36:39], a[4:7]
    s_add_u32 m0, s44, 26624
    v_mfma_f32_16x16x32_bf16 a[8:11], v[48:51], v[40:43], a[8:11]
    s_mov_b32 s49, 27648
    v_mfma_f32_16x16x32_bf16 a[12:15], v[48:51], v[44:47], a[12:15]
    buffer_load_dwordx4 v4, s[12:15], s48 offen lds
    v_mfma_f32_16x16x32_bf16 a[16:19], v[52:55], v[32:35], a[16:19]
    s_add_u32 m0, s44, 27648
    v_mfma_f32_16x16x32_bf16 a[20:23], v[52:55], v[36:39], a[20:23]
    s_mov_b32 s50, 202752
    v_mfma_f32_16x16x32_bf16 a[24:27], v[52:55], v[40:43], a[24:27]
    buffer_load_dwordx4 v4, s[12:15], s49 offen lds
    v_mfma_f32_16x16x32_bf16 a[28:31], v[52:55], v[44:47], a[28:31]
    s_add_u32 m0, s45, 26624
    v_mfma_f32_16x16x32_bf16 a[32:35], v[56:59], v[32:35], a[32:35]
    s_nop 0
    v_mfma_f32_16x16x32_bf16 a[36:39], v[56:59], v[36:39], a[36:39]
    buffer_load_dwordx4 v5, s[16:19], s50 offen offset:0 lds
    v_mfma_f32_16x16x32_bf16 a[40:43], v[56:59], v[40:43], a[40:43]
    buffer_load_dwordx4 v5, s[16:19], s50 offen offset:1024 lds
    v_mfma_f32_16x16x32_bf16 a[44:47], v[56:59], v[44:47], a[44:47]
    buffer_load_dwordx4 v5, s[16:19], s50 offen offset:2048 lds
    v_mfma_f32_16x16x32_bf16 a[48:51], v[60:63], v[32:35], a[48:51]
    buffer_load_dwordx4 v5, s[16:19], s50 offen offset:3072 lds
    v_mfma_f32_16x16x32_bf16 a[52:55], v[60:63], v[36:39], a[52:55]
    s_add_u32 m0, s46, 26624
    v_mfma_f32_16x16x32_bf16 a[56:59], v[60:63], v[40:43], a[56:59]
    s_nop 0
    v_mfma_f32_16x16x32_bf16 a[60:63], v[60:63], v[44:47], a[60:63]
    buffer_load_dwordx4 v6, s[16:19], s50 offen lds
    v_mfma_f32_16x16x32_bf16 a[64:67], v[64:67], v[32:35], a[64:67]
    ds_read_b128 v[84:87], v8 offset:0
    v_mfma_f32_16x16x32_bf16 a[68:71], v[64:67], v[36:39], a[68:71]
    ds_read_b128 v[100:103], v11 offset:0
    v_mfma_f32_16x16x32_bf16 a[72:75], v[64:67], v[40:43], a[72:75]
    ds_read_b128 v[88:91], v8 offset:1024
    v_mfma_f32_16x16x32_bf16 a[76:79], v[64:67], v[44:47], a[76:79]
    ds_read_b128 v[104:107], v11 offset:1024
    v_mfma_f32_16x16x32_bf16 a[80:83], v[68:71], v[32:35], a[80:83]
    ds_read_b128 v[92:95], v8 offset:2048
    v_mfma_f32_16x16x32_bf16 a[84:87], v[68:71], v[36:39], a[84:87]
    ds_read_b128 v[108:111], v11 offset:2048
    v_mfma_f32_16x16x32_bf16 a[88:91], v[68:71], v[40:43], a[88:91]
    ds_read_b128 v[96:99], v8 offset:3072
    v_mfma_f32_16x16x32_bf16 a[92:95], v[68:71], v[44:47], a[92:95]
    ds_read_b128 v[112:115], v11 offset:3072
    v_mfma_f32_16x16x32_bf16 a[96:99], v[72:75], v[32:35], a[96:99]
    ds_read_b128 v[116:119], v11 offset:4096
    v_mfma_f32_16x16x32_bf16 a[100:103], v[72:75], v[36:39], a[100:103]
    ds_read_b128 v[120:123], v11 offset:5120
    v_mfma_f32_16x16x32_bf16 a[104:107], v[72:75], v[40:43], a[104:107]
    ds_read_b128 v[124:127], v11 offset:6144
    v_mfma_f32_16x16x32_bf16 a[108:111], v[72:75], v[44:47], a[108:111]
    ds_read_b128 v[128:131], v11 offset:7168
    v_mfma_f32_16x16x32_bf16 a[112:115], v[76:79], v[32:35], a[112:115]
    ds_read_b128 v[132:135], v11 offset:8192
    v_mfma_f32_16x16x32_bf16 a[116:119], v[76:79], v[36:39], a[116:119]
    v_mfma_f32_16x16x32_bf16 a[120:123], v[76:79], v[40:43], a[120:123]
    v_mfma_f32_16x16x32_bf16 a[124:127], v[76:79], v[44:47], a[124:127]
    v_mfma_f32_16x16x32_bf16 a[128:131], v[80:83], v[32:35], a[128:131]
    v_mfma_f32_16x16x32_bf16 a[132:135], v[80:83], v[36:39], a[132:135]
    v_mfma_f32_16x16x32_bf16 a[136:139], v[80:83], v[40:43], a[136:139]
    v_mfma_f32_16x16x32_bf16 a[140:143], v[80:83], v[44:47], a[140:143]
    s_waitcnt vmcnt(21) lgkmcnt(0)
    s_barrier
    v_mfma_f32_16x16x32_bf16 a[0:3], v[100:103], v[84:87], a[0:3]
    s_mov_b32 s48, 12288
    v_mfma_f32_16x16x32_bf16 a[4:7], v[100:103], v[88:91], a[4:7]
    s_add_u32 m0, s44, 53248
    v_mfma_f32_16x16x32_bf16 a[8:11], v[100:103], v[92:95], a[8:11]
    s_mov_b32 s49, 28672
    v_mfma_f32_16x16x32_bf16 a[12:15], v[100:103], v[96:99], a[12:15]
    buffer_load_dwordx4 v4, s[12:15], s48 offen lds
    v_mfma_f32_16x16x32_bf16 a[16:19], v[104:107], v[84:87], a[16:19]
    s_add_u32 m0, s44, 54272
    v_mfma_f32_16x16x32_bf16 a[20:23], v[104:107], v[88:91], a[20:23]
    s_mov_b32 s50, 221184
    v_mfma_f32_16x16x32_bf16 a[24:27], v[104:107], v[92:95], a[24:27]
    buffer_load_dwordx4 v4, s[12:15], s49 offen lds
    v_mfma_f32_16x16x32_bf16 a[28:31], v[104:107], v[96:99], a[28:31]
    s_add_u32 m0, s45, 53248
    v_mfma_f32_16x16x32_bf16 a[32:35], v[108:111], v[84:87], a[32:35]
    s_nop 0
    v_mfma_f32_16x16x32_bf16 a[36:39], v[108:111], v[88:91], a[36:39]
    buffer_load_dwordx4 v5, s[16:19], s50 offen offset:0 lds
    v_mfma_f32_16x16x32_bf16 a[40:43], v[108:111], v[92:95], a[40:43]
    buffer_load_dwordx4 v5, s[16:19], s50 offen offset:1024 lds
    v_mfma_f32_16x16x32_bf16 a[44:47], v[108:111], v[96:99], a[44:47]
    buffer_load_dwordx4 v5, s[16:19], s50 offen offset:2048 lds
    v_mfma_f32_16x16x32_bf16 a[48:51], v[112:115], v[84:87], a[48:51]
    buffer_load_dwordx4 v5, s[16:19], s50 offen offset:3072 lds
    v_mfma_f32_16x16x32_bf16 a[52:55], v[112:115], v[88:91], a[52:55]
    s_add_u32 m0, s46, 53248
    v_mfma_f32_16x16x32_bf16 a[56:59], v[112:115], v[92:95], a[56:59]
    s_nop 0
    v_mfma_f32_16x16x32_bf16 a[60:63], v[112:115], v[96:99], a[60:63]
    buffer_load_dwordx4 v6, s[16:19], s50 offen lds
    v_mfma_f32_16x16x32_bf16 a[64:67], v[116:119], v[84:87], a[64:67]
    ds_read_b128 v[32:35], v8 offset:26624
    v_mfma_f32_16x16x32_bf16 a[68:71], v[116:119], v[88:91], a[68:71]
    ds_read_b128 v[48:51], v11 offset:26624
    v_mfma_f32_16x16x32_bf16 a[72:75], v[116:119], v[92:95], a[72:75]
    ds_read_b128 v[36:39], v8 offset:27648
    v_mfma_f32_16x16x32_bf16 a[76:79], v[116:119], v[96:99], a[76:79]
    ds_read_b128 v[52:55], v11 offset:27648
    v_mfma_f32_16x16x32_bf16 a[80:83], v[120:123], v[84:87], a[80:83]
    ds_read_b128 v[40:43], v8 offset:28672
    v_mfma_f32_16x16x32_bf16 a[84:87], v[120:123], v[88:91], a[84:87]
    ds_read_b128 v[56:59], v11 offset:28672
    v_mfma_f32_16x16x32_bf16 a[88:91], v[120:123], v[92:95], a[88:91]
    ds_read_b128 v[44:47], v8 offset:29696
    v_mfma_f32_16x16x32_bf16 a[92:95], v[120:123], v[96:99], a[92:95]
    ds_read_b128 v[60:63], v11 offset:29696
    v_mfma_f32_16x16x32_bf16 a[96:99], v[124:127], v[84:87], a[96:99]
    ds_read_b128 v[64:67], v11 offset:30720
    v_mfma_f32_16x16x32_bf16 a[100:103], v[124:127], v[88:91], a[100:103]
    ds_read_b128 v[68:71], v11 offset:31744
    v_mfma_f32_16x16x32_bf16 a[104:107], v[124:127], v[92:95], a[104:107]
    ds_read_b128 v[72:75], v11 offset:32768
    v_mfma_f32_16x16x32_bf16 a[108:111], v[124:127], v[96:99], a[108:111]
    ds_read_b128 v[76:79], v11 offset:33792
    v_mfma_f32_16x16x32_bf16 a[112:115], v[128:131], v[84:87], a[112:115]
    ds_read_b128 v[80:83], v11 offset:34816
    v_mfma_f32_16x16x32_bf16 a[116:119], v[128:131], v[88:91], a[116:119]
    v_mfma_f32_16x16x32_bf16 a[120:123], v[128:131], v[92:95], a[120:123]
    v_mfma_f32_16x16x32_bf16 a[124:127], v[128:131], v[96:99], a[124:127]
    v_mfma_f32_16x16x32_bf16 a[128:131], v[132:135], v[84:87], a[128:131]
    v_mfma_f32_16x16x32_bf16 a[132:135], v[132:135], v[88:91], a[132:135]
    v_mfma_f32_16x16x32_bf16 a[136:139], v[132:135], v[92:95], a[136:139]
    v_mfma_f32_16x16x32_bf16 a[140:143], v[132:135], v[96:99], a[140:143]
    s_waitcnt vmcnt(21) lgkmcnt(0)
    s_barrier
    v_mfma_f32_16x16x32_bf16 a[0:3], v[48:51], v[32:35], a[0:3]
    s_mov_b32 s48, 13312
    v_mfma_f32_16x16x32_bf16 a[4:7], v[48:51], v[36:39], a[4:7]
    s_add_u32 m0, s44, 79872
    v_mfma_f32_16x16x32_bf16 a[8:11], v[48:51], v[40:43], a[8:11]
    s_mov_b32 s49, 29696
    v_mfma_f32_16x16x32_bf16 a[12:15], v[48:51], v[44:47], a[12:15]
    buffer_load_dwordx4 v4, s[12:15], s48 offen lds
    v_mfma_f32_16x16x32_bf16 a[16:19], v[52:55], v[32:35], a[16:19]
    s_add_u32 m0, s44, 80896
    v_mfma_f32_16x16x32_bf16 a[20:23], v[52:55], v[36:39], a[20:23]
    s_mov_b32 s50, 239616
    v_mfma_f32_16x16x32_bf16 a[24:27], v[52:55], v[40:43], a[24:27]
    buffer_load_dwordx4 v4, s[12:15], s49 offen lds
    v_mfma_f32_16x16x32_bf16 a[28:31], v[52:55], v[44:47], a[28:31]
    s_add_u32 m0, s45, 79872
    v_mfma_f32_16x16x32_bf16 a[32:35], v[56:59], v[32:35], a[32:35]
    s_nop 0
    v_mfma_f32_16x16x32_bf16 a[36:39], v[56:59], v[36:39], a[36:39]
    buffer_load_dwordx4 v5, s[16:19], s50 offen offset:0 lds
    v_mfma_f32_16x16x32_bf16 a[40:43], v[56:59], v[40:43], a[40:43]
    buffer_load_dwordx4 v5, s[16:19], s50 offen offset:1024 lds
    v_mfma_f32_16x16x32_bf16 a[44:47], v[56:59], v[44:47], a[44:47]
    buffer_load_dwordx4 v5, s[16:19], s50 offen offset:2048 lds
    v_mfma_f32_16x16x32_bf16 a[48:51], v[60:63], v[32:35], a[48:51]
    buffer_load_dwordx4 v5, s[16:19], s50 offen offset:3072 lds
    v_mfma_f32_16x16x32_bf16 a[52:55], v[60:63], v[36:39], a[52:55]
    s_add_u32 m0, s46, 79872
    v_mfma_f32_16x16x32_bf16 a[56:59], v[60:63], v[40:43], a[56:59]
    s_nop 0
    v_mfma_f32_16x16x32_bf16 a[60:63], v[60:63], v[44:47], a[60:63]
    buffer_load_dwordx4 v6, s[16:19], s50 offen lds
    v_mfma_f32_16x16x32_bf16 a[64:67], v[64:67], v[32:35], a[64:67]
    ds_read_b128 v[84:87], v9 offset:0
    v_mfma_f32_16x16x32_bf16 a[68:71], v[64:67], v[36:39], a[68:71]
    ds_read_b128 v[100:103], v12 offset:0
    v_mfma_f32_16x16x32_bf16 a[72:75], v[64:67], v[40:43], a[72:75]
    ds_read_b128 v[88:91], v9 offset:1024
    v_mfma_f32_16x16x32_bf16 a[76:79], v[64:67], v[44:47], a[76:79]
    ds_read_b128 v[104:107], v12 offset:1024
    v_mfma_f32_16x16x32_bf16 a[80:83], v[68:71], v[32:35], a[80:83]
    ds_read_b128 v[92:95], v9 offset:2048
    v_mfma_f32_16x16x32_bf16 a[84:87], v[68:71], v[36:39], a[84:87]
    ds_read_b128 v[108:111], v12 offset:2048
    v_mfma_f32_16x16x32_bf16 a[88:91], v[68:71], v[40:43], a[88:91]
    ds_read_b128 v[96:99], v9 offset:3072
    v_mfma_f32_16x16x32_bf16 a[92:95], v[68:71], v[44:47], a[92:95]
    ds_read_b128 v[112:115], v12 offset:3072
    v_mfma_f32_16x16x32_bf16 a[96:99], v[72:75], v[32:35], a[96:99]
    ds_read_b128 v[116:119], v12 offset:4096
    v_mfma_f32_16x16x32_bf16 a[100:103], v[72:75], v[36:39], a[100:103]
    ds_read_b128 v[120:123], v12 offset:5120
    v_mfma_f32_16x16x32_bf16 a[104:107], v[72:75], v[40:43], a[104:107]
    ds_read_b128 v[124:127], v12 offset:6144
    v_mfma_f32_16x16x32_bf16 a[108:111], v[72:75], v[44:47], a[108:111]
    ds_read_b128 v[128:131], v12 offset:7168
    v_mfma_f32_16x16x32_bf16 a[112:115], v[76:79], v[32:35], a[112:115]
    ds_read_b128 v[132:135], v12 offset:8192
    v_mfma_f32_16x16x32_bf16 a[116:119], v[76:79], v[36:39], a[116:119]
    v_mfma_f32_16x16x32_bf16 a[120:123], v[76:79], v[40:43], a[120:123]
    v_mfma_f32_16x16x32_bf16 a[124:127], v[76:79], v[44:47], a[124:127]
    v_mfma_f32_16x16x32_bf16 a[128:131], v[80:83], v[32:35], a[128:131]
    v_mfma_f32_16x16x32_bf16 a[132:135], v[80:83], v[36:39], a[132:135]
    v_mfma_f32_16x16x32_bf16 a[136:139], v[80:83], v[40:43], a[136:139]
    v_mfma_f32_16x16x32_bf16 a[140:143], v[80:83], v[44:47], a[140:143]
    s_waitcnt vmcnt(21) lgkmcnt(0)
    s_barrier
    v_mfma_f32_16x16x32_bf16 a[0:3], v[100:103], v[84:87], a[0:3]
    s_mov_b32 s48, 14336
    v_mfma_f32_16x16x32_bf16 a[4:7], v[100:103], v[88:91], a[4:7]
    s_add_u32 m0, s44, 106496
    v_mfma_f32_16x16x32_bf16 a[8:11], v[100:103], v[92:95], a[8:11]
    s_mov_b32 s49, 30720
    v_mfma_f32_16x16x32_bf16 a[12:15], v[100:103], v[96:99], a[12:15]
    buffer_load_dwordx4 v4, s[12:15], s48 offen lds
    v_mfma_f32_16x16x32_bf16 a[16:19], v[104:107], v[84:87], a[16:19]
    s_add_u32 m0, s44, 107520
    v_mfma_f32_16x16x32_bf16 a[20:23], v[104:107], v[88:91], a[20:23]
    s_mov_b32 s50, 258048
    v_mfma_f32_16x16x32_bf16 a[24:27], v[104:107], v[92:95], a[24:27]
    buffer_load_dwordx4 v4, s[12:15], s49 offen lds
    v_mfma_f32_16x16x32_bf16 a[28:31], v[104:107], v[96:99], a[28:31]
    s_add_u32 m0, s45, 106496
    v_mfma_f32_16x16x32_bf16 a[32:35], v[108:111], v[84:87], a[32:35]
    s_nop 0
    v_mfma_f32_16x16x32_bf16 a[36:39], v[108:111], v[88:91], a[36:39]
    buffer_load_dwordx4 v5, s[16:19], s50 offen offset:0 lds
    v_mfma_f32_16x16x32_bf16 a[40:43], v[108:111], v[92:95], a[40:43]
    buffer_load_dwordx4 v5, s[16:19], s50 offen offset:1024 lds
    v_mfma_f32_16x16x32_bf16 a[44:47], v[108:111], v[96:99], a[44:47]
    buffer_load_dwordx4 v5, s[16:19], s50 offen offset:2048 lds
    v_mfma_f32_16x16x32_bf16 a[48:51], v[112:115], v[84:87], a[48:51]
    buffer_load_dwordx4 v5, s[16:19], s50 offen offset:3072 lds
    v_mfma_f32_16x16x32_bf16 a[52:55], v[112:115], v[88:91], a[52:55]
    s_add_u32 m0, s46, 106496
    v_mfma_f32_16x16x32_bf16 a[56:59], v[112:115], v[92:95], a[56:59]
    s_nop 0
    v_mfma_f32_16x16x32_bf16 a[60:63], v[112:115], v[96:99], a[60:63]
    buffer_load_dwordx4 v6, s[16:19], s50 offen lds
    v_mfma_f32_16x16x32_bf16 a[64:67], v[116:119], v[84:87], a[64:67]
    ds_read_b128 v[32:35], v7 offset:0
    v_mfma_f32_16x16x32_bf16 a[68:71], v[116:119], v[88:91], a[68:71]
    ds_read_b128 v[48:51], v10 offset:0
    v_mfma_f32_16x16x32_bf16 a[72:75], v[116:119], v[92:95], a[72:75]
    ds_read_b128 v[36:39], v7 offset:1024
    v_mfma_f32_16x16x32_bf16 a[76:79], v[116:119], v[96:99], a[76:79]
    ds_read_b128 v[52:55], v10 offset:1024
    v_mfma_f32_16x16x32_bf16 a[80:83], v[120:123], v[84:87], a[80:83]
    ds_read_b128 v[40:43], v7 offset:2048
    v_mfma_f32_16x16x32_bf16 a[84:87], v[120:123], v[88:91], a[84:87]
    ds_read_b128 v[56:59], v10 offset:2048
    v_mfma_f32_16x16x32_bf16 a[88:91], v[120:123], v[92:95], a[88:91]
    ds_read_b128 v[44:47], v7 offset:3072
    v_mfma_f32_16x16x32_bf16 a[92:95], v[120:123], v[96:99], a[92:95]
    ds_read_b128 v[60:63], v10 offset:3072
    v_mfma_f32_16x16x32_bf16 a[96:99], v[124:127], v[84:87], a[96:99]
    ds_read_b128 v[64:67], v10 offset:4096
    v_mfma_f32_16x16x32_bf16 a[100:103], v[124:127], v[88:91], a[100:103]
    ds_read_b128 v[68:71], v10 offset:5120
    v_mfma_f32_16x16x32_bf16 a[104:107], v[124:127], v[92:95], a[104:107]
    ds_read_b128 v[72:75], v10 offset:6144
    v_mfma_f32_16x16x32_bf16 a[108:111], v[124:127], v[96:99], a[108:111]
    ds_read_b128 v[76:79], v10 offset:7168
    v_mfma_f32_16x16x32_bf16 a[112:115], v[128:131], v[84:87], a[112:115]
    ds_read_b128 v[80:83], v10 offset:8192
    v_mfma_f32_16x16x32_bf16 a[116:119], v[128:131], v[88:91], a[116:119]
    v_mfma_f32_16x16x32_bf16 a[120:123], v[128:131], v[92:95], a[120:123]
    v_mfma_f32_16x16x32_bf16 a[124:127], v[128:131], v[96:99], a[124:127]
    v_mfma_f32_16x16x32_bf16 a[128:131], v[132:135], v[84:87], a[128:131]
    v_mfma_f32_16x16x32_bf16 a[132:135], v[132:135], v[88:91], a[132:135]
    v_mfma_f32_16x16x32_bf16 a[136:139], v[132:135], v[92:95], a[136:139]
    v_mfma_f32_16x16x32_bf16 a[140:143], v[132:135], v[96:99], a[140:143]
    s_waitcnt vmcnt(21) lgkmcnt(0)
    s_barrier
    v_mfma_f32_16x16x32_bf16 a[0:3], v[48:51], v[32:35], a[0:3]
    s_mov_b32 s48, 15360
    v_mfma_f32_16x16x32_bf16 a[4:7], v[48:51], v[36:39], a[4:7]
    s_add_u32 m0, s44, 0
    v_mfma_f32_16x16x32_bf16 a[8:11], v[48:51], v[40:43], a[8:11]
    s_mov_b32 s49, 31744
    v_mfma_f32_16x16x32_bf16 a[12:15], v[48:51], v[44:47], a[12:15]
    buffer_load_dwordx4 v4, s[12:15], s48 offen lds
    v_mfma_f32_16x16x32_bf16 a[16:19], v[52:55], v[32:35], a[16:19]
    s_add_u32 m0, s44, 1024
    v_mfma_f32_16x16x32_bf16 a[20:23], v[52:55], v[36:39], a[20:23]
    s_mov_b32 s50, 276480
    v_mfma_f32_16x16x32_bf16 a[24:27], v[52:55], v[40:43], a[24:27]
    buffer_load_dwordx4 v4, s[12:15], s49 offen lds
    v_mfma_f32_16x16x32_bf16 a[28:31], v[52:55], v[44:47], a[28:31]
    s_add_u32 m0, s45, 0
    v_mfma_f32_16x16x32_bf16 a[32:35], v[56:59], v[32:35], a[32:35]
    s_nop 0
    v_mfma_f32_16x16x32_bf16 a[36:39], v[56:59], v[36:39], a[36:39]
    buffer_load_dwordx4 v5, s[16:19], s50 offen offset:0 lds
    v_mfma_f32_16x16x32_bf16 a[40:43], v[56:59], v[40:43], a[40:43]
    buffer_load_dwordx4 v5, s[16:19], s50 offen offset:1024 lds
    v_mfma_f32_16x16x32_bf16 a[44:47], v[56:59], v[44:47], a[44:47]
    buffer_load_dwordx4 v5, s[16:19], s50 offen offset:2048 lds
    v_mfma_f32_16x16x32_bf16 a[48:51], v[60:63], v[32:35], a[48:51]
    buffer_load_dwordx4 v5, s[16:19], s50 offen offset:3072 lds
    v_mfma_f32_16x16x32_bf16 a[52:55], v[60:63], v[36:39], a[52:55]
    s_add_u32 m0, s46, 0
    v_mfma_f32_16x16x32_bf16 a[56:59], v[60:63], v[40:43], a[56:59]
    s_nop 0
    v_mfma_f32_16x16x32_bf16 a[60:63], v[60:63], v[44:47], a[60:63]
    buffer_load_dwordx4 v6, s[16:19], s50 offen lds
    v_mfma_f32_16x16x32_bf16 a[64:67], v[64:67], v[32:35], a[64:67]
    ds_read_b128 v[84:87], v7 offset:26624
    v_mfma_f32_16x16x32_bf16 a[68:71], v[64:67], v[36:39], a[68:71]
    ds_read_b128 v[100:103], v10 offset:26624
    v_mfma_f32_16x16x32_bf16 a[72:75], v[64:67], v[40:43], a[72:75]
    ds_read_b128 v[88:91], v7 offset:27648
    v_mfma_f32_16x16x32_bf16 a[76:79], v[64:67], v[44:47], a[76:79]
    ds_read_b128 v[104:107], v10 offset:27648
    v_mfma_f32_16x16x32_bf16 a[80:83], v[68:71], v[32:35], a[80:83]
    ds_read_b128 v[92:95], v7 offset:28672
    v_mfma_f32_16x16x32_bf16 a[84:87], v[68:71], v[36:39], a[84:87]
    ds_read_b128 v[108:111], v10 offset:28672
    v_mfma_f32_16x16x32_bf16 a[88:91], v[68:71], v[40:43], a[88:91]
    ds_read_b128 v[96:99], v7 offset:29696
    v_mfma_f32_16x16x32_bf16 a[92:95], v[68:71], v[44:47], a[92:95]
    ds_read_b128 v[112:115], v10 offset:29696
    v_mfma_f32_16x16x32_bf16 a[96:99], v[72:75], v[32:35], a[96:99]
    ds_read_b128 v[116:119], v10 offset:30720
    v_mfma_f32_16x16x32_bf16 a[100:103], v[72:75], v[36:39], a[100:103]
    ds_read_b128 v[120:123], v10 offset:31744
    v_mfma_f32_16x16x32_bf16 a[104:107], v[72:75], v[40:43], a[104:107]
    ds_read_b128 v[124:127], v10 offset:32768
    v_mfma_f32_16x16x32_bf16 a[108:111], v[72:75], v[44:47], a[108:111]
    ds_read_b128 v[128:131], v10 offset:33792
    v_mfma_f32_16x16x32_bf16 a[112:115], v[76:79], v[32:35], a[112:115]
    ds_read_b128 v[132:135], v10 offset:34816
    v_mfma_f32_16x16x32_bf16 a[116:119], v[76:79], v[36:39], a[116:119]
    v_mfma_f32_16x16x32_bf16 a[120:123], v[76:79], v[40:43], a[120:123]
    v_mfma_f32_16x16x32_bf16 a[124:127], v[76:79], v[44:47], a[124:127]
    v_mfma_f32_16x16x32_bf16 a[128:131], v[80:83], v[32:35], a[128:131]
    v_mfma_f32_16x16x32_bf16 a[132:135], v[80:83], v[36:39], a[132:135]
    v_mfma_f32_16x16x32_bf16 a[136:139], v[80:83], v[40:43], a[136:139]
    v_mfma_f32_16x16x32_bf16 a[140:143], v[80:83], v[44:47], a[140:143]
    s_waitcnt vmcnt(21) lgkmcnt(0)
    s_barrier
    v_mfma_f32_16x16x32_bf16 a[0:3], v[100:103], v[84:87], a[0:3]
    ds_read_b128 v[32:35], v8 offset:0
    v_mfma_f32_16x16x32_bf16 a[4:7], v[100:103], v[88:91], a[4:7]
    ds_read_b128 v[48:51], v11 offset:0
    v_mfma_f32_16x16x32_bf16 a[8:11], v[100:103], v[92:95], a[8:11]
    ds_read_b128 v[36:39], v8 offset:1024
    v_mfma_f32_16x16x32_bf16 a[12:15], v[100:103], v[96:99], a[12:15]
    ds_read_b128 v[52:55], v11 offset:1024
    v_mfma_f32_16x16x32_bf16 a[16:19], v[104:107], v[84:87], a[16:19]
    ds_read_b128 v[40:43], v8 offset:2048
    v_mfma_f32_16x16x32_bf16 a[20:23], v[104:107], v[88:91], a[20:23]
    ds_read_b128 v[56:59], v11 offset:2048
    v_mfma_f32_16x16x32_bf16 a[24:27], v[104:107], v[92:95], a[24:27]
    ds_read_b128 v[44:47], v8 offset:3072
    v_mfma_f32_16x16x32_bf16 a[28:31], v[104:107], v[96:99], a[28:31]
    ds_read_b128 v[60:63], v11 offset:3072
    v_mfma_f32_16x16x32_bf16 a[32:35], v[108:111], v[84:87], a[32:35]
    ds_read_b128 v[64:67], v11 offset:4096
    v_mfma_f32_16x16x32_bf16 a[36:39], v[108:111], v[88:91], a[36:39]
    ds_read_b128 v[68:71], v11 offset:5120
    v_mfma_f32_16x16x32_bf16 a[40:43], v[108:111], v[92:95], a[40:43]
    ds_read_b128 v[72:75], v11 offset:6144
    v_mfma_f32_16x16x32_bf16 a[44:47], v[108:111], v[96:99], a[44:47]
    ds_read_b128 v[76:79], v11 offset:7168
    v_mfma_f32_16x16x32_bf16 a[48:51], v[112:115], v[84:87], a[48:51]
    ds_read_b128 v[80:83], v11 offset:8192
    v_mfma_f32_16x16x32_bf16 a[52:55], v[112:115], v[88:91], a[52:55]
    v_mfma_f32_16x16x32_bf16 a[56:59], v[112:115], v[92:95], a[56:59]
    v_mfma_f32_16x16x32_bf16 a[60:63], v[112:115], v[96:99], a[60:63]
    v_mfma_f32_16x16x32_bf16 a[64:67], v[116:119], v[84:87], a[64:67]
    v_mfma_f32_16x16x32_bf16 a[68:71], v[116:119], v[88:91], a[68:71]
    v_mfma_f32_16x16x32_bf16 a[72:75], v[116:119], v[92:95], a[72:75]
    v_mfma_f32_16x16x32_bf16 a[76:79], v[116:119], v[96:99], a[76:79]
    v_mfma_f32_16x16x32_bf16 a[80:83], v[120:123], v[84:87], a[80:83]
    v_mfma_f32_16x16x32_bf16 a[84:87], v[120:123], v[88:91], a[84:87]
    v_mfma_f32_16x16x32_bf16 a[88:91], v[120:123], v[92:95], a[88:91]
    v_mfma_f32_16x16x32_bf16 a[92:95], v[120:123], v[96:99], a[92:95]
    v_mfma_f32_16x16x32_bf16 a[96:99], v[124:127], v[84:87], a[96:99]
    v_mfma_f32_16x16x32_bf16 a[100:103], v[124:127], v[88:91], a[100:103]
    v_mfma_f32_16x16x32_bf16 a[104:107], v[124:127], v[92:95], a[104:107]
    v_mfma_f32_16x16x32_bf16 a[108:111], v[124:127], v[96:99], a[108:111]
    v_mfma_f32_16x16x32_bf16 a[112:115], v[128:131], v[84:87], a[112:115]
    v_mfma_f32_16x16x32_bf16 a[116:119], v[128:131], v[88:91], a[116:119]
    v_mfma_f32_16x16x32_bf16 a[120:123], v[128:131], v[92:95], a[120:123]
    v_mfma_f32_16x16x32_bf16 a[124:127], v[128:131], v[96:99], a[124:127]
    v_mfma_f32_16x16x32_bf16 a[128:131], v[132:135], v[84:87], a[128:131]
    v_mfma_f32_16x16x32_bf16 a[132:135], v[132:135], v[88:91], a[132:135]
    v_mfma_f32_16x16x32_bf16 a[136:139], v[132:135], v[92:95], a[136:139]
    v_mfma_f32_16x16x32_bf16 a[140:143], v[132:135], v[96:99], a[140:143]
    s_waitcnt vmcnt(14) lgkmcnt(0)
    s_barrier
    v_mfma_f32_16x16x32_bf16 a[0:3], v[48:51], v[32:35], a[0:3]
    ds_read_b128 v[84:87], v8 offset:26624
    v_mfma_f32_16x16x32_bf16 a[4:7], v[48:51], v[36:39], a[4:7]
    ds_read_b128 v[100:103], v11 offset:26624
    v_mfma_f32_16x16x32_bf16 a[8:11], v[48:51], v[40:43], a[8:11]
    ds_read_b128 v[88:91], v8 offset:27648
    v_mfma_f32_16x16x32_bf16 a[12:15], v[48:51], v[44:47], a[12:15]
    ds_read_b128 v[104:107], v11 offset:27648
    v_mfma_f32_16x16x32_bf16 a[16:19], v[52:55], v[32:35], a[16:19]
    ds_read_b128 v[92:95], v8 offset:28672
    v_mfma_f32_16x16x32_bf16 a[20:23], v[52:55], v[36:39], a[20:23]
    ds_read_b128 v[108:111], v11 offset:28672
    v_mfma_f32_16x16x32_bf16 a[24:27], v[52:55], v[40:43], a[24:27]
    ds_read_b128 v[96:99], v8 offset:29696
    v_mfma_f32_16x16x32_bf16 a[28:31], v[52:55], v[44:47], a[28:31]
    ds_read_b128 v[112:115], v11 offset:29696
    v_mfma_f32_16x16x32_bf16 a[32:35], v[56:59], v[32:35], a[32:35]
    ds_read_b128 v[116:119], v11 offset:30720
    v_mfma_f32_16x16x32_bf16 a[36:39], v[56:59], v[36:39], a[36:39]
    ds_read_b128 v[120:123], v11 offset:31744
    v_mfma_f32_16x16x32_bf16 a[40:43], v[56:59], v[40:43], a[40:43]
    ds_read_b128 v[124:127], v11 offset:32768
    v_mfma_f32_16x16x32_bf16 a[44:47], v[56:59], v[44:47], a[44:47]
    ds_read_b128 v[128:131], v11 offset:33792
    v_mfma_f32_16x16x32_bf16 a[48:51], v[60:63], v[32:35], a[48:51]
    ds_read_b128 v[132:135], v11 offset:34816
    v_mfma_f32_16x16x32_bf16 a[52:55], v[60:63], v[36:39], a[52:55]
    v_mfma_f32_16x16x32_bf16 a[56:59], v[60:63], v[40:43], a[56:59]
    v_mfma_f32_16x16x32_bf16 a[60:63], v[60:63], v[44:47], a[60:63]
    v_mfma_f32_16x16x32_bf16 a[64:67], v[64:67], v[32:35], a[64:67]
    v_mfma_f32_16x16x32_bf16 a[68:71], v[64:67], v[36:39], a[68:71]
    v_mfma_f32_16x16x32_bf16 a[72:75], v[64:67], v[40:43], a[72:75]
    v_mfma_f32_16x16x32_bf16 a[76:79], v[64:67], v[44:47], a[76:79]
    v_mfma_f32_16x16x32_bf16 a[80:83], v[68:71], v[32:35], a[80:83]
    v_mfma_f32_16x16x32_bf16 a[84:87], v[68:71], v[36:39], a[84:87]
    v_mfma_f32_16x16x32_bf16 a[88:91], v[68:71], v[40:43], a[88:91]
    v_mfma_f32_16x16x32_bf16 a[92:95], v[68:71], v[44:47], a[92:95]
    v_mfma_f32_16x16x32_bf16 a[96:99], v[72:75], v[32:35], a[96:99]
    v_mfma_f32_16x16x32_bf16 a[100:103], v[72:75], v[36:39], a[100:103]
    v_mfma_f32_16x16x32_bf16 a[104:107], v[72:75], v[40:43], a[104:107]
    v_mfma_f32_16x16x32_bf16 a[108:111], v[72:75], v[44:47], a[108:111]
    v_mfma_f32_16x16x32_bf16 a[112:115], v[76:79], v[32:35], a[112:115]
    v_mfma_f32_16x16x32_bf16 a[116:119], v[76:79], v[36:39], a[116:119]
    v_mfma_f32_16x16x32_bf16 a[120:123], v[76:79], v[40:43], a[120:123]
    v_mfma_f32_16x16x32_bf16 a[124:127], v[76:79], v[44:47], a[124:127]
    v_mfma_f32_16x16x32_bf16 a[128:131], v[80:83], v[32:35], a[128:131]
    v_mfma_f32_16x16x32_bf16 a[132:135], v[80:83], v[36:39], a[132:135]
    v_mfma_f32_16x16x32_bf16 a[136:139], v[80:83], v[40:43], a[136:139]
    v_mfma_f32_16x16x32_bf16 a[140:143], v[80:83], v[44:47], a[140:143]
    s_waitcnt vmcnt(7) lgkmcnt(0)
    s_barrier
    v_mfma_f32_16x16x32_bf16 a[0:3], v[100:103], v[84:87], a[0:3]
    ds_read_b128 v[32:35], v9 offset:0
    v_mfma_f32_16x16x32_bf16 a[4:7], v[100:103], v[88:91], a[4:7]
    ds_read_b128 v[48:51], v12 offset:0
    v_mfma_f32_16x16x32_bf16 a[8:11], v[100:103], v[92:95], a[8:11]
    ds_read_b128 v[36:39], v9 offset:1024
    v_mfma_f32_16x16x32_bf16 a[12:15], v[100:103], v[96:99], a[12:15]
    ds_read_b128 v[52:55], v12 offset:1024
    v_mfma_f32_16x16x32_bf16 a[16:19], v[104:107], v[84:87], a[16:19]
    ds_read_b128 v[40:43], v9 offset:2048
    v_mfma_f32_16x16x32_bf16 a[20:23], v[104:107], v[88:91], a[20:23]
    ds_read_b128 v[56:59], v12 offset:2048
    v_mfma_f32_16x16x32_bf16 a[24:27], v[104:107], v[92:95], a[24:27]
    ds_read_b128 v[44:47], v9 offset:3072
    v_mfma_f32_16x16x32_bf16 a[28:31], v[104:107], v[96:99], a[28:31]
    ds_read_b128 v[60:63], v12 offset:3072
    v_mfma_f32_16x16x32_bf16 a[32:35], v[108:111], v[84:87], a[32:35]
    ds_read_b128 v[64:67], v12 offset:4096
    v_mfma_f32_16x16x32_bf16 a[36:39], v[108:111], v[88:91], a[36:39]
    ds_read_b128 v[68:71], v12 offset:5120
    v_mfma_f32_16x16x32_bf16 a[40:43], v[108:111], v[92:95], a[40:43]
    ds_read_b128 v[72:75], v12 offset:6144
    v_mfma_f32_16x16x32_bf16 a[44:47], v[108:111], v[96:99], a[44:47]
    ds_read_b128 v[76:79], v12 offset:7168
    v_mfma_f32_16x16x32_bf16 a[48:51], v[112:115], v[84:87], a[48:51]
    ds_read_b128 v[80:83], v12 offset:8192
    v_mfma_f32_16x16x32_bf16 a[52:55], v[112:115], v[88:91], a[52:55]
    v_mfma_f32_16x16x32_bf16 a[56:59], v[112:115], v[92:95], a[56:59]
    v_mfma_f32_16x16x32_bf16 a[60:63], v[112:115], v[96:99], a[60:63]
    v_mfma_f32_16x16x32_bf16 a[64:67], v[116:119], v[84:87], a[64:67]
    v_mfma_f32_16x16x32_bf16 a[68:71], v[116:119], v[88:91], a[68:71]
    v_mfma_f32_16x16x32_bf16 a[72:75], v[116:119], v[92:95], a[72:75]
    v_mfma_f32_16x16x32_bf16 a[76:79], v[116:119], v[96:99], a[76:79]
    v_mfma_f32_16x16x32_bf16 a[80:83], v[120:123], v[84:87], a[80:83]
    v_mfma_f32_16x16x32_bf16 a[84:87], v[120:123], v[88:91], a[84:87]
    v_mfma_f32_16x16x32_bf16 a[88:91], v[120:123], v[92:95], a[88:91]
    v_mfma_f32_16x16x32_bf16 a[92:95], v[120:123], v[96:99], a[92:95]
    v_mfma_f32_16x16x32_bf16 a[96:99], v[124:127], v[84:87], a[96:99]
    v_mfma_f32_16x16x32_bf16 a[100:103], v[124:127], v[88:91], a[100:103]
    v_mfma_f32_16x16x32_bf16 a[104:107], v[124:127], v[92:95], a[104:107]
    v_mfma_f32_16x16x32_bf16 a[108:111], v[124:127], v[96:99], a[108:111]
    v_mfma_f32_16x16x32_bf16 a[112:115], v[128:131], v[84:87], a[112:115]
    v_mfma_f32_16x16x32_bf16 a[116:119], v[128:131], v[88:91], a[116:119]
    v_mfma_f32_16x16x32_bf16 a[120:123], v[128:131], v[92:95], a[120:123]
    v_mfma_f32_16x16x32_bf16 a[124:127], v[128:131], v[96:99], a[124:127]
    v_mfma_f32_16x16x32_bf16 a[128:131], v[132:135], v[84:87], a[128:131]
    v_mfma_f32_16x16x32_bf16 a[132:135], v[132:135], v[88:91], a[132:135]
    v_mfma_f32_16x16x32_bf16 a[136:139], v[132:135], v[92:95], a[136:139]
    v_mfma_f32_16x16x32_bf16 a[140:143], v[132:135], v[96:99], a[140:143]
    s_waitcnt vmcnt(0) lgkmcnt(0)
    s_barrier
    v_mfma_f32_16x16x32_bf16 a[0:3], v[48:51], v[32:35], a[0:3]
    ds_read_b128 v[84:87], v7 offset:0
    v_mfma_f32_16x16x32_bf16 a[4:7], v[48:51], v[36:39], a[4:7]
    ds_read_b128 v[100:103], v10 offset:0
    v_mfma_f32_16x16x32_bf16 a[8:11], v[48:51], v[40:43], a[8:11]
    ds_read_b128 v[88:91], v7 offset:1024
    v_mfma_f32_16x16x32_bf16 a[12:15], v[48:51], v[44:47], a[12:15]
    ds_read_b128 v[104:107], v10 offset:1024
    v_mfma_f32_16x16x32_bf16 a[16:19], v[52:55], v[32:35], a[16:19]
    ds_read_b128 v[92:95], v7 offset:2048
    v_mfma_f32_16x16x32_bf16 a[20:23], v[52:55], v[36:39], a[20:23]
    ds_read_b128 v[108:111], v10 offset:2048
    v_mfma_f32_16x16x32_bf16 a[24:27], v[52:55], v[40:43], a[24:27]
    ds_read_b128 v[96:99], v7 offset:3072
    v_mfma_f32_16x16x32_bf16 a[28:31], v[52:55], v[44:47], a[28:31]
    ds_read_b128 v[112:115], v10 offset:3072
    v_mfma_f32_16x16x32_bf16 a[32:35], v[56:59], v[32:35], a[32:35]
    ds_read_b128 v[116:119], v10 offset:4096
    v_mfma_f32_16x16x32_bf16 a[36:39], v[56:59], v[36:39], a[36:39]
    ds_read_b128 v[120:123], v10 offset:5120
    v_mfma_f32_16x16x32_bf16 a[40:43], v[56:59], v[40:43], a[40:43]
    ds_read_b128 v[124:127], v10 offset:6144
    v_mfma_f32_16x16x32_bf16 a[44:47], v[56:59], v[44:47], a[44:47]
    ds_read_b128 v[128:131], v10 offset:7168
    v_mfma_f32_16x16x32_bf16 a[48:51], v[60:63], v[32:35], a[48:51]
    ds_read_b128 v[132:135], v10 offset:8192
    v_mfma_f32_16x16x32_bf16 a[52:55], v[60:63], v[36:39], a[52:55]
    v_mfma_f32_16x16x32_bf16 a[56:59], v[60:63], v[40:43], a[56:59]
    v_mfma_f32_16x16x32_bf16 a[60:63], v[60:63], v[44:47], a[60:63]
    v_mfma_f32_16x16x32_bf16 a[64:67], v[64:67], v[32:35], a[64:67]
    v_mfma_f32_16x16x32_bf16 a[68:71], v[64:67], v[36:39], a[68:71]
    v_mfma_f32_16x16x32_bf16 a[72:75], v[64:67], v[40:43], a[72:75]
    v_mfma_f32_16x16x32_bf16 a[76:79], v[64:67], v[44:47], a[76:79]
    v_mfma_f32_16x16x32_bf16 a[80:83], v[68:71], v[32:35], a[80:83]
    v_mfma_f32_16x16x32_bf16 a[84:87], v[68:71], v[36:39], a[84:87]
    v_mfma_f32_16x16x32_bf16 a[88:91], v[68:71], v[40:43], a[88:91]
    v_mfma_f32_16x16x32_bf16 a[92:95], v[68:71], v[44:47], a[92:95]
    v_mfma_f32_16x16x32_bf16 a[96:99], v[72:75], v[32:35], a[96:99]
    v_mfma_f32_16x16x32_bf16 a[100:103], v[72:75], v[36:39], a[100:103]
    v_mfma_f32_16x16x32_bf16 a[104:107], v[72:75], v[40:43], a[104:107]
    v_mfma_f32_16x16x32_bf16 a[108:111], v[72:75], v[44:47], a[108:111]
    v_mfma_f32_16x16x32_bf16 a[112:115], v[76:79], v[32:35], a[112:115]
    v_mfma_f32_16x16x32_bf16 a[116:119], v[76:79], v[36:39], a[116:119]
    v_mfma_f32_16x16x32_bf16 a[120:123], v[76:79], v[40:43], a[120:123]
    v_mfma_f32_16x16x32_bf16 a[124:127], v[76:79], v[44:47], a[124:127]
    v_mfma_f32_16x16x32_bf16 a[128:131], v[80:83], v[32:35], a[128:131]
    v_mfma_f32_16x16x32_bf16 a[132:135], v[80:83], v[36:39], a[132:135]
    v_mfma_f32_16x16x32_bf16 a[136:139], v[80:83], v[40:43], a[136:139]
    v_mfma_f32_16x16x32_bf16 a[140:143], v[80:83], v[44:47], a[140:143]
    s_waitcnt vmcnt(0) lgkmcnt(0)
    s_barrier
    v_mfma_f32_16x16x32_bf16 a[0:3], v[100:103], v[84:87], a[0:3]
    v_mfma_f32_16x16x32_bf16 a[4:7], v[100:103], v[88:91], a[4:7]
    v_mfma_f32_16x16x32_bf16 a[8:11], v[100:103], v[92:95], a[8:11]
    v_mfma_f32_16x16x32_bf16 a[12:15], v[100:103], v[96:99], a[12:15]
    v_mfma_f32_16x16x32_bf16 a[16:19], v[104:107], v[84:87], a[16:19]
    v_mfma_f32_16x16x32_bf16 a[20:23], v[104:107], v[88:91], a[20:23]
    v_mfma_f32_16x16x32_bf16 a[24:27], v[104:107], v[92:95], a[24:27]
    v_mfma_f32_16x16x32_bf16 a[28:31], v[104:107], v[96:99], a[28:31]
    v_mfma_f32_16x16x32_bf16 a[32:35], v[108:111], v[84:87], a[32:35]
    v_mfma_f32_16x16x32_bf16 a[36:39], v[108:111], v[88:91], a[36:39]
    v_mfma_f32_16x16x32_bf16 a[40:43], v[108:111], v[92:95], a[40:43]
    v_mfma_f32_16x16x32_bf16 a[44:47], v[108:111], v[96:99], a[44:47]
    v_mfma_f32_16x16x32_bf16 a[48:51], v[112:115], v[84:87], a[48:51]
    v_mfma_f32_16x16x32_bf16 a[52:55], v[112:115], v[88:91], a[52:55]
    v_mfma_f32_16x16x32_bf16 a[56:59], v[112:115], v[92:95], a[56:59]
    v_mfma_f32_16x16x32_bf16 a[60:63], v[112:115], v[96:99], a[60:63]
    v_mfma_f32_16x16x32_bf16 a[64:67], v[116:119], v[84:87], a[64:67]
    v_mfma_f32_16x16x32_bf16 a[68:71], v[116:119], v[88:91], a[68:71]
    v_mfma_f32_16x16x32_bf16 a[72:75], v[116:119], v[92:95], a[72:75]
    v_mfma_f32_16x16x32_bf16 a[76:79], v[116:119], v[96:99], a[76:79]
    v_mfma_f32_16x16x32_bf16 a[80:83], v[120:123], v[84:87], a[80:83]
    v_mfma_f32_16x16x32_bf16 a[84:87], v[120:123], v[88:91], a[84:87]
    v_mfma_f32_16x16x32_bf16 a[88:91], v[120:123], v[92:95], a[88:91]
    v_mfma_f32_16x16x32_bf16 a[92:95], v[120:123], v[96:99], a[92:95]
    v_mfma_f32_16x16x32_bf16 a[96:99], v[124:127], v[84:87], a[96:99]
    v_mfma_f32_16x16x32_bf16 a[100:103], v[124:127], v[88:91], a[100:103]
    v_mfma_f32_16x16x32_bf16 a[104:107], v[124:127], v[92:95], a[104:107]
    v_mfma_f32_16x16x32_bf16 a[108:111], v[124:127], v[96:99], a[108:111]
    v_mfma_f32_16x16x32_bf16 a[112:115], v[128:131], v[84:87], a[112:115]
    v_mfma_f32_16x16x32_bf16 a[116:119], v[128:131], v[88:91], a[116:119]
    v_mfma_f32_16x16x32_bf16 a[120:123], v[128:131], v[92:95], a[120:123]
    v_mfma_f32_16x16x32_bf16 a[124:127], v[128:131], v[96:99], a[124:127]
    v_mfma_f32_16x16x32_bf16 a[128:131], v[132:135], v[84:87], a[128:131]
    v_mfma_f32_16x16x32_bf16 a[132:135], v[132:135], v[88:91], a[132:135]
    v_mfma_f32_16x16x32_bf16 a[136:139], v[132:135], v[92:95], a[136:139]
    v_mfma_f32_16x16x32_bf16 a[140:143], v[132:135], v[96:99], a[140:143]
    s_nop 7
    s_nop 7
    s_barrier
    v_and_b32 v140, 15, v2
    v_lshlrev_b32 v140, 4, v140
    v_lshrrev_b32 v141, 4, v2
    v_lshl_add_u32 v140, v141, 2, v140
    s_mul_i32 s52, s7, 14
    s_lshl_b32 s53, s6, 3
    s_lshl_b32 s54, s9, 2
    s_add_u32 s53, s53, s54
    s_mul_i32 s53, s53, 57344
    s_mov_b32 s55, 0xffff0000
    s_add_u32 s56, s52, 5
    s_lshl_b32 s56, s56, 8
    s_add_u32 s56, s56, s53
    v_accvgpr_read_b32 v142, a0
    v_accvgpr_read_b32 v143, a1
    v_accvgpr_read_b32 v144, a2
    v_accvgpr_read_b32 v145, a3
    v_cvt_pk_bf16_f32 v146, v142, v143
    v_cvt_pk_bf16_f32 v147, v144, v145
    v_lshlrev_b32 v142, 16, v146
    v_and_b32 v143, s55, v146
    v_lshlrev_b32 v144, 16, v147
    v_and_b32 v145, s55, v147
    v_mul_f32 v142, v142, v143
    v_mul_f32 v144, v144, v145
    v_cvt_pk_bf16_f32 v148, v142, v144
    s_add_u32 s57, s56, 0
    buffer_store_dword v148, v140, s[24:27], s57 offen
    v_accvgpr_read_b32 v142, a4
    v_accvgpr_read_b32 v143, a5
    v_accvgpr_read_b32 v144, a6
    v_accvgpr_read_b32 v145, a7
    v_cvt_pk_bf16_f32 v146, v142, v143
    v_cvt_pk_bf16_f32 v147, v144, v145
    v_lshlrev_b32 v142, 16, v146
    v_and_b32 v143, s55, v146
    v_lshlrev_b32 v144, 16, v147
    v_and_b32 v145, s55, v147
    v_mul_f32 v142, v142, v143
    v_mul_f32 v144, v144, v145
    v_cvt_pk_bf16_f32 v149, v142, v144
    s_add_u32 s57, s56, 57344
    buffer_store_dword v149, v140, s[24:27], s57 offen
    v_accvgpr_read_b32 v142, a8
    v_accvgpr_read_b32 v143, a9
    v_accvgpr_read_b32 v144, a10
    v_accvgpr_read_b32 v145, a11
    v_cvt_pk_bf16_f32 v146, v142, v143
    v_cvt_pk_bf16_f32 v147, v144, v145
    v_lshlrev_b32 v142, 16, v146
    v_and_b32 v143, s55, v146
    v_lshlrev_b32 v144, 16, v147
    v_and_b32 v145, s55, v147
    v_mul_f32 v142, v142, v143
    v_mul_f32 v144, v144, v145
    v_cvt_pk_bf16_f32 v150, v142, v144
    s_add_u32 s57, s56, 114688
    buffer_store_dword v150, v140, s[24:27], s57 offen
    v_accvgpr_read_b32 v142, a12
    v_accvgpr_read_b32 v143, a13
    v_accvgpr_read_b32 v144, a14
    v_accvgpr_read_b32 v145, a15
    v_cvt_pk_bf16_f32 v146, v142, v143
    v_cvt_pk_bf16_f32 v147, v144, v145
    v_lshlrev_b32 v142, 16, v146
    v_and_b32 v143, s55, v146
    v_lshlrev_b32 v144, 16, v147
    v_and_b32 v145, s55, v147
    v_mul_f32 v142, v142, v143
    v_mul_f32 v144, v144, v145
    v_cvt_pk_bf16_f32 v151, v142, v144
    s_add_u32 s57, s56, 172032
    buffer_store_dword v151, v140, s[24:27], s57 offen
    s_add_u32 s56, s52, 6
    s_lshl_b32 s56, s56, 8
    s_add_u32 s56, s56, s53
    v_accvgpr_read_b32 v142, a16
    v_accvgpr_read_b32 v143, a17
    v_accvgpr_read_b32 v144, a18
    v_accvgpr_read_b32 v145, a19
    v_cvt_pk_bf16_f32 v146, v142, v143
    v_cvt_pk_bf16_f32 v147, v144, v145
    v_lshlrev_b32 v142, 16, v146
    v_and_b32 v143, s55, v146
    v_lshlrev_b32 v144, 16, v147
    v_and_b32 v145, s55, v147
    v_mul_f32 v142, v142, v143
    v_mul_f32 v144, v144, v145
    v_cvt_pk_bf16_f32 v148, v142, v144
    s_add_u32 s57, s56, 0
    buffer_store_dword v148, v140, s[24:27], s57 offen
    v_accvgpr_read_b32 v142, a20
    v_accvgpr_read_b32 v143, a21
    v_accvgpr_read_b32 v144, a22
    v_accvgpr_read_b32 v145, a23
    v_cvt_pk_bf16_f32 v146, v142, v143
    v_cvt_pk_bf16_f32 v147, v144, v145
    v_lshlrev_b32 v142, 16, v146
    v_and_b32 v143, s55, v146
    v_lshlrev_b32 v144, 16, v147
    v_and_b32 v145, s55, v147
    v_mul_f32 v142, v142, v143
    v_mul_f32 v144, v144, v145
    v_cvt_pk_bf16_f32 v149, v142, v144
    s_add_u32 s57, s56, 57344
    buffer_store_dword v149, v140, s[24:27], s57 offen
    v_accvgpr_read_b32 v142, a24
    v_accvgpr_read_b32 v143, a25
    v_accvgpr_read_b32 v144, a26
    v_accvgpr_read_b32 v145, a27
    v_cvt_pk_bf16_f32 v146, v142, v143
    v_cvt_pk_bf16_f32 v147, v144, v145
    v_lshlrev_b32 v142, 16, v146
    v_and_b32 v143, s55, v146
    v_lshlrev_b32 v144, 16, v147
    v_and_b32 v145, s55, v147
    v_mul_f32 v142, v142, v143
    v_mul_f32 v144, v144, v145
    v_cvt_pk_bf16_f32 v150, v142, v144
    s_add_u32 s57, s56, 114688
    buffer_store_dword v150, v140, s[24:27], s57 offen
    v_accvgpr_read_b32 v142, a28
    v_accvgpr_read_b32 v143, a29
    v_accvgpr_read_b32 v144, a30
    v_accvgpr_read_b32 v145, a31
    v_cvt_pk_bf16_f32 v146, v142, v143
    v_cvt_pk_bf16_f32 v147, v144, v145
    v_lshlrev_b32 v142, 16, v146
    v_and_b32 v143, s55, v146
    v_lshlrev_b32 v144, 16, v147
    v_and_b32 v145, s55, v147
    v_mul_f32 v142, v142, v143
    v_mul_f32 v144, v144, v145
    v_cvt_pk_bf16_f32 v151, v142, v144
    s_add_u32 s57, s56, 172032
    buffer_store_dword v151, v140, s[24:27], s57 offen
    s_add_u32 s56, s52, 7
    s_lshl_b32 s56, s56, 8
    s_add_u32 s56, s56, s53
    v_accvgpr_read_b32 v142, a32
    v_accvgpr_read_b32 v143, a33
    v_accvgpr_read_b32 v144, a34
    v_accvgpr_read_b32 v145, a35
    v_cvt_pk_bf16_f32 v146, v142, v143
    v_cvt_pk_bf16_f32 v147, v144, v145
    v_lshlrev_b32 v142, 16, v146
    v_and_b32 v143, s55, v146
    v_lshlrev_b32 v144, 16, v147
    v_and_b32 v145, s55, v147
    v_mul_f32 v142, v142, v143
    v_mul_f32 v144, v144, v145
    v_cvt_pk_bf16_f32 v148, v142, v144
    s_add_u32 s57, s56, 0
    buffer_store_dword v148, v140, s[24:27], s57 offen
    v_accvgpr_read_b32 v142, a36
    v_accvgpr_read_b32 v143, a37
    v_accvgpr_read_b32 v144, a38
    v_accvgpr_read_b32 v145, a39
    v_cvt_pk_bf16_f32 v146, v142, v143
    v_cvt_pk_bf16_f32 v147, v144, v145
    v_lshlrev_b32 v142, 16, v146
    v_and_b32 v143, s55, v146
    v_lshlrev_b32 v144, 16, v147
    v_and_b32 v145, s55, v147
    v_mul_f32 v142, v142, v143
    v_mul_f32 v144, v144, v145
    v_cvt_pk_bf16_f32 v149, v142, v144
    s_add_u32 s57, s56, 57344
    buffer_store_dword v149, v140, s[24:27], s57 offen
    v_accvgpr_read_b32 v142, a40
    v_accvgpr_read_b32 v143, a41
    v_accvgpr_read_b32 v144, a42
    v_accvgpr_read_b32 v145, a43
    v_cvt_pk_bf16_f32 v146, v142, v143
    v_cvt_pk_bf16_f32 v147, v144, v145
    v_lshlrev_b32 v142, 16, v146
    v_and_b32 v143, s55, v146
    v_lshlrev_b32 v144, 16, v147
    v_and_b32 v145, s55, v147
    v_mul_f32 v142, v142, v143
    v_mul_f32 v144, v144, v145
    v_cvt_pk_bf16_f32 v150, v142, v144
    s_add_u32 s57, s56, 114688
    buffer_store_dword v150, v140, s[24:27], s57 offen
    v_accvgpr_read_b32 v142, a44
    v_accvgpr_read_b32 v143, a45
    v_accvgpr_read_b32 v144, a46
    v_accvgpr_read_b32 v145, a47
    v_cvt_pk_bf16_f32 v146, v142, v143
    v_cvt_pk_bf16_f32 v147, v144, v145
    v_lshlrev_b32 v142, 16, v146
    v_and_b32 v143, s55, v146
    v_lshlrev_b32 v144, 16, v147
    v_and_b32 v145, s55, v147
    v_mul_f32 v142, v142, v143
    v_mul_f32 v144, v144, v145
    v_cvt_pk_bf16_f32 v151, v142, v144
    s_add_u32 s57, s56, 172032
    buffer_store_dword v151, v140, s[24:27], s57 offen
    s_add_u32 s56, s52, 8
    s_lshl_b32 s56, s56, 8
    s_add_u32 s56, s56, s53
    v_accvgpr_read_b32 v142, a48
    v_accvgpr_read_b32 v143, a49
    v_accvgpr_read_b32 v144, a50
    v_accvgpr_read_b32 v145, a51
    v_cvt_pk_bf16_f32 v146, v142, v143
    v_cvt_pk_bf16_f32 v147, v144, v145
    v_lshlrev_b32 v142, 16, v146
    v_and_b32 v143, s55, v146
    v_lshlrev_b32 v144, 16, v147
    v_and_b32 v145, s55, v147
    v_mul_f32 v142, v142, v143
    v_mul_f32 v144, v144, v145
    v_cvt_pk_bf16_f32 v148, v142, v144
    s_add_u32 s57, s56, 0
    buffer_store_dword v148, v140, s[24:27], s57 offen
    v_accvgpr_read_b32 v142, a52
    v_accvgpr_read_b32 v143, a53
    v_accvgpr_read_b32 v144, a54
    v_accvgpr_read_b32 v145, a55
    v_cvt_pk_bf16_f32 v146, v142, v143
    v_cvt_pk_bf16_f32 v147, v144, v145
    v_lshlrev_b32 v142, 16, v146
    v_and_b32 v143, s55, v146
    v_lshlrev_b32 v144, 16, v147
    v_and_b32 v145, s55, v147
    v_mul_f32 v142, v142, v143
    v_mul_f32 v144, v144, v145
    v_cvt_pk_bf16_f32 v149, v142, v144
    s_add_u32 s57, s56, 57344
    buffer_store_dword v149, v140, s[24:27], s57 offen
    v_accvgpr_read_b32 v142, a56
    v_accvgpr_read_b32 v143, a57
    v_accvgpr_read_b32 v144, a58
    v_accvgpr_read_b32 v145, a59
    v_cvt_pk_bf16_f32 v146, v142, v143
    v_cvt_pk_bf16_f32 v147, v144, v145
    v_lshlrev_b32 v142, 16, v146
    v_and_b32 v143, s55, v146
    v_lshlrev_b32 v144, 16, v147
    v_and_b32 v145, s55, v147
    v_mul_f32 v142, v142, v143
    v_mul_f32 v144, v144, v145
    v_cvt_pk_bf16_f32 v150, v142, v144
    s_add_u32 s57, s56, 114688
    buffer_store_dword v150, v140, s[24:27], s57 offen
    v_accvgpr_read_b32 v142, a60
    v_accvgpr_read_b32 v143, a61
    v_accvgpr_read_b32 v144, a62
    v_accvgpr_read_b32 v145, a63
    v_cvt_pk_bf16_f32 v146, v142, v143
    v_cvt_pk_bf16_f32 v147, v144, v145
    v_lshlrev_b32 v142, 16, v146
    v_and_b32 v143, s55, v146
    v_lshlrev_b32 v144, 16, v147
    v_and_b32 v145, s55, v147
    v_mul_f32 v142, v142, v143
    v_mul_f32 v144, v144, v145
    v_cvt_pk_bf16_f32 v151, v142, v144
    s_add_u32 s57, s56, 172032
    buffer_store_dword v151, v140, s[24:27], s57 offen
    s_add_u32 s56, s52, 9
    s_lshl_b32 s56, s56, 8
    s_add_u32 s56, s56, s53
    v_accvgpr_read_b32 v142, a64
    v_accvgpr_read_b32 v143, a65
    v_accvgpr_read_b32 v144, a66
    v_accvgpr_read_b32 v145, a67
    v_cvt_pk_bf16_f32 v146, v142, v143
    v_cvt_pk_bf16_f32 v147, v144, v145
    v_lshlrev_b32 v142, 16, v146
    v_and_b32 v143, s55, v146
    v_lshlrev_b32 v144, 16, v147
    v_and_b32 v145, s55, v147
    v_mul_f32 v142, v142, v143
    v_mul_f32 v144, v144, v145
    v_cvt_pk_bf16_f32 v148, v142, v144
    s_add_u32 s57, s56, 0
    buffer_store_dword v148, v140, s[24:27], s57 offen
    v_accvgpr_read_b32 v142, a68
    v_accvgpr_read_b32 v143, a69
    v_accvgpr_read_b32 v144, a70
    v_accvgpr_read_b32 v145, a71
    v_cvt_pk_bf16_f32 v146, v142, v143
    v_cvt_pk_bf16_f32 v147, v144, v145
    v_lshlrev_b32 v142, 16, v146
    v_and_b32 v143, s55, v146
    v_lshlrev_b32 v144, 16, v147
    v_and_b32 v145, s55, v147
    v_mul_f32 v142, v142, v143
    v_mul_f32 v144, v144, v145
    v_cvt_pk_bf16_f32 v149, v142, v144
    s_add_u32 s57, s56, 57344
    buffer_store_dword v149, v140, s[24:27], s57 offen
    v_accvgpr_read_b32 v142, a72
    v_accvgpr_read_b32 v143, a73
    v_accvgpr_read_b32 v144, a74
    v_accvgpr_read_b32 v145, a75
    v_cvt_pk_bf16_f32 v146, v142, v143
    v_cvt_pk_bf16_f32 v147, v144, v145
    v_lshlrev_b32 v142, 16, v146
    v_and_b32 v143, s55, v146
    v_lshlrev_b32 v144, 16, v147
    v_and_b32 v145, s55, v147
    v_mul_f32 v142, v142, v143
    v_mul_f32 v144, v144, v145
    v_cvt_pk_bf16_f32 v150, v142, v144
    s_add_u32 s57, s56, 114688
    buffer_store_dword v150, v140, s[24:27], s57 offen
    v_accvgpr_read_b32 v142, a76
    v_accvgpr_read_b32 v143, a77
    v_accvgpr_read_b32 v144, a78
    v_accvgpr_read_b32 v145, a79
    v_cvt_pk_bf16_f32 v146, v142, v143
    v_cvt_pk_bf16_f32 v147, v144, v145
    v_lshlrev_b32 v142, 16, v146
    v_and_b32 v143, s55, v146
    v_lshlrev_b32 v144, 16, v147
    v_and_b32 v145, s55, v147
    v_mul_f32 v142, v142, v143
    v_mul_f32 v144, v144, v145
    v_cvt_pk_bf16_f32 v151, v142, v144
    s_add_u32 s57, s56, 172032
    buffer_store_dword v151, v140, s[24:27], s57 offen
    s_add_u32 s56, s52, 10
    s_lshl_b32 s56, s56, 8
    s_add_u32 s56, s56, s53
    v_accvgpr_read_b32 v142, a80
    v_accvgpr_read_b32 v143, a81
    v_accvgpr_read_b32 v144, a82
    v_accvgpr_read_b32 v145, a83
    v_cvt_pk_bf16_f32 v146, v142, v143
    v_cvt_pk_bf16_f32 v147, v144, v145
    v_lshlrev_b32 v142, 16, v146
    v_and_b32 v143, s55, v146
    v_lshlrev_b32 v144, 16, v147
    v_and_b32 v145, s55, v147
    v_mul_f32 v142, v142, v143
    v_mul_f32 v144, v144, v145
    v_cvt_pk_bf16_f32 v148, v142, v144
    s_add_u32 s57, s56, 0
    buffer_store_dword v148, v140, s[24:27], s57 offen
    v_accvgpr_read_b32 v142, a84
    v_accvgpr_read_b32 v143, a85
    v_accvgpr_read_b32 v144, a86
    v_accvgpr_read_b32 v145, a87
    v_cvt_pk_bf16_f32 v146, v142, v143
    v_cvt_pk_bf16_f32 v147, v144, v145
    v_lshlrev_b32 v142, 16, v146
    v_and_b32 v143, s55, v146
    v_lshlrev_b32 v144, 16, v147
    v_and_b32 v145, s55, v147
    v_mul_f32 v142, v142, v143
    v_mul_f32 v144, v144, v145
    v_cvt_pk_bf16_f32 v149, v142, v144
    s_add_u32 s57, s56, 57344
    buffer_store_dword v149, v140, s[24:27], s57 offen
    v_accvgpr_read_b32 v142, a88
    v_accvgpr_read_b32 v143, a89
    v_accvgpr_read_b32 v144, a90
    v_accvgpr_read_b32 v145, a91
    v_cvt_pk_bf16_f32 v146, v142, v143
    v_cvt_pk_bf16_f32 v147, v144, v145
    v_lshlrev_b32 v142, 16, v146
    v_and_b32 v143, s55, v146
    v_lshlrev_b32 v144, 16, v147
    v_and_b32 v145, s55, v147
    v_mul_f32 v142, v142, v143
    v_mul_f32 v144, v144, v145
    v_cvt_pk_bf16_f32 v150, v142, v144
    s_add_u32 s57, s56, 114688
    buffer_store_dword v150, v140, s[24:27], s57 offen
    v_accvgpr_read_b32 v142, a92
    v_accvgpr_read_b32 v143, a93
    v_accvgpr_read_b32 v144, a94
    v_accvgpr_read_b32 v145, a95
    v_cvt_pk_bf16_f32 v146, v142, v143
    v_cvt_pk_bf16_f32 v147, v144, v145
    v_lshlrev_b32 v142, 16, v146
    v_and_b32 v143, s55, v146
    v_lshlrev_b32 v144, 16, v147
    v_and_b32 v145, s55, v147
    v_mul_f32 v142, v142, v143
    v_mul_f32 v144, v144, v145
    v_cvt_pk_bf16_f32 v151, v142, v144
    s_add_u32 s57, s56, 172032
    buffer_store_dword v151, v140, s[24:27], s57 offen
    s_add_u32 s56, s52, 11
    s_lshl_b32 s56, s56, 8
    s_add_u32 s56, s56, s53
    v_accvgpr_read_b32 v142, a96
    v_accvgpr_read_b32 v143, a97
    v_accvgpr_read_b32 v144, a98
    v_accvgpr_read_b32 v145, a99
    v_cvt_pk_bf16_f32 v146, v142, v143
    v_cvt_pk_bf16_f32 v147, v144, v145
    v_lshlrev_b32 v142, 16, v146
    v_and_b32 v143, s55, v146
    v_lshlrev_b32 v144, 16, v147
    v_and_b32 v145, s55, v147
    v_mul_f32 v142, v142, v143
    v_mul_f32 v144, v144, v145
    v_cvt_pk_bf16_f32 v148, v142, v144
    s_add_u32 s57, s56, 0
    buffer_store_dword v148, v140, s[24:27], s57 offen
    v_accvgpr_read_b32 v142, a100
    v_accvgpr_read_b32 v143, a101
    v_accvgpr_read_b32 v144, a102
    v_accvgpr_read_b32 v145, a103
    v_cvt_pk_bf16_f32 v146, v142, v143
    v_cvt_pk_bf16_f32 v147, v144, v145
    v_lshlrev_b32 v142, 16, v146
    v_and_b32 v143, s55, v146
    v_lshlrev_b32 v144, 16, v147
    v_and_b32 v145, s55, v147
    v_mul_f32 v142, v142, v143
    v_mul_f32 v144, v144, v145
    v_cvt_pk_bf16_f32 v149, v142, v144
    s_add_u32 s57, s56, 57344
    buffer_store_dword v149, v140, s[24:27], s57 offen
    v_accvgpr_read_b32 v142, a104
    v_accvgpr_read_b32 v143, a105
    v_accvgpr_read_b32 v144, a106
    v_accvgpr_read_b32 v145, a107
    v_cvt_pk_bf16_f32 v146, v142, v143
    v_cvt_pk_bf16_f32 v147, v144, v145
    v_lshlrev_b32 v142, 16, v146
    v_and_b32 v143, s55, v146
    v_lshlrev_b32 v144, 16, v147
    v_and_b32 v145, s55, v147
    v_mul_f32 v142, v142, v143
    v_mul_f32 v144, v144, v145
    v_cvt_pk_bf16_f32 v150, v142, v144
    s_add_u32 s57, s56, 114688
    buffer_store_dword v150, v140, s[24:27], s57 offen
    v_accvgpr_read_b32 v142, a108
    v_accvgpr_read_b32 v143, a109
    v_accvgpr_read_b32 v144, a110
    v_accvgpr_read_b32 v145, a111
    v_cvt_pk_bf16_f32 v146, v142, v143
    v_cvt_pk_bf16_f32 v147, v144, v145
    v_lshlrev_b32 v142, 16, v146
    v_and_b32 v143, s55, v146
    v_lshlrev_b32 v144, 16, v147
    v_and_b32 v145, s55, v147
    v_mul_f32 v142, v142, v143
    v_mul_f32 v144, v144, v145
    v_cvt_pk_bf16_f32 v151, v142, v144
    s_add_u32 s57, s56, 172032
    buffer_store_dword v151, v140, s[24:27], s57 offen
    s_add_u32 s56, s52, 12
    s_lshl_b32 s56, s56, 8
    s_add_u32 s56, s56, s53
    v_accvgpr_read_b32 v142, a112
    v_accvgpr_read_b32 v143, a113
    v_accvgpr_read_b32 v144, a114
    v_accvgpr_read_b32 v145, a115
    v_cvt_pk_bf16_f32 v146, v142, v143
    v_cvt_pk_bf16_f32 v147, v144, v145
    v_lshlrev_b32 v142, 16, v146
    v_and_b32 v143, s55, v146
    v_lshlrev_b32 v144, 16, v147
    v_and_b32 v145, s55, v147
    v_mul_f32 v142, v142, v143
    v_mul_f32 v144, v144, v145
    v_cvt_pk_bf16_f32 v148, v142, v144
    s_add_u32 s57, s56, 0
    buffer_store_dword v148, v140, s[24:27], s57 offen
    v_accvgpr_read_b32 v142, a116
    v_accvgpr_read_b32 v143, a117
    v_accvgpr_read_b32 v144, a118
    v_accvgpr_read_b32 v145, a119
    v_cvt_pk_bf16_f32 v146, v142, v143
    v_cvt_pk_bf16_f32 v147, v144, v145
    v_lshlrev_b32 v142, 16, v146
    v_and_b32 v143, s55, v146
    v_lshlrev_b32 v144, 16, v147
    v_and_b32 v145, s55, v147
    v_mul_f32 v142, v142, v143
    v_mul_f32 v144, v144, v145
    v_cvt_pk_bf16_f32 v149, v142, v144
    s_add_u32 s57, s56, 57344
    buffer_store_dword v149, v140, s[24:27], s57 offen
    v_accvgpr_read_b32 v142, a120
    v_accvgpr_read_b32 v143, a121
    v_accvgpr_read_b32 v144, a122
    v_accvgpr_read_b32 v145, a123
    v_cvt_pk_bf16_f32 v146, v142, v143
    v_cvt_pk_bf16_f32 v147, v144, v145
    v_lshlrev_b32 v142, 16, v146
    v_and_b32 v143, s55, v146
    v_lshlrev_b32 v144, 16, v147
    v_and_b32 v145, s55, v147
    v_mul_f32 v142, v142, v143
    v_mul_f32 v144, v144, v145
    v_cvt_pk_bf16_f32 v150, v142, v144
    s_add_u32 s57, s56, 114688
    buffer_store_dword v150, v140, s[24:27], s57 offen
    v_accvgpr_read_b32 v142, a124
    v_accvgpr_read_b32 v143, a125
    v_accvgpr_read_b32 v144, a126
    v_accvgpr_read_b32 v145, a127
    v_cvt_pk_bf16_f32 v146, v142, v143
    v_cvt_pk_bf16_f32 v147, v144, v145
    v_lshlrev_b32 v142, 16, v146
    v_and_b32 v143, s55, v146
    v_lshlrev_b32 v144, 16, v147
    v_and_b32 v145, s55, v147
    v_mul_f32 v142, v142, v143
    v_mul_f32 v144, v144, v145
    v_cvt_pk_bf16_f32 v151, v142, v144
    s_add_u32 s57, s56, 172032
    buffer_store_dword v151, v140, s[24:27], s57 offen
    s_add_u32 s56, s52, 13
    s_lshl_b32 s56, s56, 8
    s_add_u32 s56, s56, s53
    v_accvgpr_read_b32 v142, a128
    v_accvgpr_read_b32 v143, a129
    v_accvgpr_read_b32 v144, a130
    v_accvgpr_read_b32 v145, a131
    v_cvt_pk_bf16_f32 v146, v142, v143
    v_cvt_pk_bf16_f32 v147, v144, v145
    v_lshlrev_b32 v142, 16, v146
    v_and_b32 v143, s55, v146
    v_lshlrev_b32 v144, 16, v147
    v_and_b32 v145, s55, v147
    v_mul_f32 v142, v142, v143
    v_mul_f32 v144, v144, v145
    v_cvt_pk_bf16_f32 v148, v142, v144
    s_add_u32 s57, s56, 0
    buffer_store_dword v148, v140, s[24:27], s57 offen
    v_accvgpr_read_b32 v142, a132
    v_accvgpr_read_b32 v143, a133
    v_accvgpr_read_b32 v144, a134
    v_accvgpr_read_b32 v145, a135
    v_cvt_pk_bf16_f32 v146, v142, v143
    v_cvt_pk_bf16_f32 v147, v144, v145
    v_lshlrev_b32 v142, 16, v146
    v_and_b32 v143, s55, v146
    v_lshlrev_b32 v144, 16, v147
    v_and_b32 v145, s55, v147
    v_mul_f32 v142, v142, v143
    v_mul_f32 v144, v144, v145
    v_cvt_pk_bf16_f32 v149, v142, v144
    s_add_u32 s57, s56, 57344
    buffer_store_dword v149, v140, s[24:27], s57 offen
    v_accvgpr_read_b32 v142, a136
    v_accvgpr_read_b32 v143, a137
    v_accvgpr_read_b32 v144, a138
    v_accvgpr_read_b32 v145, a139
    v_cvt_pk_bf16_f32 v146, v142, v143
    v_cvt_pk_bf16_f32 v147, v144, v145
    v_lshlrev_b32 v142, 16, v146
    v_and_b32 v143, s55, v146
    v_lshlrev_b32 v144, 16, v147
    v_and_b32 v145, s55, v147
    v_mul_f32 v142, v142, v143
    v_mul_f32 v144, v144, v145
    v_cvt_pk_bf16_f32 v150, v142, v144
    s_add_u32 s57, s56, 114688
    buffer_store_dword v150, v140, s[24:27], s57 offen
    v_accvgpr_read_b32 v142, a140
    v_accvgpr_read_b32 v143, a141
    v_accvgpr_read_b32 v144, a142
    v_accvgpr_read_b32 v145, a143
    v_cvt_pk_bf16_f32 v146, v142, v143
    v_cvt_pk_bf16_f32 v147, v144, v145
    v_lshlrev_b32 v142, 16, v146
    v_and_b32 v143, s55, v146
    v_lshlrev_b32 v144, 16, v147
    v_and_b32 v145, s55, v147
    v_mul_f32 v142, v142, v143
    v_mul_f32 v144, v144, v145
    v_cvt_pk_bf16_f32 v151, v142, v144
    s_add_u32 s57, s56, 172032
    buffer_store_dword v151, v140, s[24:27], s57 offen
K1_done:
    s_endpgm
.section .rodata,"a"
.p2align 6
.amdhsa_kernel k1_kernel
  .amdhsa_next_free_vgpr 304
  .amdhsa_next_free_sgpr 96
  .amdhsa_accum_offset 160
  .amdhsa_group_segment_fixed_size 0
  .amdhsa_kernarg_size 128
  .amdhsa_user_sgpr_count 2
  .amdhsa_user_sgpr_kernarg_segment_ptr 1
  .amdhsa_system_sgpr_workgroup_id_x 1
.end_amdhsa_kernel
.text
.globl k2_kernel
.p2align 8
.type k2_kernel,@function
k2_kernel:
    s_cmp_ge_u32 s2, 256
    s_cbranch_scc1 K2_done
    s_load_dwordx2 s[4:5], s[0:1], 120
    s_load_dwordx2 s[36:37], s[0:1], 0
    s_load_dwordx2 s[38:39], s[0:1], 104
    s_and_b32 s6, s2, 7
    s_lshr_b32 s7, s2, 3
    s_lshl_b32 s6, s6, 2
    s_and_b32 s8, s7, 3
    s_add_u32 s6, s6, s8
    s_lshr_b32 s7, s7, 2
    v_lshrrev_b32 v1, 6, v0
    v_and_b32 v2, 63, v0
    s_nop 0
    v_readfirstlane_b32 s8, v1
    s_waitcnt lgkmcnt(0)
    s_add_u32 s12, s4, 16777216
    s_addc_u32 s13, s5, 0
    s_mov_b32 s14, 4194304
    s_mov_b32 s15, 0x00020000
    s_add_u32 s16, s4, 10485760
    s_addc_u32 s17, s5, 0
    s_mov_b32 s18, 1048576
    s_mov_b32 s19, 0x00020000
    s_add_u32 s20, s4, 20971520
    s_addc_u32 s21, s5, 0
    s_mov_b32 s22, 7340032
    s_mov_b32 s23, 0x00020000
    s_add_u32 s24, s4, 11534336
    s_addc_u32 s25, s5, 0
    s_mov_b32 s26, 1835008
    s_mov_b32 s27, 0x00020000
    s_add_u32 s28, s4, 2097152
    s_addc_u32 s29, s5, 0
    s_mov_b32 s30, 2097152
    s_mov_b32 s31, 0x00020000
    s_mov_b32 s32, s36
    s_mov_b32 s33, s37
    s_mov_b32 s34, 2097152
    s_mov_b32 s35, 0x00020000
    s_mov_b32 s40, s38
    s_mov_b32 s41, s39
    s_mov_b32 s42, 4194304
    s_mov_b32 s43, 0x00020000
    v_lshlrev_b32 v3, 4, v2
    s_lshl_b32 s44, s6, 17
    s_lshl_b32 s45, s8, 13
    s_add_u32 s44, s44, s45
    s_lshl_b32 s46, s7, 17
    s_add_u32 s46, s46, s45
    s_mul_i32 s47, s6, 229376
    s_mul_i32 s45, s8, 14336
    s_add_u32 s47, s47, s45
    s_mul_i32 s48, s7, 229376
    s_add_u32 s48, s48, s45
    s_add_u32 s50, s44, 0
    buffer_load_dwordx4 v[32:35], v3, s[12:15], s50 offen
    s_add_u32 s51, s46, 0
    buffer_load_dwordx4 v[48:51], v3, s[16:19], s51 offen
    s_add_u32 s50, s44, 32768
    buffer_load_dwordx4 v[36:39], v3, s[12:15], s50 offen
    s_add_u32 s51, s46, 32768
    buffer_load_dwordx4 v[52:55], v3, s[16:19], s51 offen
    s_add_u32 s50, s44, 65536
    buffer_load_dwordx4 v[40:43], v3, s[12:15], s50 offen
    s_add_u32 s51, s46, 65536
    buffer_load_dwordx4 v[56:59], v3, s[16:19], s51 offen
    s_add_u32 s50, s44, 98304
    buffer_load_dwordx4 v[44:47], v3, s[12:15], s50 offen
    s_add_u32 s51, s46, 98304
    buffer_load_dwordx4 v[60:63], v3, s[16:19], s51 offen
    s_add_u32 s50, s44, 1024
    buffer_load_dwordx4 v[64:67], v3, s[12:15], s50 offen
    s_add_u32 s51, s46, 1024
    buffer_load_dwordx4 v[80:83], v3, s[16:19], s51 offen
    s_add_u32 s50, s44, 33792
    buffer_load_dwordx4 v[68:71], v3, s[12:15], s50 offen
    s_add_u32 s51, s46, 33792
    buffer_load_dwordx4 v[84:87], v3, s[16:19], s51 offen
    s_add_u32 s50, s44, 66560
    buffer_load_dwordx4 v[72:75], v3, s[12:15], s50 offen
    s_add_u32 s51, s46, 66560
    buffer_load_dwordx4 v[88:91], v3, s[16:19], s51 offen
    s_add_u32 s50, s44, 99328
    buffer_load_dwordx4 v[76:79], v3, s[12:15], s50 offen
    s_add_u32 s51, s46, 99328
    buffer_load_dwordx4 v[92:95], v3, s[16:19], s51 offen
    s_waitcnt vmcnt(8)
    v_mfma_f32_16x16x32_bf16 a[0:3], v[32:35], v[48:51], 0
    s_add_u32 s50, s44, 2048
    v_mfma_f32_16x16x32_bf16 a[4:7], v[36:39], v[48:51], 0
    buffer_load_dwordx4 v[96:99], v3, s[12:15], s50 offen
    v_mfma_f32_16x16x32_bf16 a[8:11], v[40:43], v[48:51], 0
    s_add_u32 s51, s46, 2048
    v_mfma_f32_16x16x32_bf16 a[12:15], v[44:47], v[48:51], 0
    buffer_load_dwordx4 v[112:115], v3, s[16:19], s51 offen
    v_mfma_f32_16x16x32_bf16 a[16:19], v[32:35], v[52:55], 0
    s_add_u32 s50, s44, 34816
    v_mfma_f32_16x16x32_bf16 a[20:23], v[36:39], v[52:55], 0
    buffer_load_dwordx4 v[100:103], v3, s[12:15], s50 offen
    v_mfma_f32_16x16x32_bf16 a[24:27], v[40:43], v[52:55], 0
    s_add_u32 s51, s46, 34816
    v_mfma_f32_16x16x32_bf16 a[28:31], v[44:47], v[52:55], 0
    buffer_load_dwordx4 v[116:119], v3, s[16:19], s51 offen
    v_mfma_f32_16x16x32_bf16 a[32:35], v[32:35], v[56:59], 0
    s_add_u32 s50, s44, 67584
    v_mfma_f32_16x16x32_bf16 a[36:39], v[36:39], v[56:59], 0
    buffer_load_dwordx4 v[104:107], v3, s[12:15], s50 offen
    v_mfma_f32_16x16x32_bf16 a[40:43], v[40:43], v[56:59], 0
    s_add_u32 s51, s46, 67584
    v_mfma_f32_16x16x32_bf16 a[44:47], v[44:47], v[56:59], 0
    buffer_load_dwordx4 v[120:123], v3, s[16:19], s51 offen
    v_mfma_f32_16x16x32_bf16 a[48:51], v[32:35], v[60:63], 0
    s_add_u32 s50, s44, 100352
    v_mfma_f32_16x16x32_bf16 a[52:55], v[36:39], v[60:63], 0
    buffer_load_dwordx4 v[108:111], v3, s[12:15], s50 offen
    v_mfma_f32_16x16x32_bf16 a[56:59], v[40:43], v[60:63], 0
    s_add_u32 s51, s46, 100352
    v_mfma_f32_16x16x32_bf16 a[60:63], v[44:47], v[60:63], 0
    buffer_load_dwordx4 v[124:127], v3, s[16:19], s51 offen
    s_waitcnt vmcnt(8)
    v_mfma_f32_16x16x32_bf16 a[0:3], v[64:67], v[80:83], a[0:3]
    s_add_u32 s50, s44, 3072
    v_mfma_f32_16x16x32_bf16 a[4:7], v[68:71], v[80:83], a[4:7]
    buffer_load_dwordx4 v[32:35], v3, s[12:15], s50 offen
    v_mfma_f32_16x16x32_bf16 a[8:11], v[72:75], v[80:83], a[8:11]
    s_add_u32 s51, s46, 3072
    v_mfma_f32_16x16x32_bf16 a[12:15], v[76:79], v[80:83], a[12:15]
    buffer_load_dwordx4 v[48:51], v3, s[16:19], s51 offen
    v_mfma_f32_16x16x32_bf16 a[16:19], v[64:67], v[84:87], a[16:19]
    s_add_u32 s50, s44, 35840
    v_mfma_f32_16x16x32_bf16 a[20:23], v[68:71], v[84:87], a[20:23]
    buffer_load_dwordx4 v[36:39], v3, s[12:15], s50 offen
    v_mfma_f32_16x16x32_bf16 a[24:27], v[72:75], v[84:87], a[24:27]
    s_add_u32 s51, s46, 35840
    v_mfma_f32_16x16x32_bf16 a[28:31], v[76:79], v[84:87], a[28:31]
    buffer_load_dwordx4 v[52:55], v3, s[16:19], s51 offen
    v_mfma_f32_16x16x32_bf16 a[32:35], v[64:67], v[88:91], a[32:35]
    s_add_u32 s50, s44, 68608
    v_mfma_f32_16x16x32_bf16 a[36:39], v[68:71], v[88:91], a[36:39]
    buffer_load_dwordx4 v[40:43], v3, s[12:15], s50 offen
    v_mfma_f32_16x16x32_bf16 a[40:43], v[72:75], v[88:91], a[40:43]
    s_add_u32 s51, s46, 68608
    v_mfma_f32_16x16x32_bf16 a[44:47], v[76:79], v[88:91], a[44:47]
    buffer_load_dwordx4 v[56:59], v3, s[16:19], s51 offen
    v_mfma_f32_16x16x32_bf16 a[48:51], v[64:67], v[92:95], a[48:51]
    s_add_u32 s50, s44, 101376
    v_mfma_f32_16x16x32_bf16 a[52:55], v[68:71], v[92:95], a[52:55]
    buffer_load_dwordx4 v[44:47], v3, s[12:15], s50 offen
    v_mfma_f32_16x16x32_bf16 a[56:59], v[72:75], v[92:95], a[56:59]
    s_add_u32 s51, s46, 101376
    v_mfma_f32_16x16x32_bf16 a[60:63], v[76:79], v[92:95], a[60:63]
    buffer_load_dwordx4 v[60:63], v3, s[16:19], s51 offen
    s_waitcnt vmcnt(8)
    v_mfma_f32_16x16x32_bf16 a[0:3], v[96:99], v[112:115], a[0:3]
    s_add_u32 s50, s44, 4096
    v_mfma_f32_16x16x32_bf16 a[4:7], v[100:103], v[112:115], a[4:7]
    buffer_load_dwordx4 v[64:67], v3, s[12:15], s50 offen
    v_mfma_f32_16x16x32_bf16 a[8:11], v[104:107], v[112:115], a[8:11]
    s_add_u32 s51, s46, 4096
    v_mfma_f32_16x16x32_bf16 a[12:15], v[108:111], v[112:115], a[12:15]
    buffer_load_dwordx4 v[80:83], v3, s[16:19], s51 offen
    v_mfma_f32_16x16x32_bf16 a[16:19], v[96:99], v[116:119], a[16:19]
    s_add_u32 s50, s44, 36864
    v_mfma_f32_16x16x32_bf16 a[20:23], v[100:103], v[116:119], a[20:23]
    buffer_load_dwordx4 v[68:71], v3, s[12:15], s50 offen
    v_mfma_f32_16x16x32_bf16 a[24:27], v[104:107], v[116:119], a[24:27]
    s_add_u32 s51, s46, 36864
    v_mfma_f32_16x16x32_bf16 a[28:31], v[108:111], v[116:119], a[28:31]
    buffer_load_dwordx4 v[84:87], v3, s[16:19], s51 offen
    v_mfma_f32_16x16x32_bf16 a[32:35], v[96:99], v[120:123], a[32:35]
    s_add_u32 s50, s44, 69632
    v_mfma_f32_16x16x32_bf16 a[36:39], v[100:103], v[120:123], a[36:39]
    buffer_load_dwordx4 v[72:75], v3, s[12:15], s50 offen
    v_mfma_f32_16x16x32_bf16 a[40:43], v[104:107], v[120:123], a[40:43]
    s_add_u32 s51, s46, 69632
    v_mfma_f32_16x16x32_bf16 a[44:47], v[108:111], v[120:123], a[44:47]
    buffer_load_dwordx4 v[88:91], v3, s[16:19], s51 offen
    v_mfma_f32_16x16x32_bf16 a[48:51], v[96:99], v[124:127], a[48:51]
    s_add_u32 s50, s44, 102400
    v_mfma_f32_16x16x32_bf16 a[52:55], v[100:103], v[124:127], a[52:55]
    buffer_load_dwordx4 v[76:79], v3, s[12:15], s50 offen
    v_mfma_f32_16x16x32_bf16 a[56:59], v[104:107], v[124:127], a[56:59]
    s_add_u32 s51, s46, 102400
    v_mfma_f32_16x16x32_bf16 a[60:63], v[108:111], v[124:127], a[60:63]
    buffer_load_dwordx4 v[92:95], v3, s[16:19], s51 offen
    s_waitcnt vmcnt(8)
    v_mfma_f32_16x16x32_bf16 a[0:3], v[32:35], v[48:51], a[0:3]
    s_add_u32 s50, s44, 5120
    v_mfma_f32_16x16x32_bf16 a[4:7], v[36:39], v[48:51], a[4:7]
    buffer_load_dwordx4 v[96:99], v3, s[12:15], s50 offen
    v_mfma_f32_16x16x32_bf16 a[8:11], v[40:43], v[48:51], a[8:11]
    s_add_u32 s51, s46, 5120
    v_mfma_f32_16x16x32_bf16 a[12:15], v[44:47], v[48:51], a[12:15]
    buffer_load_dwordx4 v[112:115], v3, s[16:19], s51 offen
    v_mfma_f32_16x16x32_bf16 a[16:19], v[32:35], v[52:55], a[16:19]
    s_add_u32 s50, s44, 37888
    v_mfma_f32_16x16x32_bf16 a[20:23], v[36:39], v[52:55], a[20:23]
    buffer_load_dwordx4 v[100:103], v3, s[12:15], s50 offen
    v_mfma_f32_16x16x32_bf16 a[24:27], v[40:43], v[52:55], a[24:27]
    s_add_u32 s51, s46, 37888
    v_mfma_f32_16x16x32_bf16 a[28:31], v[44:47], v[52:55], a[28:31]
    buffer_load_dwordx4 v[116:119], v3, s[16:19], s51 offen
    v_mfma_f32_16x16x32_bf16 a[32:35], v[32:35], v[56:59], a[32:35]
    s_add_u32 s50, s44, 70656
    v_mfma_f32_16x16x32_bf16 a[36:39], v[36:39], v[56:59], a[36:39]
    buffer_load_dwordx4 v[104:107], v3, s[12:15], s50 offen
    v_mfma_f32_16x16x32_bf16 a[40:43], v[40:43], v[56:59], a[40:43]
    s_add_u32 s51, s46, 70656
    v_mfma_f32_16x16x32_bf16 a[44:47], v[44:47], v[56:59], a[44:47]
    buffer_load_dwordx4 v[120:123], v3, s[16:19], s51 offen
    v_mfma_f32_16x16x32_bf16 a[48:51], v[32:35], v[60:63], a[48:51]
    s_add_u32 s50, s44, 103424
    v_mfma_f32_16x16x32_bf16 a[52:55], v[36:39], v[60:63], a[52:55]
    buffer_load_dwordx4 v[108:111], v3, s[12:15], s50 offen
    v_mfma_f32_16x16x32_bf16 a[56:59], v[40:43], v[60:63], a[56:59]
    s_add_u32 s51, s46, 103424
    v_mfma_f32_16x16x32_bf16 a[60:63], v[44:47], v[60:63], a[60:63]
    buffer_load_dwordx4 v[124:127], v3, s[16:19], s51 offen
    s_waitcnt vmcnt(8)
    v_mfma_f32_16x16x32_bf16 a[0:3], v[64:67], v[80:83], a[0:3]
    s_add_u32 s50, s44, 6144
    v_mfma_f32_16x16x32_bf16 a[4:7], v[68:71], v[80:83], a[4:7]
    buffer_load_dwordx4 v[32:35], v3, s[12:15], s50 offen
    v_mfma_f32_16x16x32_bf16 a[8:11], v[72:75], v[80:83], a[8:11]
    s_add_u32 s51, s46, 6144
    v_mfma_f32_16x16x32_bf16 a[12:15], v[76:79], v[80:83], a[12:15]
    buffer_load_dwordx4 v[48:51], v3, s[16:19], s51 offen
    v_mfma_f32_16x16x32_bf16 a[16:19], v[64:67], v[84:87], a[16:19]
    s_add_u32 s50, s44, 38912
    v_mfma_f32_16x16x32_bf16 a[20:23], v[68:71], v[84:87], a[20:23]
    buffer_load_dwordx4 v[36:39], v3, s[12:15], s50 offen
    v_mfma_f32_16x16x32_bf16 a[24:27], v[72:75], v[84:87], a[24:27]
    s_add_u32 s51, s46, 38912
    v_mfma_f32_16x16x32_bf16 a[28:31], v[76:79], v[84:87], a[28:31]
    buffer_load_dwordx4 v[52:55], v3, s[16:19], s51 offen
    v_mfma_f32_16x16x32_bf16 a[32:35], v[64:67], v[88:91], a[32:35]
    s_add_u32 s50, s44, 71680
    v_mfma_f32_16x16x32_bf16 a[36:39], v[68:71], v[88:91], a[36:39]
    buffer_load_dwordx4 v[40:43], v3, s[12:15], s50 offen
    v_mfma_f32_16x16x32_bf16 a[40:43], v[72:75], v[88:91], a[40:43]
    s_add_u32 s51, s46, 71680
    v_mfma_f32_16x16x32_bf16 a[44:47], v[76:79], v[88:91], a[44:47]
    buffer_load_dwordx4 v[56:59], v3, s[16:19], s51 offen
    v_mfma_f32_16x16x32_bf16 a[48:51], v[64:67], v[92:95], a[48:51]
    s_add_u32 s50, s44, 104448
    v_mfma_f32_16x16x32_bf16 a[52:55], v[68:71], v[92:95], a[52:55]
    buffer_load_dwordx4 v[44:47], v3, s[12:15], s50 offen
    v_mfma_f32_16x16x32_bf16 a[56:59], v[72:75], v[92:95], a[56:59]
    s_add_u32 s51, s46, 104448
    v_mfma_f32_16x16x32_bf16 a[60:63], v[76:79], v[92:95], a[60:63]
    buffer_load_dwordx4 v[60:63], v3, s[16:19], s51 offen
    s_waitcnt vmcnt(8)
    v_mfma_f32_16x16x32_bf16 a[0:3], v[96:99], v[112:115], a[0:3]
    s_add_u32 s50, s44, 7168
    v_mfma_f32_16x16x32_bf16 a[4:7], v[100:103], v[112:115], a[4:7]
    buffer_load_dwordx4 v[64:67], v3, s[12:15], s50 offen
    v_mfma_f32_16x16x32_bf16 a[8:11], v[104:107], v[112:115], a[8:11]
    s_add_u32 s51, s46, 7168
    v_mfma_f32_16x16x32_bf16 a[12:15], v[108:111], v[112:115], a[12:15]
    buffer_load_dwordx4 v[80:83], v3, s[16:19], s51 offen
    v_mfma_f32_16x16x32_bf16 a[16:19], v[96:99], v[116:119], a[16:19]
    s_add_u32 s50, s44, 39936
    v_mfma_f32_16x16x32_bf16 a[20:23], v[100:103], v[116:119], a[20:23]
    buffer_load_dwordx4 v[68:71], v3, s[12:15], s50 offen
    v_mfma_f32_16x16x32_bf16 a[24:27], v[104:107], v[116:119], a[24:27]
    s_add_u32 s51, s46, 39936
    v_mfma_f32_16x16x32_bf16 a[28:31], v[108:111], v[116:119], a[28:31]
    buffer_load_dwordx4 v[84:87], v3, s[16:19], s51 offen
    v_mfma_f32_16x16x32_bf16 a[32:35], v[96:99], v[120:123], a[32:35]
    s_add_u32 s50, s44, 72704
    v_mfma_f32_16x16x32_bf16 a[36:39], v[100:103], v[120:123], a[36:39]
    buffer_load_dwordx4 v[72:75], v3, s[12:15], s50 offen
    v_mfma_f32_16x16x32_bf16 a[40:43], v[104:107], v[120:123], a[40:43]
    s_add_u32 s51, s46, 72704
    v_mfma_f32_16x16x32_bf16 a[44:47], v[108:111], v[120:123], a[44:47]
    buffer_load_dwordx4 v[88:91], v3, s[16:19], s51 offen
    v_mfma_f32_16x16x32_bf16 a[48:51], v[96:99], v[124:127], a[48:51]
    s_add_u32 s50, s44, 105472
    v_mfma_f32_16x16x32_bf16 a[52:55], v[100:103], v[124:127], a[52:55]
    buffer_load_dwordx4 v[76:79], v3, s[12:15], s50 offen
    v_mfma_f32_16x16x32_bf16 a[56:59], v[104:107], v[124:127], a[56:59]
    s_add_u32 s51, s46, 105472
    v_mfma_f32_16x16x32_bf16 a[60:63], v[108:111], v[124:127], a[60:63]
    buffer_load_dwordx4 v[92:95], v3, s[16:19], s51 offen
    s_waitcnt vmcnt(8)
    v_mfma_f32_16x16x32_bf16 a[0:3], v[32:35], v[48:51], a[0:3]
    s_add_u32 s50, s47, 0
    v_mfma_f32_16x16x32_bf16 a[4:7], v[36:39], v[48:51], a[4:7]
    buffer_load_dwordx4 v[96:99], v3, s[20:23], s50 offen
    v_mfma_f32_16x16x32_bf16 a[8:11], v[40:43], v[48:51], a[8:11]
    s_add_u32 s51, s48, 0
    v_mfma_f32_16x16x32_bf16 a[12:15], v[44:47], v[48:51], a[12:15]
    buffer_load_dwordx4 v[112:115], v3, s[24:27], s51 offen
    v_mfma_f32_16x16x32_bf16 a[16:19], v[32:35], v[52:55], a[16:19]
    s_add_u32 s50, s47, 57344
    v_mfma_f32_16x16x32_bf16 a[20:23], v[36:39], v[52:55], a[20:23]
    buffer_load_dwordx4 v[100:103], v3, s[20:23], s50 offen
    v_mfma_f32_16x16x32_bf16 a[24:27], v[40:43], v[52:55], a[24:27]
    s_add_u32 s51, s48, 57344
    v_mfma_f32_16x16x32_bf16 a[28:31], v[44:47], v[52:55], a[28:31]
    buffer_load_dwordx4 v[116:119], v3, s[24:27], s51 offen
    v_mfma_f32_16x16x32_bf16 a[32:35], v[32:35], v[56:59], a[32:35]
    s_add_u32 s50, s47, 114688
    v_mfma_f32_16x16x32_bf16 a[36:39], v[36:39], v[56:59], a[36:39]
    buffer_load_dwordx4 v[104:107], v3, s[20:23], s50 offen
    v_mfma_f32_16x16x32_bf16 a[40:43], v[40:43], v[56:59], a[40:43]
    s_add_u32 s51, s48, 114688
    v_mfma_f32_16x16x32_bf16 a[44:47], v[44:47], v[56:59], a[44:47]
    buffer_load_dwordx4 v[120:123], v3, s[24:27], s51 offen
    v_mfma_f32_16x16x32_bf16 a[48:51], v[32:35], v[60:63], a[48:51]
    s_add_u32 s50, s47, 172032
    v_mfma_f32_16x16x32_bf16 a[52:55], v[36:39], v[60:63], a[52:55]
    buffer_load_dwordx4 v[108:111], v3, s[20:23], s50 offen
    v_mfma_f32_16x16x32_bf16 a[56:59], v[40:43], v[60:63], a[56:59]
    s_add_u32 s51, s48, 172032
    v_mfma_f32_16x16x32_bf16 a[60:63], v[44:47], v[60:63], a[60:63]
    buffer_load_dwordx4 v[124:127], v3, s[24:27], s51 offen
    s_waitcnt vmcnt(8)
    v_mfma_f32_16x16x32_bf16 a[0:3], v[64:67], v[80:83], a[0:3]
    s_add_u32 s50, s47, 1024
    v_mfma_f32_16x16x32_bf16 a[4:7], v[68:71], v[80:83], a[4:7]
    buffer_load_dwordx4 v[32:35], v3, s[20:23], s50 offen
    v_mfma_f32_16x16x32_bf16 a[8:11], v[72:75], v[80:83], a[8:11]
    s_add_u32 s51, s48, 1024
    v_mfma_f32_16x16x32_bf16 a[12:15], v[76:79], v[80:83], a[12:15]
    buffer_load_dwordx4 v[48:51], v3, s[24:27], s51 offen
    v_mfma_f32_16x16x32_bf16 a[16:19], v[64:67], v[84:87], a[16:19]
    s_add_u32 s50, s47, 58368
    v_mfma_f32_16x16x32_bf16 a[20:23], v[68:71], v[84:87], a[20:23]
    buffer_load_dwordx4 v[36:39], v3, s[20:23], s50 offen
    v_mfma_f32_16x16x32_bf16 a[24:27], v[72:75], v[84:87], a[24:27]
    s_add_u32 s51, s48, 58368
    v_mfma_f32_16x16x32_bf16 a[28:31], v[76:79], v[84:87], a[28:31]
    buffer_load_dwordx4 v[52:55], v3, s[24:27], s51 offen
    v_mfma_f32_16x16x32_bf16 a[32:35], v[64:67], v[88:91], a[32:35]
    s_add_u32 s50, s47, 115712
    v_mfma_f32_16x16x32_bf16 a[36:39], v[68:71], v[88:91], a[36:39]
    buffer_load_dwordx4 v[40:43], v3, s[20:23], s50 offen
    v_mfma_f32_16x16x32_bf16 a[40:43], v[72:75], v[88:91], a[40:43]
    s_add_u32 s51, s48, 115712
    v_mfma_f32_16x16x32_bf16 a[44:47], v[76:79], v[88:91], a[44:47]
    buffer_load_dwordx4 v[56:59], v3, s[24:27], s51 offen
    v_mfma_f32_16x16x32_bf16 a[48:51], v[64:67], v[92:95], a[48:51]
    s_add_u32 s50, s47, 173056
    v_mfma_f32_16x16x32_bf16 a[52:55], v[68:71], v[92:95], a[52:55]
    buffer_load_dwordx4 v[44:47], v3, s[20:23], s50 offen
    v_mfma_f32_16x16x32_bf16 a[56:59], v[72:75], v[92:95], a[56:59]
    s_add_u32 s51, s48, 173056
    v_mfma_f32_16x16x32_bf16 a[60:63], v[76:79], v[92:95], a[60:63]
    buffer_load_dwordx4 v[60:63], v3, s[24:27], s51 offen
    s_waitcnt vmcnt(8)
    v_mfma_f32_16x16x32_bf16 a[64:67], v[96:99], v[112:115], 0
    s_add_u32 s50, s47, 2048
    v_mfma_f32_16x16x32_bf16 a[68:71], v[100:103], v[112:115], 0
    buffer_load_dwordx4 v[64:67], v3, s[20:23], s50 offen
    v_mfma_f32_16x16x32_bf16 a[72:75], v[104:107], v[112:115], 0
    s_add_u32 s51, s48, 2048
    v_mfma_f32_16x16x32_bf16 a[76:79], v[108:111], v[112:115], 0
    buffer_load_dwordx4 v[80:83], v3, s[24:27], s51 offen
    v_mfma_f32_16x16x32_bf16 a[80:83], v[96:99], v[116:119], 0
    s_add_u32 s50, s47, 59392
    v_mfma_f32_16x16x32_bf16 a[84:87], v[100:103], v[116:119], 0
    buffer_load_dwordx4 v[68:71], v3, s[20:23], s50 offen
    v_mfma_f32_16x16x32_bf16 a[88:91], v[104:107], v[116:119], 0
    s_add_u32 s51, s48, 59392
    v_mfma_f32_16x16x32_bf16 a[92:95], v[108:111], v[116:119], 0
    buffer_load_dwordx4 v[84:87], v3, s[24:27], s51 offen
    v_mfma_f32_16x16x32_bf16 a[96:99], v[96:99], v[120:123], 0
    s_add_u32 s50, s47, 116736
    v_mfma_f32_16x16x32_bf16 a[100:103], v[100:103], v[120:123], 0
    buffer_load_dwordx4 v[72:75], v3, s[20:23], s50 offen
    v_mfma_f32_16x16x32_bf16 a[104:107], v[104:107], v[120:123], 0
    s_add_u32 s51, s48, 116736
    v_mfma_f32_16x16x32_bf16 a[108:111], v[108:111], v[120:123], 0
    buffer_load_dwordx4 v[88:91], v3, s[24:27], s51 offen
    v_mfma_f32_16x16x32_bf16 a[112:115], v[96:99], v[124:127], 0
    s_add_u32 s50, s47, 174080
    v_mfma_f32_16x16x32_bf16 a[116:119], v[100:103], v[124:127], 0
    buffer_load_dwordx4 v[76:79], v3, s[20:23], s50 offen
    v_mfma_f32_16x16x32_bf16 a[120:123], v[104:107], v[124:127], 0
    s_add_u32 s51, s48, 174080
    v_mfma_f32_16x16x32_bf16 a[124:127], v[108:111], v[124:127], 0
    buffer_load_dwordx4 v[92:95], v3, s[24:27], s51 offen
    s_waitcnt vmcnt(8)
    v_mfma_f32_16x16x32_bf16 a[64:67], v[32:35], v[48:51], a[64:67]
    s_add_u32 s50, s47, 3072
    v_mfma_f32_16x16x32_bf16 a[68:71], v[36:39], v[48:51], a[68:71]
    buffer_load_dwordx4 v[96:99], v3, s[20:23], s50 offen
    v_mfma_f32_16x16x32_bf16 a[72:75], v[40:43], v[48:51], a[72:75]
    s_add_u32 s51, s48, 3072
    v_mfma_f32_16x16x32_bf16 a[76:79], v[44:47], v[48:51], a[76:79]
    buffer_load_dwordx4 v[112:115], v3, s[24:27], s51 offen
    v_mfma_f32_16x16x32_bf16 a[80:83], v[32:35], v[52:55], a[80:83]
    s_add_u32 s50, s47, 60416
    v_mfma_f32_16x16x32_bf16 a[84:87], v[36:39], v[52:55], a[84:87]
    buffer_load_dwordx4 v[100:103], v3, s[20:23], s50 offen
    v_mfma_f32_16x16x32_bf16 a[88:91], v[40:43], v[52:55], a[88:91]
    s_add_u32 s51, s48, 60416
    v_mfma_f32_16x16x32_bf16 a[92:95], v[44:47], v[52:55], a[92:95]
    buffer_load_dwordx4 v[116:119], v3, s[24:27], s51 offen
    v_mfma_f32_16x16x32_bf16 a[96:99], v[32:35], v[56:59], a[96:99]
    s_add_u32 s50, s47, 117760
    v_mfma_f32_16x16x32_bf16 a[100:103], v[36:39], v[56:59], a[100:103]
    buffer_load_dwordx4 v[104:107], v3, s[20:23], s50 offen
    v_mfma_f32_16x16x32_bf16 a[104:107], v[40:43], v[56:59], a[104:107]
    s_add_u32 s51, s48, 117760
    v_mfma_f32_16x16x32_bf16 a[108:111], v[44:47], v[56:59], a[108:111]
    buffer_load_dwordx4 v[120:123], v3, s[24:27], s51 offen
    v_mfma_f32_16x16x32_bf16 a[112:115], v[32:35], v[60:63], a[112:115]
    s_add_u32 s50, s47, 175104
    v_mfma_f32_16x16x32_bf16 a[116:119], v[36:39], v[60:63], a[116:119]
    buffer_load_dwordx4 v[108:111], v3, s[20:23], s50 offen
    v_mfma_f32_16x16x32_bf16 a[120:123], v[40:43], v[60:63], a[120:123]
    s_add_u32 s51, s48, 175104
    v_mfma_f32_16x16x32_bf16 a[124:127], v[44:47], v[60:63], a[124:127]
    buffer_load_dwordx4 v[124:127], v3, s[24:27], s51 offen
    s_waitcnt vmcnt(8)
    v_mfma_f32_16x16x32_bf16 a[64:67], v[64:67], v[80:83], a[64:67]
    s_add_u32 s50, s47, 4096
    v_mfma_f32_16x16x32_bf16 a[68:71], v[68:71], v[80:83], a[68:71]
    buffer_load_dwordx4 v[32:35], v3, s[20:23], s50 offen
    v_mfma_f32_16x16x32_bf16 a[72:75], v[72:75], v[80:83], a[72:75]
    s_add_u32 s51, s48, 4096
    v_mfma_f32_16x16x32_bf16 a[76:79], v[76:79], v[80:83], a[76:79]
    buffer_load_dwordx4 v[48:51], v3, s[24:27], s51 offen
    v_mfma_f32_16x16x32_bf16 a[80:83], v[64:67], v[84:87], a[80:83]
    s_add_u32 s50, s47, 61440
    v_mfma_f32_16x16x32_bf16 a[84:87], v[68:71], v[84:87], a[84:87]
    buffer_load_dwordx4 v[36:39], v3, s[20:23], s50 offen
    v_mfma_f32_16x16x32_bf16 a[88:91], v[72:75], v[84:87], a[88:91]
    s_add_u32 s51, s48, 61440
    v_mfma_f32_16x16x32_bf16 a[92:95], v[76:79], v[84:87], a[92:95]
    buffer_load_dwordx4 v[52:55], v3, s[24:27], s51 offen
    v_mfma_f32_16x16x32_bf16 a[96:99], v[64:67], v[88:91], a[96:99]
    s_add_u32 s50, s47, 118784
    v_mfma_f32_16x16x32_bf16 a[100:103], v[68:71], v[88:91], a[100:103]
    buffer_load_dwordx4 v[40:43], v3, s[20:23], s50 offen
    v_mfma_f32_16x16x32_bf16 a[104:107], v[72:75], v[88:91], a[104:107]
    s_add_u32 s51, s48, 118784
    v_mfma_f32_16x16x32_bf16 a[108:111], v[76:79], v[88:91], a[108:111]
    buffer_load_dwordx4 v[56:59], v3, s[24:27], s51 offen
    v_mfma_f32_16x16x32_bf16 a[112:115], v[64:67], v[92:95], a[112:115]
    s_add_u32 s50, s47, 176128
    v_mfma_f32_16x16x32_bf16 a[116:119], v[68:71], v[92:95], a[116:119]
    buffer_load_dwordx4 v[44:47], v3, s[20:23], s50 offen
    v_mfma_f32_16x16x32_bf16 a[120:123], v[72:75], v[92:95], a[120:123]
    s_add_u32 s51, s48, 176128
    v_mfma_f32_16x16x32_bf16 a[124:127], v[76:79], v[92:95], a[124:127]
    buffer_load_dwordx4 v[60:63], v3, s[24:27], s51 offen
    s_waitcnt vmcnt(8)
    v_mfma_f32_16x16x32_bf16 a[64:67], v[96:99], v[112:115], a[64:67]
    s_add_u32 s50, s47, 5120
    v_mfma_f32_16x16x32_bf16 a[68:71], v[100:103], v[112:115], a[68:71]
    buffer_load_dwordx4 v[64:67], v3, s[20:23], s50 offen
    v_mfma_f32_16x16x32_bf16 a[72:75], v[104:107], v[112:115], a[72:75]
    s_add_u32 s51, s48, 5120
    v_mfma_f32_16x16x32_bf16 a[76:79], v[108:111], v[112:115], a[76:79]
    buffer_load_dwordx4 v[80:83], v3, s[24:27], s51 offen
    v_mfma_f32_16x16x32_bf16 a[80:83], v[96:99], v[116:119], a[80:83]
    s_add_u32 s50, s47, 62464
    v_mfma_f32_16x16x32_bf16 a[84:87], v[100:103], v[116:119], a[84:87]
    buffer_load_dwordx4 v[68:71], v3, s[20:23], s50 offen
    v_mfma_f32_16x16x32_bf16 a[88:91], v[104:107], v[116:119], a[88:91]
    s_add_u32 s51, s48, 62464
    v_mfma_f32_16x16x32_bf16 a[92:95], v[108:111], v[116:119], a[92:95]
    buffer_load_dwordx4 v[84:87], v3, s[24:27], s51 offen
    v_mfma_f32_16x16x32_bf16 a[96:99], v[96:99], v[120:123], a[96:99]
    s_add_u32 s50, s47, 119808
    v_mfma_f32_16x16x32_bf16 a[100:103], v[100:103], v[120:123], a[100:103]
    buffer_load_dwordx4 v[72:75], v3, s[20:23], s50 offen
    v_mfma_f32_16x16x32_bf16 a[104:107], v[104:107], v[120:123], a[104:107]
    s_add_u32 s51, s48, 119808
    v_mfma_f32_16x16x32_bf16 a[108:111], v[108:111], v[120:123], a[108:111]
    buffer_load_dwordx4 v[88:91], v3, s[24:27], s51 offen
    v_mfma_f32_16x16x32_bf16 a[112:115], v[96:99], v[124:127], a[112:115]
    s_add_u32 s50, s47, 177152
    v_mfma_f32_16x16x32_bf16 a[116:119], v[100:103], v[124:127], a[116:119]
    buffer_load_dwordx4 v[76:79], v3, s[20:23], s50 offen
    v_mfma_f32_16x16x32_bf16 a[120:123], v[104:107], v[124:127], a[120:123]
    s_add_u32 s51, s48, 177152
    v_mfma_f32_16x16x32_bf16 a[124:127], v[108:111], v[124:127], a[124:127]
    buffer_load_dwordx4 v[92:95], v3, s[24:27], s51 offen
    s_waitcnt vmcnt(8)
    v_mfma_f32_16x16x32_bf16 a[64:67], v[32:35], v[48:51], a[64:67]
    s_add_u32 s50, s47, 6144
    v_mfma_f32_16x16x32_bf16 a[68:71], v[36:39], v[48:51], a[68:71]
    buffer_load_dwordx4 v[96:99], v3, s[20:23], s50 offen
    v_mfma_f32_16x16x32_bf16 a[72:75], v[40:43], v[48:51], a[72:75]
    s_add_u32 s51, s48, 6144
    v_mfma_f32_16x16x32_bf16 a[76:79], v[44:47], v[48:51], a[76:79]
    buffer_load_dwordx4 v[112:115], v3, s[24:27], s51 offen
    v_mfma_f32_16x16x32_bf16 a[80:83], v[32:35], v[52:55], a[80:83]
    s_add_u32 s50, s47, 63488
    v_mfma_f32_16x16x32_bf16 a[84:87], v[36:39], v[52:55], a[84:87]
    buffer_load_dwordx4 v[100:103], v3, s[20:23], s50 offen
    v_mfma_f32_16x16x32_bf16 a[88:91], v[40:43], v[52:55], a[88:91]
    s_add_u32 s51, s48, 63488
    v_mfma_f32_16x16x32_bf16 a[92:95], v[44:47], v[52:55], a[92:95]
    buffer_load_dwordx4 v[116:119], v3, s[24:27], s51 offen
    v_mfma_f32_16x16x32_bf16 a[96:99], v[32:35], v[56:59], a[96:99]
    s_add_u32 s50, s47, 120832
    v_mfma_f32_16x16x32_bf16 a[100:103], v[36:39], v[56:59], a[100:103]
    buffer_load_dwordx4 v[104:107], v3, s[20:23], s50 offen
    v_mfma_f32_16x16x32_bf16 a[104:107], v[40:43], v[56:59], a[104:107]
    s_add_u32 s51, s48, 120832
    v_mfma_f32_16x16x32_bf16 a[108:111], v[44:47], v[56:59], a[108:111]
    buffer_load_dwordx4 v[120:123], v3, s[24:27], s51 offen
    v_mfma_f32_16x16x32_bf16 a[112:115], v[32:35], v[60:63], a[112:115]
    s_add_u32 s50, s47, 178176
    v_mfma_f32_16x16x32_bf16 a[116:119], v[36:39], v[60:63], a[116:119]
    buffer_load_dwordx4 v[108:111], v3, s[20:23], s50 offen
    v_mfma_f32_16x16x32_bf16 a[120:123], v[40:43], v[60:63], a[120:123]
    s_add_u32 s51, s48, 178176
    v_mfma_f32_16x16x32_bf16 a[124:127], v[44:47], v[60:63], a[124:127]
    buffer_load_dwordx4 v[124:127], v3, s[24:27], s51 offen
    s_waitcnt vmcnt(8)
    v_mfma_f32_16x16x32_bf16 a[64:67], v[64:67], v[80:83], a[64:67]
    s_add_u32 s50, s47, 7168
    v_mfma_f32_16x16x32_bf16 a[68:71], v[68:71], v[80:83], a[68:71]
    buffer_load_dwordx4 v[32:35], v3, s[20:23], s50 offen
    v_mfma_f32_16x16x32_bf16 a[72:75], v[72:75], v[80:83], a[72:75]
    s_add_u32 s51, s48, 7168
    v_mfma_f32_16x16x32_bf16 a[76:79], v[76:79], v[80:83], a[76:79]
    buffer_load_dwordx4 v[48:51], v3, s[24:27], s51 offen
    v_mfma_f32_16x16x32_bf16 a[80:83], v[64:67], v[84:87], a[80:83]
    s_add_u32 s50, s47, 64512
    v_mfma_f32_16x16x32_bf16 a[84:87], v[68:71], v[84:87], a[84:87]
    buffer_load_dwordx4 v[36:39], v3, s[20:23], s50 offen
    v_mfma_f32_16x16x32_bf16 a[88:91], v[72:75], v[84:87], a[88:91]
    s_add_u32 s51, s48, 64512
    v_mfma_f32_16x16x32_bf16 a[92:95], v[76:79], v[84:87], a[92:95]
    buffer_load_dwordx4 v[52:55], v3, s[24:27], s51 offen
    v_mfma_f32_16x16x32_bf16 a[96:99], v[64:67], v[88:91], a[96:99]
    s_add_u32 s50, s47, 121856
    v_mfma_f32_16x16x32_bf16 a[100:103], v[68:71], v[88:91], a[100:103]
    buffer_load_dwordx4 v[40:43], v3, s[20:23], s50 offen
    v_mfma_f32_16x16x32_bf16 a[104:107], v[72:75], v[88:91], a[104:107]
    s_add_u32 s51, s48, 121856
    v_mfma_f32_16x16x32_bf16 a[108:111], v[76:79], v[88:91], a[108:111]
    buffer_load_dwordx4 v[56:59], v3, s[24:27], s51 offen
    v_mfma_f32_16x16x32_bf16 a[112:115], v[64:67], v[92:95], a[112:115]
    s_add_u32 s50, s47, 179200
    v_mfma_f32_16x16x32_bf16 a[116:119], v[68:71], v[92:95], a[116:119]
    buffer_load_dwordx4 v[44:47], v3, s[20:23], s50 offen
    v_mfma_f32_16x16x32_bf16 a[120:123], v[72:75], v[92:95], a[120:123]
    s_add_u32 s51, s48, 179200
    v_mfma_f32_16x16x32_bf16 a[124:127], v[76:79], v[92:95], a[124:127]
    buffer_load_dwordx4 v[60:63], v3, s[24:27], s51 offen
    s_waitcnt vmcnt(8)
    v_mfma_f32_16x16x32_bf16 a[64:67], v[96:99], v[112:115], a[64:67]
    s_add_u32 s50, s47, 8192
    v_mfma_f32_16x16x32_bf16 a[68:71], v[100:103], v[112:115], a[68:71]
    buffer_load_dwordx4 v[64:67], v3, s[20:23], s50 offen
    v_mfma_f32_16x16x32_bf16 a[72:75], v[104:107], v[112:115], a[72:75]
    s_add_u32 s51, s48, 8192
    v_mfma_f32_16x16x32_bf16 a[76:79], v[108:111], v[112:115], a[76:79]
    buffer_load_dwordx4 v[80:83], v3, s[24:27], s51 offen
    v_mfma_f32_16x16x32_bf16 a[80:83], v[96:99], v[116:119], a[80:83]
    s_add_u32 s50, s47, 65536
    v_mfma_f32_16x16x32_bf16 a[84:87], v[100:103], v[116:119], a[84:87]
    buffer_load_dwordx4 v[68:71], v3, s[20:23], s50 offen
    v_mfma_f32_16x16x32_bf16 a[88:91], v[104:107], v[116:119], a[88:91]
    s_add_u32 s51, s48, 65536
    v_mfma_f32_16x16x32_bf16 a[92:95], v[108:111], v[116:119], a[92:95]
    buffer_load_dwordx4 v[84:87], v3, s[24:27], s51 offen
    v_mfma_f32_16x16x32_bf16 a[96:99], v[96:99], v[120:123], a[96:99]
    s_add_u32 s50, s47, 122880
    v_mfma_f32_16x16x32_bf16 a[100:103], v[100:103], v[120:123], a[100:103]
    buffer_load_dwordx4 v[72:75], v3, s[20:23], s50 offen
    v_mfma_f32_16x16x32_bf16 a[104:107], v[104:107], v[120:123], a[104:107]
    s_add_u32 s51, s48, 122880
    v_mfma_f32_16x16x32_bf16 a[108:111], v[108:111], v[120:123], a[108:111]
    buffer_load_dwordx4 v[88:91], v3, s[24:27], s51 offen
    v_mfma_f32_16x16x32_bf16 a[112:115], v[96:99], v[124:127], a[112:115]
    s_add_u32 s50, s47, 180224
    v_mfma_f32_16x16x32_bf16 a[116:119], v[100:103], v[124:127], a[116:119]
    buffer_load_dwordx4 v[76:79], v3, s[20:23], s50 offen
    v_mfma_f32_16x16x32_bf16 a[120:123], v[104:107], v[124:127], a[120:123]
    s_add_u32 s51, s48, 180224
    v_mfma_f32_16x16x32_bf16 a[124:127], v[108:111], v[124:127], a[124:127]
    buffer_load_dwordx4 v[92:95], v3, s[24:27], s51 offen
    s_waitcnt vmcnt(8)
    v_mfma_f32_16x16x32_bf16 a[64:67], v[32:35], v[48:51], a[64:67]
    s_add_u32 s50, s47, 9216
    v_mfma_f32_16x16x32_bf16 a[68:71], v[36:39], v[48:51], a[68:71]
    buffer_load_dwordx4 v[96:99], v3, s[20:23], s50 offen
    v_mfma_f32_16x16x32_bf16 a[72:75], v[40:43], v[48:51], a[72:75]
    s_add_u32 s51, s48, 9216
    v_mfma_f32_16x16x32_bf16 a[76:79], v[44:47], v[48:51], a[76:79]
    buffer_load_dwordx4 v[112:115], v3, s[24:27], s51 offen
    v_mfma_f32_16x16x32_bf16 a[80:83], v[32:35], v[52:55], a[80:83]
    s_add_u32 s50, s47, 66560
    v_mfma_f32_16x16x32_bf16 a[84:87], v[36:39], v[52:55], a[84:87]
    buffer_load_dwordx4 v[100:103], v3, s[20:23], s50 offen
    v_mfma_f32_16x16x32_bf16 a[88:91], v[40:43], v[52:55], a[88:91]
    s_add_u32 s51, s48, 66560
    v_mfma_f32_16x16x32_bf16 a[92:95], v[44:47], v[52:55], a[92:95]
    buffer_load_dwordx4 v[116:119], v3, s[24:27], s51 offen
    v_mfma_f32_16x16x32_bf16 a[96:99], v[32:35], v[56:59], a[96:99]
    s_add_u32 s50, s47, 123904
    v_mfma_f32_16x16x32_bf16 a[100:103], v[36:39], v[56:59], a[100:103]
    buffer_load_dwordx4 v[104:107], v3, s[20:23], s50 offen
    v_mfma_f32_16x16x32_bf16 a[104:107], v[40:43], v[56:59], a[104:107]
    s_add_u32 s51, s48, 123904
    v_mfma_f32_16x16x32_bf16 a[108:111], v[44:47], v[56:59], a[108:111]
    buffer_load_dwordx4 v[120:123], v3, s[24:27], s51 offen
    v_mfma_f32_16x16x32_bf16 a[112:115], v[32:35], v[60:63], a[112:115]
    s_add_u32 s50, s47, 181248
    v_mfma_f32_16x16x32_bf16 a[116:119], v[36:39], v[60:63], a[116:119]
    buffer_load_dwordx4 v[108:111], v3, s[20:23], s50 offen
    v_mfma_f32_16x16x32_bf16 a[120:123], v[40:43], v[60:63], a[120:123]
    s_add_u32 s51, s48, 181248
    v_mfma_f32_16x16x32_bf16 a[124:127], v[44:47], v[60:63], a[124:127]
    buffer_load_dwordx4 v[124:127], v3, s[24:27], s51 offen
    s_waitcnt vmcnt(8)
    v_mfma_f32_16x16x32_bf16 a[64:67], v[64:67], v[80:83], a[64:67]
    s_add_u32 s50, s47, 10240
    v_mfma_f32_16x16x32_bf16 a[68:71], v[68:71], v[80:83], a[68:71]
    buffer_load_dwordx4 v[32:35], v3, s[20:23], s50 offen
    v_mfma_f32_16x16x32_bf16 a[72:75], v[72:75], v[80:83], a[72:75]
    s_add_u32 s51, s48, 10240
    v_mfma_f32_16x16x32_bf16 a[76:79], v[76:79], v[80:83], a[76:79]
    buffer_load_dwordx4 v[48:51], v3, s[24:27], s51 offen
    v_mfma_f32_16x16x32_bf16 a[80:83], v[64:67], v[84:87], a[80:83]
    s_add_u32 s50, s47, 67584
    v_mfma_f32_16x16x32_bf16 a[84:87], v[68:71], v[84:87], a[84:87]
    buffer_load_dwordx4 v[36:39], v3, s[20:23], s50 offen
    v_mfma_f32_16x16x32_bf16 a[88:91], v[72:75], v[84:87], a[88:91]
    s_add_u32 s51, s48, 67584
    v_mfma_f32_16x16x32_bf16 a[92:95], v[76:79], v[84:87], a[92:95]
    buffer_load_dwordx4 v[52:55], v3, s[24:27], s51 offen
    v_mfma_f32_16x16x32_bf16 a[96:99], v[64:67], v[88:91], a[96:99]
    s_add_u32 s50, s47, 124928
    v_mfma_f32_16x16x32_bf16 a[100:103], v[68:71], v[88:91], a[100:103]
    buffer_load_dwordx4 v[40:43], v3, s[20:23], s50 offen
    v_mfma_f32_16x16x32_bf16 a[104:107], v[72:75], v[88:91], a[104:107]
    s_add_u32 s51, s48, 124928
    v_mfma_f32_16x16x32_bf16 a[108:111], v[76:79], v[88:91], a[108:111]
    buffer_load_dwordx4 v[56:59], v3, s[24:27], s51 offen
    v_mfma_f32_16x16x32_bf16 a[112:115], v[64:67], v[92:95], a[112:115]
    s_add_u32 s50, s47, 182272
    v_mfma_f32_16x16x32_bf16 a[116:119], v[68:71], v[92:95], a[116:119]
    buffer_load_dwordx4 v[44:47], v3, s[20:23], s50 offen
    v_mfma_f32_16x16x32_bf16 a[120:123], v[72:75], v[92:95], a[120:123]
    s_add_u32 s51, s48, 182272
    v_mfma_f32_16x16x32_bf16 a[124:127], v[76:79], v[92:95], a[124:127]
    buffer_load_dwordx4 v[60:63], v3, s[24:27], s51 offen
    s_waitcnt vmcnt(8)
    v_mfma_f32_16x16x32_bf16 a[64:67], v[96:99], v[112:115], a[64:67]
    s_add_u32 s50, s47, 11264
    v_mfma_f32_16x16x32_bf16 a[68:71], v[100:103], v[112:115], a[68:71]
    buffer_load_dwordx4 v[64:67], v3, s[20:23], s50 offen
    v_mfma_f32_16x16x32_bf16 a[72:75], v[104:107], v[112:115], a[72:75]
    s_add_u32 s51, s48, 11264
    v_mfma_f32_16x16x32_bf16 a[76:79], v[108:111], v[112:115], a[76:79]
    buffer_load_dwordx4 v[80:83], v3, s[24:27], s51 offen
    v_mfma_f32_16x16x32_bf16 a[80:83], v[96:99], v[116:119], a[80:83]
    s_add_u32 s50, s47, 68608
    v_mfma_f32_16x16x32_bf16 a[84:87], v[100:103], v[116:119], a[84:87]
    buffer_load_dwordx4 v[68:71], v3, s[20:23], s50 offen
    v_mfma_f32_16x16x32_bf16 a[88:91], v[104:107], v[116:119], a[88:91]
    s_add_u32 s51, s48, 68608
    v_mfma_f32_16x16x32_bf16 a[92:95], v[108:111], v[116:119], a[92:95]
    buffer_load_dwordx4 v[84:87], v3, s[24:27], s51 offen
    v_mfma_f32_16x16x32_bf16 a[96:99], v[96:99], v[120:123], a[96:99]
    s_add_u32 s50, s47, 125952
    v_mfma_f32_16x16x32_bf16 a[100:103], v[100:103], v[120:123], a[100:103]
    buffer_load_dwordx4 v[72:75], v3, s[20:23], s50 offen
    v_mfma_f32_16x16x32_bf16 a[104:107], v[104:107], v[120:123], a[104:107]
    s_add_u32 s51, s48, 125952
    v_mfma_f32_16x16x32_bf16 a[108:111], v[108:111], v[120:123], a[108:111]
    buffer_load_dwordx4 v[88:91], v3, s[24:27], s51 offen
    v_mfma_f32_16x16x32_bf16 a[112:115], v[96:99], v[124:127], a[112:115]
    s_add_u32 s50, s47, 183296
    v_mfma_f32_16x16x32_bf16 a[116:119], v[100:103], v[124:127], a[116:119]
    buffer_load_dwordx4 v[76:79], v3, s[20:23], s50 offen
    v_mfma_f32_16x16x32_bf16 a[120:123], v[104:107], v[124:127], a[120:123]
    s_add_u32 s51, s48, 183296
    v_mfma_f32_16x16x32_bf16 a[124:127], v[108:111], v[124:127], a[124:127]
    buffer_load_dwordx4 v[92:95], v3, s[24:27], s51 offen
    s_waitcnt vmcnt(8)
    v_mfma_f32_16x16x32_bf16 a[64:67], v[32:35], v[48:51], a[64:67]
    s_add_u32 s50, s47, 12288
    v_mfma_f32_16x16x32_bf16 a[68:71], v[36:39], v[48:51], a[68:71]
    buffer_load_dwordx4 v[96:99], v3, s[20:23], s50 offen
    v_mfma_f32_16x16x32_bf16 a[72:75], v[40:43], v[48:51], a[72:75]
    s_add_u32 s51, s48, 12288
    v_mfma_f32_16x16x32_bf16 a[76:79], v[44:47], v[48:51], a[76:79]
    buffer_load_dwordx4 v[112:115], v3, s[24:27], s51 offen
    v_mfma_f32_16x16x32_bf16 a[80:83], v[32:35], v[52:55], a[80:83]
    s_add_u32 s50, s47, 69632
    v_mfma_f32_16x16x32_bf16 a[84:87], v[36:39], v[52:55], a[84:87]
    buffer_load_dwordx4 v[100:103], v3, s[20:23], s50 offen
    v_mfma_f32_16x16x32_bf16 a[88:91], v[40:43], v[52:55], a[88:91]
    s_add_u32 s51, s48, 69632
    v_mfma_f32_16x16x32_bf16 a[92:95], v[44:47], v[52:55], a[92:95]
    buffer_load_dwordx4 v[116:119], v3, s[24:27], s51 offen
    v_mfma_f32_16x16x32_bf16 a[96:99], v[32:35], v[56:59], a[96:99]
    s_add_u32 s50, s47, 126976
    v_mfma_f32_16x16x32_bf16 a[100:103], v[36:39], v[56:59], a[100:103]
    buffer_load_dwordx4 v[104:107], v3, s[20:23], s50 offen
    v_mfma_f32_16x16x32_bf16 a[104:107], v[40:43], v[56:59], a[104:107]
    s_add_u32 s51, s48, 126976
    v_mfma_f32_16x16x32_bf16 a[108:111], v[44:47], v[56:59], a[108:111]
    buffer_load_dwordx4 v[120:123], v3, s[24:27], s51 offen
    v_mfma_f32_16x16x32_bf16 a[112:115], v[32:35], v[60:63], a[112:115]
    s_add_u32 s50, s47, 184320
    v_mfma_f32_16x16x32_bf16 a[116:119], v[36:39], v[60:63], a[116:119]
    buffer_load_dwordx4 v[108:111], v3, s[20:23], s50 offen
    v_mfma_f32_16x16x32_bf16 a[120:123], v[40:43], v[60:63], a[120:123]
    s_add_u32 s51, s48, 184320
    v_mfma_f32_16x16x32_bf16 a[124:127], v[44:47], v[60:63], a[124:127]
    buffer_load_dwordx4 v[124:127], v3, s[24:27], s51 offen
    s_waitcnt vmcnt(8)
    v_mfma_f32_16x16x32_bf16 a[64:67], v[64:67], v[80:83], a[64:67]
    s_add_u32 s50, s47, 13312
    v_mfma_f32_16x16x32_bf16 a[68:71], v[68:71], v[80:83], a[68:71]
    buffer_load_dwordx4 v[32:35], v3, s[20:23], s50 offen
    v_mfma_f32_16x16x32_bf16 a[72:75], v[72:75], v[80:83], a[72:75]
    s_add_u32 s51, s48, 13312
    v_mfma_f32_16x16x32_bf16 a[76:79], v[76:79], v[80:83], a[76:79]
    buffer_load_dwordx4 v[48:51], v3, s[24:27], s51 offen
    v_mfma_f32_16x16x32_bf16 a[80:83], v[64:67], v[84:87], a[80:83]
    s_add_u32 s50, s47, 70656
    v_mfma_f32_16x16x32_bf16 a[84:87], v[68:71], v[84:87], a[84:87]
    buffer_load_dwordx4 v[36:39], v3, s[20:23], s50 offen
    v_mfma_f32_16x16x32_bf16 a[88:91], v[72:75], v[84:87], a[88:91]
    s_add_u32 s51, s48, 70656
    v_mfma_f32_16x16x32_bf16 a[92:95], v[76:79], v[84:87], a[92:95]
    buffer_load_dwordx4 v[52:55], v3, s[24:27], s51 offen
    v_mfma_f32_16x16x32_bf16 a[96:99], v[64:67], v[88:91], a[96:99]
    s_add_u32 s50, s47, 128000
    v_mfma_f32_16x16x32_bf16 a[100:103], v[68:71], v[88:91], a[100:103]
    buffer_load_dwordx4 v[40:43], v3, s[20:23], s50 offen
    v_mfma_f32_16x16x32_bf16 a[104:107], v[72:75], v[88:91], a[104:107]
    s_add_u32 s51, s48, 128000
    v_mfma_f32_16x16x32_bf16 a[108:111], v[76:79], v[88:91], a[108:111]
    buffer_load_dwordx4 v[56:59], v3, s[24:27], s51 offen
    v_mfma_f32_16x16x32_bf16 a[112:115], v[64:67], v[92:95], a[112:115]
    s_add_u32 s50, s47, 185344
    v_mfma_f32_16x16x32_bf16 a[116:119], v[68:71], v[92:95], a[116:119]
    buffer_load_dwordx4 v[44:47], v3, s[20:23], s50 offen
    v_mfma_f32_16x16x32_bf16 a[120:123], v[72:75], v[92:95], a[120:123]
    s_add_u32 s51, s48, 185344
    v_mfma_f32_16x16x32_bf16 a[124:127], v[76:79], v[92:95], a[124:127]
    buffer_load_dwordx4 v[60:63], v3, s[24:27], s51 offen
    s_waitcnt vmcnt(8)
    v_mfma_f32_16x16x32_bf16 a[64:67], v[96:99], v[112:115], a[64:67]
    v_mfma_f32_16x16x32_bf16 a[68:71], v[100:103], v[112:115], a[68:71]
    v_mfma_f32_16x16x32_bf16 a[72:75], v[104:107], v[112:115], a[72:75]
    v_mfma_f32_16x16x32_bf16 a[76:79], v[108:111], v[112:115], a[76:79]
    v_mfma_f32_16x16x32_bf16 a[80:83], v[96:99], v[116:119], a[80:83]
    v_mfma_f32_16x16x32_bf16 a[84:87], v[100:103], v[116:119], a[84:87]
    v_mfma_f32_16x16x32_bf16 a[88:91], v[104:107], v[116:119], a[88:91]
    v_mfma_f32_16x16x32_bf16 a[92:95], v[108:111], v[116:119], a[92:95]
    v_mfma_f32_16x16x32_bf16 a[96:99], v[96:99], v[120:123], a[96:99]
    v_mfma_f32_16x16x32_bf16 a[100:103], v[100:103], v[120:123], a[100:103]
    v_mfma_f32_16x16x32_bf16 a[104:107], v[104:107], v[120:123], a[104:107]
    v_mfma_f32_16x16x32_bf16 a[108:111], v[108:111], v[120:123], a[108:111]
    v_mfma_f32_16x16x32_bf16 a[112:115], v[96:99], v[124:127], a[112:115]
    v_mfma_f32_16x16x32_bf16 a[116:119], v[100:103], v[124:127], a[116:119]
    v_mfma_f32_16x16x32_bf16 a[120:123], v[104:107], v[124:127], a[120:123]
    v_mfma_f32_16x16x32_bf16 a[124:127], v[108:111], v[124:127], a[124:127]
    s_waitcnt vmcnt(0)
    v_mfma_f32_16x16x32_bf16 a[64:67], v[32:35], v[48:51], a[64:67]
    v_mfma_f32_16x16x32_bf16 a[68:71], v[36:39], v[48:51], a[68:71]
    v_mfma_f32_16x16x32_bf16 a[72:75], v[40:43], v[48:51], a[72:75]
    v_mfma_f32_16x16x32_bf16 a[76:79], v[44:47], v[48:51], a[76:79]
    v_mfma_f32_16x16x32_bf16 a[80:83], v[32:35], v[52:55], a[80:83]
    v_mfma_f32_16x16x32_bf16 a[84:87], v[36:39], v[52:55], a[84:87]
    v_mfma_f32_16x16x32_bf16 a[88:91], v[40:43], v[52:55], a[88:91]
    v_mfma_f32_16x16x32_bf16 a[92:95], v[44:47], v[52:55], a[92:95]
    v_mfma_f32_16x16x32_bf16 a[96:99], v[32:35], v[56:59], a[96:99]
    v_mfma_f32_16x16x32_bf16 a[100:103], v[36:39], v[56:59], a[100:103]
    v_mfma_f32_16x16x32_bf16 a[104:107], v[40:43], v[56:59], a[104:107]
    v_mfma_f32_16x16x32_bf16 a[108:111], v[44:47], v[56:59], a[108:111]
    v_mfma_f32_16x16x32_bf16 a[112:115], v[32:35], v[60:63], a[112:115]
    v_mfma_f32_16x16x32_bf16 a[116:119], v[36:39], v[60:63], a[116:119]
    v_mfma_f32_16x16x32_bf16 a[120:123], v[40:43], v[60:63], a[120:123]
    v_mfma_f32_16x16x32_bf16 a[124:127], v[44:47], v[60:63], a[124:127]
    s_nop 7
    s_nop 7
    v_and_b32 v4, 15, v2
    v_lshlrev_b32 v4, 2, v4
    v_lshrrev_b32 v5, 4, v2
    v_lshl_add_u32 v4, v5, 10, v4
    s_lshl_b32 s52, s8, 15
    v_add_u32 v4, s52, v4
    v_accvgpr_read_b32 v8, a0
    v_accvgpr_read_b32 v9, a1
    v_accvgpr_read_b32 v10, a2
    v_accvgpr_read_b32 v11, a3
    ds_write_b32 v4, v8 offset:0
    ds_write_b32 v4, v9 offset:256
    ds_write_b32 v4, v10 offset:512
    ds_write_b32 v4, v11 offset:768
    v_accvgpr_read_b32 v8, a4
    v_accvgpr_read_b32 v9, a5
    v_accvgpr_read_b32 v10, a6
    v_accvgpr_read_b32 v11, a7
    ds_write_b32 v4, v8 offset:4096
    ds_write_b32 v4, v9 offset:4352
    ds_write_b32 v4, v10 offset:4608
    ds_write_b32 v4, v11 offset:4864
    v_accvgpr_read_b32 v8, a8
    v_accvgpr_read_b32 v9, a9
    v_accvgpr_read_b32 v10, a10
    v_accvgpr_read_b32 v11, a11
    ds_write_b32 v4, v8 offset:8192
    ds_write_b32 v4, v9 offset:8448
    ds_write_b32 v4, v10 offset:8704
    ds_write_b32 v4, v11 offset:8960
    v_accvgpr_read_b32 v8, a12
    v_accvgpr_read_b32 v9, a13
    v_accvgpr_read_b32 v10, a14
    v_accvgpr_read_b32 v11, a15
    ds_write_b32 v4, v8 offset:12288
    ds_write_b32 v4, v9 offset:12544
    ds_write_b32 v4, v10 offset:12800
    ds_write_b32 v4, v11 offset:13056
    v_accvgpr_read_b32 v8, a16
    v_accvgpr_read_b32 v9, a17
    v_accvgpr_read_b32 v10, a18
    v_accvgpr_read_b32 v11, a19
    ds_write_b32 v4, v8 offset:64
    ds_write_b32 v4, v9 offset:320
    ds_write_b32 v4, v10 offset:576
    ds_write_b32 v4, v11 offset:832
    v_accvgpr_read_b32 v8, a20
    v_accvgpr_read_b32 v9, a21
    v_accvgpr_read_b32 v10, a22
    v_accvgpr_read_b32 v11, a23
    ds_write_b32 v4, v8 offset:4160
    ds_write_b32 v4, v9 offset:4416
    ds_write_b32 v4, v10 offset:4672
    ds_write_b32 v4, v11 offset:4928
    v_accvgpr_read_b32 v8, a24
    v_accvgpr_read_b32 v9, a25
    v_accvgpr_read_b32 v10, a26
    v_accvgpr_read_b32 v11, a27
    ds_write_b32 v4, v8 offset:8256
    ds_write_b32 v4, v9 offset:8512
    ds_write_b32 v4, v10 offset:8768
    ds_write_b32 v4, v11 offset:9024
    v_accvgpr_read_b32 v8, a28
    v_accvgpr_read_b32 v9, a29
    v_accvgpr_read_b32 v10, a30
    v_accvgpr_read_b32 v11, a31
    ds_write_b32 v4, v8 offset:12352
    ds_write_b32 v4, v9 offset:12608
    ds_write_b32 v4, v10 offset:12864
    ds_write_b32 v4, v11 offset:13120
    v_accvgpr_read_b32 v8, a32
    v_accvgpr_read_b32 v9, a33
    v_accvgpr_read_b32 v10, a34
    v_accvgpr_read_b32 v11, a35
    ds_write_b32 v4, v8 offset:128
    ds_write_b32 v4, v9 offset:384
    ds_write_b32 v4, v10 offset:640
    ds_write_b32 v4, v11 offset:896
    v_accvgpr_read_b32 v8, a36
    v_accvgpr_read_b32 v9, a37
    v_accvgpr_read_b32 v10, a38
    v_accvgpr_read_b32 v11, a39
    ds_write_b32 v4, v8 offset:4224
    ds_write_b32 v4, v9 offset:4480
    ds_write_b32 v4, v10 offset:4736
    ds_write_b32 v4, v11 offset:4992
    v_accvgpr_read_b32 v8, a40
    v_accvgpr_read_b32 v9, a41
    v_accvgpr_read_b32 v10, a42
    v_accvgpr_read_b32 v11, a43
    ds_write_b32 v4, v8 offset:8320
    ds_write_b32 v4, v9 offset:8576
    ds_write_b32 v4, v10 offset:8832
    ds_write_b32 v4, v11 offset:9088
    v_accvgpr_read_b32 v8, a44
    v_accvgpr_read_b32 v9, a45
    v_accvgpr_read_b32 v10, a46
    v_accvgpr_read_b32 v11, a47
    ds_write_b32 v4, v8 offset:12416
    ds_write_b32 v4, v9 offset:12672
    ds_write_b32 v4, v10 offset:12928
    ds_write_b32 v4, v11 offset:13184
    v_accvgpr_read_b32 v8, a48
    v_accvgpr_read_b32 v9, a49
    v_accvgpr_read_b32 v10, a50
    v_accvgpr_read_b32 v11, a51
    ds_write_b32 v4, v8 offset:192
    ds_write_b32 v4, v9 offset:448
    ds_write_b32 v4, v10 offset:704
    ds_write_b32 v4, v11 offset:960
    v_accvgpr_read_b32 v8, a52
    v_accvgpr_read_b32 v9, a53
    v_accvgpr_read_b32 v10, a54
    v_accvgpr_read_b32 v11, a55
    ds_write_b32 v4, v8 offset:4288
    ds_write_b32 v4, v9 offset:4544
    ds_write_b32 v4, v10 offset:4800
    ds_write_b32 v4, v11 offset:5056
    v_accvgpr_read_b32 v8, a56
    v_accvgpr_read_b32 v9, a57
    v_accvgpr_read_b32 v10, a58
    v_accvgpr_read_b32 v11, a59
    ds_write_b32 v4, v8 offset:8384
    ds_write_b32 v4, v9 offset:8640
    ds_write_b32 v4, v10 offset:8896
    ds_write_b32 v4, v11 offset:9152
    v_accvgpr_read_b32 v8, a60
    v_accvgpr_read_b32 v9, a61
    v_accvgpr_read_b32 v10, a62
    v_accvgpr_read_b32 v11, a63
    ds_write_b32 v4, v8 offset:12480
    ds_write_b32 v4, v9 offset:12736
    ds_write_b32 v4, v10 offset:12992
    ds_write_b32 v4, v11 offset:13248
    v_accvgpr_read_b32 v8, a64
    v_accvgpr_read_b32 v9, a65
    v_accvgpr_read_b32 v10, a66
    v_accvgpr_read_b32 v11, a67
    ds_write_b32 v4, v8 offset:16384
    ds_write_b32 v4, v9 offset:16640
    ds_write_b32 v4, v10 offset:16896
    ds_write_b32 v4, v11 offset:17152
    v_accvgpr_read_b32 v8, a68
    v_accvgpr_read_b32 v9, a69
    v_accvgpr_read_b32 v10, a70
    v_accvgpr_read_b32 v11, a71
    ds_write_b32 v4, v8 offset:20480
    ds_write_b32 v4, v9 offset:20736
    ds_write_b32 v4, v10 offset:20992
    ds_write_b32 v4, v11 offset:21248
    v_accvgpr_read_b32 v8, a72
    v_accvgpr_read_b32 v9, a73
    v_accvgpr_read_b32 v10, a74
    v_accvgpr_read_b32 v11, a75
    ds_write_b32 v4, v8 offset:24576
    ds_write_b32 v4, v9 offset:24832
    ds_write_b32 v4, v10 offset:25088
    ds_write_b32 v4, v11 offset:25344
    v_accvgpr_read_b32 v8, a76
    v_accvgpr_read_b32 v9, a77
    v_accvgpr_read_b32 v10, a78
    v_accvgpr_read_b32 v11, a79
    ds_write_b32 v4, v8 offset:28672
    ds_write_b32 v4, v9 offset:28928
    ds_write_b32 v4, v10 offset:29184
    ds_write_b32 v4, v11 offset:29440
    v_accvgpr_read_b32 v8, a80
    v_accvgpr_read_b32 v9, a81
    v_accvgpr_read_b32 v10, a82
    v_accvgpr_read_b32 v11, a83
    ds_write_b32 v4, v8 offset:16448
    ds_write_b32 v4, v9 offset:16704
    ds_write_b32 v4, v10 offset:16960
    ds_write_b32 v4, v11 offset:17216
    v_accvgpr_read_b32 v8, a84
    v_accvgpr_read_b32 v9, a85
    v_accvgpr_read_b32 v10, a86
    v_accvgpr_read_b32 v11, a87
    ds_write_b32 v4, v8 offset:20544
    ds_write_b32 v4, v9 offset:20800
    ds_write_b32 v4, v10 offset:21056
    ds_write_b32 v4, v11 offset:21312
    v_accvgpr_read_b32 v8, a88
    v_accvgpr_read_b32 v9, a89
    v_accvgpr_read_b32 v10, a90
    v_accvgpr_read_b32 v11, a91
    ds_write_b32 v4, v8 offset:24640
    ds_write_b32 v4, v9 offset:24896
    ds_write_b32 v4, v10 offset:25152
    ds_write_b32 v4, v11 offset:25408
    v_accvgpr_read_b32 v8, a92
    v_accvgpr_read_b32 v9, a93
    v_accvgpr_read_b32 v10, a94
    v_accvgpr_read_b32 v11, a95
    ds_write_b32 v4, v8 offset:28736
    ds_write_b32 v4, v9 offset:28992
    ds_write_b32 v4, v10 offset:29248
    ds_write_b32 v4, v11 offset:29504
    v_accvgpr_read_b32 v8, a96
    v_accvgpr_read_b32 v9, a97
    v_accvgpr_read_b32 v10, a98
    v_accvgpr_read_b32 v11, a99
    ds_write_b32 v4, v8 offset:16512
    ds_write_b32 v4, v9 offset:16768
    ds_write_b32 v4, v10 offset:17024
    ds_write_b32 v4, v11 offset:17280
    v_accvgpr_read_b32 v8, a100
    v_accvgpr_read_b32 v9, a101
    v_accvgpr_read_b32 v10, a102
    v_accvgpr_read_b32 v11, a103
    ds_write_b32 v4, v8 offset:20608
    ds_write_b32 v4, v9 offset:20864
    ds_write_b32 v4, v10 offset:21120
    ds_write_b32 v4, v11 offset:21376
    v_accvgpr_read_b32 v8, a104
    v_accvgpr_read_b32 v9, a105
    v_accvgpr_read_b32 v10, a106
    v_accvgpr_read_b32 v11, a107
    ds_write_b32 v4, v8 offset:24704
    ds_write_b32 v4, v9 offset:24960
    ds_write_b32 v4, v10 offset:25216
    ds_write_b32 v4, v11 offset:25472
    v_accvgpr_read_b32 v8, a108
    v_accvgpr_read_b32 v9, a109
    v_accvgpr_read_b32 v10, a110
    v_accvgpr_read_b32 v11, a111
    ds_write_b32 v4, v8 offset:28800
    ds_write_b32 v4, v9 offset:29056
    ds_write_b32 v4, v10 offset:29312
    ds_write_b32 v4, v11 offset:29568
    v_accvgpr_read_b32 v8, a112
    v_accvgpr_read_b32 v9, a113
    v_accvgpr_read_b32 v10, a114
    v_accvgpr_read_b32 v11, a115
    ds_write_b32 v4, v8 offset:16576
    ds_write_b32 v4, v9 offset:16832
    ds_write_b32 v4, v10 offset:17088
    ds_write_b32 v4, v11 offset:17344
    v_accvgpr_read_b32 v8, a116
    v_accvgpr_read_b32 v9, a117
    v_accvgpr_read_b32 v10, a118
    v_accvgpr_read_b32 v11, a119
    ds_write_b32 v4, v8 offset:20672
    ds_write_b32 v4, v9 offset:20928
    ds_write_b32 v4, v10 offset:21184
    ds_write_b32 v4, v11 offset:21440
    v_accvgpr_read_b32 v8, a120
    v_accvgpr_read_b32 v9, a121
    v_accvgpr_read_b32 v10, a122
    v_accvgpr_read_b32 v11, a123
    ds_write_b32 v4, v8 offset:24768
    ds_write_b32 v4, v9 offset:25024
    ds_write_b32 v4, v10 offset:25280
    ds_write_b32 v4, v11 offset:25536
    v_accvgpr_read_b32 v8, a124
    v_accvgpr_read_b32 v9, a125
    v_accvgpr_read_b32 v10, a126
    v_accvgpr_read_b32 v11, a127
    ds_write_b32 v4, v8 offset:28864
    ds_write_b32 v4, v9 offset:29120
    ds_write_b32 v4, v10 offset:29376
    ds_write_b32 v4, v11 offset:29632
    s_waitcnt lgkmcnt(0)
    s_barrier
    v_lshrrev_b32 v4, 2, v0
    v_and_b32 v5, 3, v0
    v_lshlrev_b32 v6, 8, v4
    v_lshl_add_u32 v6, v5, 6, v6
    v_add_u32 v11, 0x10000, v6
    s_lshl_b32 s53, s6, 6
    v_add_u32 v7, s53, v4
    v_lshlrev_b32 v8, 9, v7
    s_lshl_b32 s54, s7, 6
    v_add_u32 v8, s54, v8
    v_lshl_add_u32 v8, v5, 4, v8
    v_lshlrev_b32 v9, 1, v8
    v_lshlrev_b32 v10, 2, v8
    buffer_load_dwordx4 v[96:99], v9, s[32:35], 0 offen
    buffer_load_dwordx4 v[100:103], v9, s[32:35], 0 offen offset:16
    buffer_load_dwordx4 v[104:107], v9, s[28:31], 0 offen
    buffer_load_dwordx4 v[108:111], v9, s[28:31], 0 offen offset:16
    ds_read_b128 v[32:35], v6 offset:0
    ds_read_b128 v[36:39], v6 offset:16
    ds_read_b128 v[40:43], v6 offset:32
    ds_read_b128 v[44:47], v6 offset:48
    ds_read_b128 v[64:67], v6 offset:32768
    ds_read_b128 v[68:71], v6 offset:32784
    ds_read_b128 v[72:75], v6 offset:32800
    ds_read_b128 v[76:79], v6 offset:32816
    s_waitcnt lgkmcnt(0)
    v_add_f32 v32, v32, v64
    v_add_f32 v33, v33, v65
    v_add_f32 v34, v34, v66
    v_add_f32 v35, v35, v67
    v_add_f32 v36, v36, v68
    v_add_f32 v37, v37, v69
    v_add_f32 v38, v38, v70
    v_add_f32 v39, v39, v71
    v_add_f32 v40, v40, v72
    v_add_f32 v41, v41, v73
    v_add_f32 v42, v42, v74
    v_add_f32 v43, v43, v75
    v_add_f32 v44, v44, v76
    v_add_f32 v45, v45, v77
    v_add_f32 v46, v46, v78
    v_add_f32 v47, v47, v79
    ds_read_b128 v[64:67], v11 offset:0
    ds_read_b128 v[68:71], v11 offset:16
    ds_read_b128 v[72:75], v11 offset:32
    ds_read_b128 v[76:79], v11 offset:48
    s_waitcnt lgkmcnt(0)
    v_add_f32 v32, v32, v64
    v_add_f32 v33, v33, v65
    v_add_f32 v34, v34, v66
    v_add_f32 v35, v35, v67
    v_add_f32 v36, v36, v68
    v_add_f32 v37, v37, v69
    v_add_f32 v38, v38, v70
    v_add_f32 v39, v39, v71
    v_add_f32 v40, v40, v72
    v_add_f32 v41, v41, v73
    v_add_f32 v42, v42, v74
    v_add_f32 v43, v43, v75
    v_add_f32 v44, v44, v76
    v_add_f32 v45, v45, v77
    v_add_f32 v46, v46, v78
    v_add_f32 v47, v47, v79
    ds_read_b128 v[64:67], v11 offset:32768
    ds_read_b128 v[68:71], v11 offset:32784
    ds_read_b128 v[72:75], v11 offset:32800
    ds_read_b128 v[76:79], v11 offset:32816
    s_waitcnt lgkmcnt(0)
    v_add_f32 v32, v32, v64
    v_add_f32 v33, v33, v65
    v_add_f32 v34, v34, v66
    v_add_f32 v35, v35, v67
    v_add_f32 v36, v36, v68
    v_add_f32 v37, v37, v69
    v_add_f32 v38, v38, v70
    v_add_f32 v39, v39, v71
    v_add_f32 v40, v40, v72
    v_add_f32 v41, v41, v73
    v_add_f32 v42, v42, v74
    v_add_f32 v43, v43, v75
    v_add_f32 v44, v44, v76
    v_add_f32 v45, v45, v77
    v_add_f32 v46, v46, v78
    v_add_f32 v47, v47, v79
    ds_read_b128 v[48:51], v6 offset:16384
    ds_read_b128 v[52:55], v6 offset:16400
    ds_read_b128 v[56:59], v6 offset:16416
    ds_read_b128 v[60:63], v6 offset:16432
    ds_read_b128 v[64:67], v6 offset:49152
    ds_read_b128 v[68:71], v6 offset:49168
    ds_read_b128 v[72:75], v6 offset:49184
    ds_read_b128 v[76:79], v6 offset:49200
    s_waitcnt lgkmcnt(0)
    v_add_f32 v48, v48, v64
    v_add_f32 v49, v49, v65
    v_add_f32 v50, v50, v66
    v_add_f32 v51, v51, v67
    v_add_f32 v52, v52, v68
    v_add_f32 v53, v53, v69
    v_add_f32 v54, v54, v70
    v_add_f32 v55, v55, v71
    v_add_f32 v56, v56, v72
    v_add_f32 v57, v57, v73
    v_add_f32 v58, v58, v74
    v_add_f32 v59, v59, v75
    v_add_f32 v60, v60, v76
    v_add_f32 v61, v61, v77
    v_add_f32 v62, v62, v78
    v_add_f32 v63, v63, v79
    ds_read_b128 v[64:67], v11 offset:16384
    ds_read_b128 v[68:71], v11 offset:16400
    ds_read_b128 v[72:75], v11 offset:16416
    ds_read_b128 v[76:79], v11 offset:16432
    s_waitcnt lgkmcnt(0)
    v_add_f32 v48, v48, v64
    v_add_f32 v49, v49, v65
    v_add_f32 v50, v50, v66
    v_add_f32 v51, v51, v67
    v_add_f32 v52, v52, v68
    v_add_f32 v53, v53, v69
    v_add_f32 v54, v54, v70
    v_add_f32 v55, v55, v71
    v_add_f32 v56, v56, v72
    v_add_f32 v57, v57, v73
    v_add_f32 v58, v58, v74
    v_add_f32 v59, v59, v75
    v_add_f32 v60, v60, v76
    v_add_f32 v61, v61, v77
    v_add_f32 v62, v62, v78
    v_add_f32 v63, v63, v79
    ds_read_b128 v[64:67], v11 offset:49152
    ds_read_b128 v[68:71], v11 offset:49168
    ds_read_b128 v[72:75], v11 offset:49184
    ds_read_b128 v[76:79], v11 offset:49200
    s_waitcnt lgkmcnt(0)
    v_add_f32 v48, v48, v64
    v_add_f32 v49, v49, v65
    v_add_f32 v50, v50, v66
    v_add_f32 v51, v51, v67
    v_add_f32 v52, v52, v68
    v_add_f32 v53, v53, v69
    v_add_f32 v54, v54, v70
    v_add_f32 v55, v55, v71
    v_add_f32 v56, v56, v72
    v_add_f32 v57, v57, v73
    v_add_f32 v58, v58, v74
    v_add_f32 v59, v59, v75
    v_add_f32 v60, v60, v76
    v_add_f32 v61, v61, v77
    v_add_f32 v62, v62, v78
    v_add_f32 v63, v63, v79
    s_mov_b32 s55, 0xffff0000
    s_waitcnt vmcnt(0)
    v_lshlrev_b32 v64, 16, v96
    v_and_b32 v65, s55, v96
    v_lshlrev_b32 v80, 16, v104
    v_and_b32 v81, s55, v104
    v_lshlrev_b32 v66, 16, v97
    v_and_b32 v67, s55, v97
    v_lshlrev_b32 v82, 16, v105
    v_and_b32 v83, s55, v105
    v_lshlrev_b32 v68, 16, v98
    v_and_b32 v69, s55, v98
    v_lshlrev_b32 v84, 16, v106
    v_and_b32 v85, s55, v106
    v_lshlrev_b32 v70, 16, v99
    v_and_b32 v71, s55, v99
    v_lshlrev_b32 v86, 16, v107
    v_and_b32 v87, s55, v107
    v_lshlrev_b32 v72, 16, v100
    v_and_b32 v73, s55, v100
    v_lshlrev_b32 v88, 16, v108
    v_and_b32 v89, s55, v108
    v_lshlrev_b32 v74, 16, v101
    v_and_b32 v75, s55, v101
    v_lshlrev_b32 v90, 16, v109
    v_and_b32 v91, s55, v109
    v_lshlrev_b32 v76, 16, v102
    v_and_b32 v77, s55, v102
    v_lshlrev_b32 v92, 16, v110
    v_and_b32 v93, s55, v110
    v_lshlrev_b32 v78, 16, v103
    v_and_b32 v79, s55, v103
    v_lshlrev_b32 v94, 16, v111
    v_and_b32 v95, s55, v111
    v_fma_f32 v32, 2.0, v32, v80
    v_cvt_pk_bf16_f32 v112, v48, v48
    v_lshlrev_b32 v48, 16, v112
    v_mul_f32 v113, 0xbfb8aa3b, v48
    v_exp_f32 v113, v113
    s_nop 0
    v_add_f32 v113, 1.0, v113
    v_rcp_f32 v113, v113
    s_nop 0
    v_mul_f32 v113, v48, v113
    v_cvt_pk_bf16_f32 v112, v113, v113
    v_lshlrev_b32 v113, 16, v112
    v_fma_f32 v64, v32, v113, v64
    v_fma_f32 v33, 2.0, v33, v81
    v_cvt_pk_bf16_f32 v112, v49, v49
    v_lshlrev_b32 v49, 16, v112
    v_mul_f32 v113, 0xbfb8aa3b, v49
    v_exp_f32 v113, v113
    s_nop 0
    v_add_f32 v113, 1.0, v113
    v_rcp_f32 v113, v113
    s_nop 0
    v_mul_f32 v113, v49, v113
    v_cvt_pk_bf16_f32 v112, v113, v113
    v_lshlrev_b32 v113, 16, v112
    v_fma_f32 v65, v33, v113, v65
    v_fma_f32 v34, 2.0, v34, v82
    v_cvt_pk_bf16_f32 v112, v50, v50
    v_lshlrev_b32 v50, 16, v112
    v_mul_f32 v113, 0xbfb8aa3b, v50
    v_exp_f32 v113, v113
    s_nop 0
    v_add_f32 v113, 1.0, v113
    v_rcp_f32 v113, v113
    s_nop 0
    v_mul_f32 v113, v50, v113
    v_cvt_pk_bf16_f32 v112, v113, v113
    v_lshlrev_b32 v113, 16, v112
    v_fma_f32 v66, v34, v113, v66
    v_fma_f32 v35, 2.0, v35, v83
    v_cvt_pk_bf16_f32 v112, v51, v51
    v_lshlrev_b32 v51, 16, v112
    v_mul_f32 v113, 0xbfb8aa3b, v51
    v_exp_f32 v113, v113
    s_nop 0
    v_add_f32 v113, 1.0, v113
    v_rcp_f32 v113, v113
    s_nop 0
    v_mul_f32 v113, v51, v113
    v_cvt_pk_bf16_f32 v112, v113, v113
    v_lshlrev_b32 v113, 16, v112
    v_fma_f32 v67, v35, v113, v67
    v_fma_f32 v36, 2.0, v36, v84
    v_cvt_pk_bf16_f32 v112, v52, v52
    v_lshlrev_b32 v52, 16, v112
    v_mul_f32 v113, 0xbfb8aa3b, v52
    v_exp_f32 v113, v113
    s_nop 0
    v_add_f32 v113, 1.0, v113
    v_rcp_f32 v113, v113
    s_nop 0
    v_mul_f32 v113, v52, v113
    v_cvt_pk_bf16_f32 v112, v113, v113
    v_lshlrev_b32 v113, 16, v112
    v_fma_f32 v68, v36, v113, v68
    v_fma_f32 v37, 2.0, v37, v85
    v_cvt_pk_bf16_f32 v112, v53, v53
    v_lshlrev_b32 v53, 16, v112
    v_mul_f32 v113, 0xbfb8aa3b, v53
    v_exp_f32 v113, v113
    s_nop 0
    v_add_f32 v113, 1.0, v113
    v_rcp_f32 v113, v113
    s_nop 0
    v_mul_f32 v113, v53, v113
    v_cvt_pk_bf16_f32 v112, v113, v113
    v_lshlrev_b32 v113, 16, v112
    v_fma_f32 v69, v37, v113, v69
    v_fma_f32 v38, 2.0, v38, v86
    v_cvt_pk_bf16_f32 v112, v54, v54
    v_lshlrev_b32 v54, 16, v112
    v_mul_f32 v113, 0xbfb8aa3b, v54
    v_exp_f32 v113, v113
    s_nop 0
    v_add_f32 v113, 1.0, v113
    v_rcp_f32 v113, v113
    s_nop 0
    v_mul_f32 v113, v54, v113
    v_cvt_pk_bf16_f32 v112, v113, v113
    v_lshlrev_b32 v113, 16, v112
    v_fma_f32 v70, v38, v113, v70
    v_fma_f32 v39, 2.0, v39, v87
    v_cvt_pk_bf16_f32 v112, v55, v55
    v_lshlrev_b32 v55, 16, v112
    v_mul_f32 v113, 0xbfb8aa3b, v55
    v_exp_f32 v113, v113
    s_nop 0
    v_add_f32 v113, 1.0, v113
    v_rcp_f32 v113, v113
    s_nop 0
    v_mul_f32 v113, v55, v113
    v_cvt_pk_bf16_f32 v112, v113, v113
    v_lshlrev_b32 v113, 16, v112
    v_fma_f32 v71, v39, v113, v71
    v_fma_f32 v40, 2.0, v40, v88
    v_cvt_pk_bf16_f32 v112, v56, v56
    v_lshlrev_b32 v56, 16, v112
    v_mul_f32 v113, 0xbfb8aa3b, v56
    v_exp_f32 v113, v113
    s_nop 0
    v_add_f32 v113, 1.0, v113
    v_rcp_f32 v113, v113
    s_nop 0
    v_mul_f32 v113, v56, v113
    v_cvt_pk_bf16_f32 v112, v113, v113
    v_lshlrev_b32 v113, 16, v112
    v_fma_f32 v72, v40, v113, v72
    v_fma_f32 v41, 2.0, v41, v89
    v_cvt_pk_bf16_f32 v112, v57, v57
    v_lshlrev_b32 v57, 16, v112
    v_mul_f32 v113, 0xbfb8aa3b, v57
    v_exp_f32 v113, v113
    s_nop 0
    v_add_f32 v113, 1.0, v113
    v_rcp_f32 v113, v113
    s_nop 0
    v_mul_f32 v113, v57, v113
    v_cvt_pk_bf16_f32 v112, v113, v113
    v_lshlrev_b32 v113, 16, v112
    v_fma_f32 v73, v41, v113, v73
    v_fma_f32 v42, 2.0, v42, v90
    v_cvt_pk_bf16_f32 v112, v58, v58
    v_lshlrev_b32 v58, 16, v112
    v_mul_f32 v113, 0xbfb8aa3b, v58
    v_exp_f32 v113, v113
    s_nop 0
    v_add_f32 v113, 1.0, v113
    v_rcp_f32 v113, v113
    s_nop 0
    v_mul_f32 v113, v58, v113
    v_cvt_pk_bf16_f32 v112, v113, v113
    v_lshlrev_b32 v113, 16, v112
    v_fma_f32 v74, v42, v113, v74
    v_fma_f32 v43, 2.0, v43, v91
    v_cvt_pk_bf16_f32 v112, v59, v59
    v_lshlrev_b32 v59, 16, v112
    v_mul_f32 v113, 0xbfb8aa3b, v59
    v_exp_f32 v113, v113
    s_nop 0
    v_add_f32 v113, 1.0, v113
    v_rcp_f32 v113, v113
    s_nop 0
    v_mul_f32 v113, v59, v113
    v_cvt_pk_bf16_f32 v112, v113, v113
    v_lshlrev_b32 v113, 16, v112
    v_fma_f32 v75, v43, v113, v75
    v_fma_f32 v44, 2.0, v44, v92
    v_cvt_pk_bf16_f32 v112, v60, v60
    v_lshlrev_b32 v60, 16, v112
    v_mul_f32 v113, 0xbfb8aa3b, v60
    v_exp_f32 v113, v113
    s_nop 0
    v_add_f32 v113, 1.0, v113
    v_rcp_f32 v113, v113
    s_nop 0
    v_mul_f32 v113, v60, v113
    v_cvt_pk_bf16_f32 v112, v113, v113
    v_lshlrev_b32 v113, 16, v112
    v_fma_f32 v76, v44, v113, v76
    v_fma_f32 v45, 2.0, v45, v93
    v_cvt_pk_bf16_f32 v112, v61, v61
    v_lshlrev_b32 v61, 16, v112
    v_mul_f32 v113, 0xbfb8aa3b, v61
    v_exp_f32 v113, v113
    s_nop 0
    v_add_f32 v113, 1.0, v113
    v_rcp_f32 v113, v113
    s_nop 0
    v_mul_f32 v113, v61, v113
    v_cvt_pk_bf16_f32 v112, v113, v113
    v_lshlrev_b32 v113, 16, v112
    v_fma_f32 v77, v45, v113, v77
    v_fma_f32 v46, 2.0, v46, v94
    v_cvt_pk_bf16_f32 v112, v62, v62
    v_lshlrev_b32 v62, 16, v112
    v_mul_f32 v113, 0xbfb8aa3b, v62
    v_exp_f32 v113, v113
    s_nop 0
    v_add_f32 v113, 1.0, v113
    v_rcp_f32 v113, v113
    s_nop 0
    v_mul_f32 v113, v62, v113
    v_cvt_pk_bf16_f32 v112, v113, v113
    v_lshlrev_b32 v113, 16, v112
    v_fma_f32 v78, v46, v113, v78
    v_fma_f32 v47, 2.0, v47, v95
    v_cvt_pk_bf16_f32 v112, v63, v63
    v_lshlrev_b32 v63, 16, v112
    v_mul_f32 v113, 0xbfb8aa3b, v63
    v_exp_f32 v113, v113
    s_nop 0
    v_add_f32 v113, 1.0, v113
    v_rcp_f32 v113, v113
    s_nop 0
    v_mul_f32 v113, v63, v113
    v_cvt_pk_bf16_f32 v112, v113, v113
    v_lshlrev_b32 v113, 16, v112
    v_fma_f32 v79, v47, v113, v79
    buffer_store_dwordx4 v[64:67], v10, s[40:43], 0 offen offset:0
    buffer_store_dwordx4 v[68:71], v10, s[40:43], 0 offen offset:16
    buffer_store_dwordx4 v[72:75], v10, s[40:43], 0 offen offset:32
    buffer_store_dwordx4 v[76:79], v10, s[40:43], 0 offen offset:48
K2_done:
    s_endpgm
.section .rodata,"a"
.p2align 6
.amdhsa_kernel k2_kernel
  .amdhsa_next_free_vgpr 256
  .amdhsa_next_free_sgpr 64
  .amdhsa_accum_offset 128
  .amdhsa_group_segment_fixed_size 0
  .amdhsa_kernarg_size 128
  .amdhsa_user_sgpr_count 2
  .amdhsa_user_sgpr_kernarg_segment_ptr 1
  .amdhsa_system_sgpr_workgroup_id_x 1
.end_amdhsa_kernel
```
